```python
import torch

def _softmax(x, axis=-1):
    return torch.softmax(x, dim=axis)
def _gelu(x):
    return torch.nn.functional.gelu(x, approximate="tanh")
def _silu(x):
    return torch.nn.functional.silu(x)
def _sigmoid(x):
    return torch.sigmoid(x)
def _layernorm(x, axis=-1, eps=1e-5):
    m = x.mean(dim=axis, keepdim=True)
    v = x.var(dim=axis, keepdim=True, unbiased=False)
    return (x - m) / torch.sqrt(v + eps)
def _scatter_add(tgt, idx, src, axis=0):
    return tgt.clone().index_add_(axis, idx, src)
def _segment_sum(src, seg, n):
    out = torch.zeros((n,) + src.shape[1:], dtype=src.dtype)
    return out.index_add_(0, seg, src)
def _pad(x, pw):
    flat = tuple(v for pair in reversed(pw) for v in pair)
    return torch.nn.functional.pad(x, flat)

kernel_name = 'interleave_layers__linear_attn_block__sliding_block__prompt'

def setup_inputs():

    _w = (lambda a: (lambda t: t.to(torch.bfloat16) if t.is_floating_point() else t)(torch.as_tensor(a)))
    def _A_setup():
        B, S, D = 1, 2048, 1024
        return {
            "x": _w((lambda *s: torch.randn(*s, dtype=torch.bfloat16) * 0.05)(B, S, D)),
            "wqkv": _w((lambda *s: torch.randn(*s, dtype=torch.bfloat16) * 0.05)(D, 3 * D)),
            "wo": _w((lambda *s: torch.randn(*s, dtype=torch.bfloat16) * 0.05)(D, D)),
        }
    _A_in = _A_setup()

    def _B_setup():
        B, S, D = 1, 2048, 1024
        return {
            "x": _w((lambda *s: torch.randn(*s, dtype=torch.bfloat16) * 0.05)(B, S, D)),
            "wqkv": _w((lambda *s: torch.randn(*s, dtype=torch.bfloat16) * 0.05)(D, 3 * D)),
            "wo": _w((lambda *s: torch.randn(*s, dtype=torch.bfloat16) * 0.05)(D, D)),
        }
    _B_in = _B_setup()

    return {
        "A_x": _A_in["x"],
        "A_wqkv": _A_in["wqkv"],
        "A_wo": _A_in["wo"],
        "B_x": _B_in["x"],
        "B_wqkv": _B_in["wqkv"],
        "B_wo": _B_in["wo"],
    }

def reference(A_x, A_wqkv, A_wo, B_x, B_wqkv, B_wo):
    def _A_ref(x, wqkv, wo):
        B, S, D = x.shape
        H = 32; Dh = D // H
        qkv = (lambda x, *d: x.permute(*d))((x @ wqkv).reshape(B, S, 3, H, Dh), 2, 0, 3, 1, 4)
        q, k, v = qkv[0], qkv[1], qkv[2]
        phi = lambda t: torch.where(t > 0, t + 1, torch.exp(t)) + 1e-6
        pq, pk = phi(q), phi(k)
        kv = torch.einsum("bhsd,bhse->bhde", pk, v)
        z = torch.einsum("bhsd->bhd", pk)
        num = torch.einsum("bhqd,bhde->bhqe", pq, kv)
        den = torch.einsum("bhqd,bhd->bhq", pq, z)[..., None] + 1e-6
        o = num / den
        return (lambda x, *d: x.permute(*d))(o, 0, 2, 1, 3).reshape(B, S, D) @ wo

    def _B_ref(x, wqkv, wo):
        B, S, D = x.shape
        H = 32; Dh = D // H; W = 256
        qkv = (lambda x, *d: x.permute(*d))((x @ wqkv).reshape(B, S, 3, H, Dh), 2, 0, 3, 1, 4)
        q, k, v = qkv[0], qkv[1], qkv[2]
        scores = torch.einsum("bhqd,bhkd->bhqk", q, k) * (Dh ** -0.5)
        idx = torch.arange(S)
        mask = (idx[:, None] - idx[None, :] >= 0) & (idx[:, None] - idx[None, :] < W)
        scores = torch.where(mask[None, None], scores, -1e9)
        p = _softmax(scores, axis=-1)
        o = torch.einsum("bhqk,bhkd->bhqd", p, v)
        return (lambda x, *d: x.permute(*d))(o, 0, 2, 1, 3).reshape(B, S, D) @ wo

    x = A_x
    x = x + _A_ref(_layernorm(x, axis=-1), A_wqkv, A_wo)
    x = x + _B_ref(_layernorm(x, axis=-1), B_wqkv, B_wo)
    x = x + _A_ref(_layernorm(x, axis=-1), A_wqkv, A_wo)
    x = x + _B_ref(_layernorm(x, axis=-1), B_wqkv, B_wo)
    return x
```

```asm
; @launch kernel=prep_kernel grid=(256,1,1) block=(256,1,1) lds=0
; @launch kernel=qkv0_kernel grid=(256,1,1) block=(256,1,1) lds=95296
; @launch kernel=atta0_kernel grid=(256,1,1) block=(256,1,1) lds=19584
; @launch kernel=wo0_kernel grid=(256,1,1) block=(256,1,1) lds=62528
; @launch kernel=qkv1_kernel grid=(256,1,1) block=(256,1,1) lds=95296
; @launch kernel=attb1_kernel grid=(512,1,1) block=(256,1,1) lds=0
; @launch kernel=wo1_kernel grid=(256,1,1) block=(256,1,1) lds=62528
; @launch kernel=qkv2_kernel grid=(256,1,1) block=(256,1,1) lds=95296
; @launch kernel=atta0_kernel grid=(256,1,1) block=(256,1,1) lds=19584
; @launch kernel=wo2_kernel grid=(256,1,1) block=(256,1,1) lds=62528
; @launch kernel=qkv3_kernel grid=(256,1,1) block=(256,1,1) lds=95296
; @launch kernel=attb1_kernel grid=(512,1,1) block=(256,1,1) lds=0
; @launch kernel=wo3_kernel grid=(256,1,1) block=(256,1,1) lds=62528
.amdgcn_target "amdgcn-amd-amdhsa--gfx950"
.text
.globl prep_kernel
.p2align 8
.type prep_kernel,@function
prep_kernel:
    s_cmp_ge_u32 s2, 256
    s_cbranch_scc1 L_prep_end
    s_load_dwordx2 s[4:5], s[0:1], 0
    s_load_dwordx2 s[6:7], s[0:1], 64
    s_waitcnt lgkmcnt(0)
    s_add_u32 s6, s6, 4194304
    s_addc_u32 s7, s7, 0
    s_lshl_b32 s3, s2, 8
    v_add_u32 v1, s3, v0
    v_lshlrev_b32 v2, 6, v1
    global_load_dwordx4 v[8:11], v2, s[4:5] offset:0
    global_load_dwordx4 v[12:15], v2, s[4:5] offset:16
    global_load_dwordx4 v[16:19], v2, s[4:5] offset:32
    global_load_dwordx4 v[20:23], v2, s[4:5] offset:48
    v_mov_b32 v4, 0
    v_mov_b32 v5, 0
    s_waitcnt vmcnt(0)
    v_lshlrev_b32 v6, 16, v8
    v_and_b32 v7, 0xffff0000, v8
    v_add_f32 v4, v4, v6
    v_fmac_f32 v5, v6, v6
    v_add_f32 v4, v4, v7
    v_fmac_f32 v5, v7, v7
    v_lshlrev_b32 v6, 16, v9
    v_and_b32 v7, 0xffff0000, v9
    v_add_f32 v4, v4, v6
    v_fmac_f32 v5, v6, v6
    v_add_f32 v4, v4, v7
    v_fmac_f32 v5, v7, v7
    v_lshlrev_b32 v6, 16, v10
    v_and_b32 v7, 0xffff0000, v10
    v_add_f32 v4, v4, v6
    v_fmac_f32 v5, v6, v6
    v_add_f32 v4, v4, v7
    v_fmac_f32 v5, v7, v7
    v_lshlrev_b32 v6, 16, v11
    v_and_b32 v7, 0xffff0000, v11
    v_add_f32 v4, v4, v6
    v_fmac_f32 v5, v6, v6
    v_add_f32 v4, v4, v7
    v_fmac_f32 v5, v7, v7
    v_lshlrev_b32 v6, 16, v12
    v_and_b32 v7, 0xffff0000, v12
    v_add_f32 v4, v4, v6
    v_fmac_f32 v5, v6, v6
    v_add_f32 v4, v4, v7
    v_fmac_f32 v5, v7, v7
    v_lshlrev_b32 v6, 16, v13
    v_and_b32 v7, 0xffff0000, v13
    v_add_f32 v4, v4, v6
    v_fmac_f32 v5, v6, v6
    v_add_f32 v4, v4, v7
    v_fmac_f32 v5, v7, v7
    v_lshlrev_b32 v6, 16, v14
    v_and_b32 v7, 0xffff0000, v14
    v_add_f32 v4, v4, v6
    v_fmac_f32 v5, v6, v6
    v_add_f32 v4, v4, v7
    v_fmac_f32 v5, v7, v7
    v_lshlrev_b32 v6, 16, v15
    v_and_b32 v7, 0xffff0000, v15
    v_add_f32 v4, v4, v6
    v_fmac_f32 v5, v6, v6
    v_add_f32 v4, v4, v7
    v_fmac_f32 v5, v7, v7
    v_lshlrev_b32 v6, 16, v16
    v_and_b32 v7, 0xffff0000, v16
    v_add_f32 v4, v4, v6
    v_fmac_f32 v5, v6, v6
    v_add_f32 v4, v4, v7
    v_fmac_f32 v5, v7, v7
    v_lshlrev_b32 v6, 16, v17
    v_and_b32 v7, 0xffff0000, v17
    v_add_f32 v4, v4, v6
    v_fmac_f32 v5, v6, v6
    v_add_f32 v4, v4, v7
    v_fmac_f32 v5, v7, v7
    v_lshlrev_b32 v6, 16, v18
    v_and_b32 v7, 0xffff0000, v18
    v_add_f32 v4, v4, v6
    v_fmac_f32 v5, v6, v6
    v_add_f32 v4, v4, v7
    v_fmac_f32 v5, v7, v7
    v_lshlrev_b32 v6, 16, v19
    v_and_b32 v7, 0xffff0000, v19
    v_add_f32 v4, v4, v6
    v_fmac_f32 v5, v6, v6
    v_add_f32 v4, v4, v7
    v_fmac_f32 v5, v7, v7
    v_lshlrev_b32 v6, 16, v20
    v_and_b32 v7, 0xffff0000, v20
    v_add_f32 v4, v4, v6
    v_fmac_f32 v5, v6, v6
    v_add_f32 v4, v4, v7
    v_fmac_f32 v5, v7, v7
    v_lshlrev_b32 v6, 16, v21
    v_and_b32 v7, 0xffff0000, v21
    v_add_f32 v4, v4, v6
    v_fmac_f32 v5, v6, v6
    v_add_f32 v4, v4, v7
    v_fmac_f32 v5, v7, v7
    v_lshlrev_b32 v6, 16, v22
    v_and_b32 v7, 0xffff0000, v22
    v_add_f32 v4, v4, v6
    v_fmac_f32 v5, v6, v6
    v_add_f32 v4, v4, v7
    v_fmac_f32 v5, v7, v7
    v_lshlrev_b32 v6, 16, v23
    v_and_b32 v7, 0xffff0000, v23
    v_add_f32 v4, v4, v6
    v_fmac_f32 v5, v6, v6
    v_add_f32 v4, v4, v7
    v_fmac_f32 v5, v7, v7
    v_lshlrev_b32 v3, 3, v1
    global_store_dwordx2 v3, v[4:5], s[6:7]
L_prep_end:
    s_endpgm
.globl qkv0_kernel
.p2align 8
.type qkv0_kernel,@function
qkv0_kernel:
    s_cmp_ge_u32 s2, 256
    s_cbranch_scc1 L_qkv0_end
    s_load_dwordx2 s[4:5], s[0:1], 0
    s_load_dwordx2 s[6:7], s[0:1], 8
    s_load_dwordx2 s[14:15], s[0:1], 64
    s_waitcnt lgkmcnt(0)
    s_add_u32 s14, s14, 4194304
    s_addc_u32 s15, s15, 0
    s_lshr_b32 s8, s2, 4
    s_and_b32 s9, s2, 15
    v_lshrrev_b32 v1, 3, v0
    v_and_b32 v2, 7, v0
    s_lshl_b32 s10, s8, 7
    v_add_u32 v3, s10, v1
    v_lshlrev_b32 v3, 11, v3
    v_lshl_add_u32 v3, v2, 4, v3
    v_add_u32 v4, 0, v3
    v_add_u32 v5, 65536, v3
    v_add_u32 v6, 131072, v3
    v_add_u32 v7, 196608, v3
    s_mov_b32 s11, 6144
    v_mul_lo_u32 v3, v1, s11
    v_lshl_add_u32 v3, v2, 4, v3
    s_lshl_b32 s12, s9, 7
    v_add_u32 v3, s12, v3
    v_add_u32 v8, 0, v3
    v_add_u32 v9, 2048, v3
    v_add_u32 v10, 4096, v3
    v_add_u32 v11, 196608, v3
    v_add_u32 v12, 198656, v3
    v_add_u32 v13, 200704, v3
    v_mul_u32_u24 v14, 144, v1
    v_lshl_add_u32 v14, v2, 4, v14
    v_mul_u32_u24 v15, 448, v1
    v_lshl_add_u32 v15, v2, 4, v15
    v_add_u32 v15, 18432, v15
    v_and_b32 v16, 63, v0
    v_lshrrev_b32 v17, 6, v0
    v_lshrrev_b32 v18, 1, v17
    v_and_b32 v19, 1, v17
    v_and_b32 v20, 31, v16
    v_lshrrev_b32 v21, 5, v16
    v_lshl_add_u32 v22, v18, 6, v20
    v_mul_u32_u24 v22, 144, v22
    v_lshl_add_u32 v22, v21, 4, v22
    v_bfe_u32 v23, v16, 2, 2
    v_lshl_add_u32 v23, v21, 3, v23
    v_mul_u32_u24 v23, 448, v23
    v_bfe_u32 v24, v16, 4, 1
    v_lshlrev_b32 v24, 5, v24
    v_lshl_add_u32 v24, v19, 6, v24
    v_and_b32 v25, 3, v16
    v_lshl_add_u32 v24, v25, 3, v24
    v_add_u32 v23, v23, v24
    v_add_u32 v23, 18432, v23
    v_add_u32 v24, 47104, v22
    v_add_u32 v25, 47104, v23
    v_lshrrev_b32 v26, 1, v0
    v_and_b32 v27, 1, v0
    v_add_u32 v28, s10, v26
    v_lshlrev_b32 v28, 8, v28
    v_lshl_add_u32 v28, v27, 7, v28
    global_load_dwordx4 v[160:163], v28, s[14:15] offset:0
    global_load_dwordx4 v[164:167], v28, s[14:15] offset:16
    global_load_dwordx4 v[168:171], v28, s[14:15] offset:32
    global_load_dwordx4 v[172:175], v28, s[14:15] offset:48
    global_load_dwordx4 v[176:179], v28, s[14:15] offset:64
    global_load_dwordx4 v[180:183], v28, s[14:15] offset:80
    global_load_dwordx4 v[184:187], v28, s[14:15] offset:96
    global_load_dwordx4 v[188:191], v28, s[14:15] offset:112
    v_mov_b32 v34, 0
    v_mov_b32 v35, 0
    global_load_dwordx4 v[40:43], v4, s[4:5]
    global_load_dwordx4 v[44:47], v5, s[4:5]
    global_load_dwordx4 v[48:51], v6, s[4:5]
    global_load_dwordx4 v[52:55], v7, s[4:5]
    global_load_dwordx4 v[56:59], v8, s[6:7]
    global_load_dwordx4 v[60:63], v9, s[6:7]
    global_load_dwordx4 v[64:67], v10, s[6:7]
    global_load_dwordx4 v[68:71], v11, s[6:7]
    global_load_dwordx4 v[72:75], v12, s[6:7]
    global_load_dwordx4 v[76:79], v13, s[6:7]
    s_add_u32 s4, s4, 128
    s_addc_u32 s5, s5, 0
    s_add_u32 s6, s6, 393216
    s_addc_u32 s7, s7, 0
    global_load_dwordx4 v[80:83], v4, s[4:5]
    global_load_dwordx4 v[84:87], v5, s[4:5]
    global_load_dwordx4 v[88:91], v6, s[4:5]
    global_load_dwordx4 v[92:95], v7, s[4:5]
    global_load_dwordx4 v[96:99], v8, s[6:7]
    global_load_dwordx4 v[100:103], v9, s[6:7]
    global_load_dwordx4 v[104:107], v10, s[6:7]
    global_load_dwordx4 v[108:111], v11, s[6:7]
    global_load_dwordx4 v[112:115], v12, s[6:7]
    global_load_dwordx4 v[116:119], v13, s[6:7]
    s_add_u32 s4, s4, 128
    s_addc_u32 s5, s5, 0
    s_add_u32 s6, s6, 393216
    s_addc_u32 s7, s7, 0
    s_waitcnt vmcnt(20)
    v_add_f32 v34, v34, v160
    v_add_f32 v35, v35, v161
    v_add_f32 v34, v34, v162
    v_add_f32 v35, v35, v163
    v_add_f32 v34, v34, v164
    v_add_f32 v35, v35, v165
    v_add_f32 v34, v34, v166
    v_add_f32 v35, v35, v167
    v_add_f32 v34, v34, v168
    v_add_f32 v35, v35, v169
    v_add_f32 v34, v34, v170
    v_add_f32 v35, v35, v171
    v_add_f32 v34, v34, v172
    v_add_f32 v35, v35, v173
    v_add_f32 v34, v34, v174
    v_add_f32 v35, v35, v175
    v_add_f32 v34, v34, v176
    v_add_f32 v35, v35, v177
    v_add_f32 v34, v34, v178
    v_add_f32 v35, v35, v179
    v_add_f32 v34, v34, v180
    v_add_f32 v35, v35, v181
    v_add_f32 v34, v34, v182
    v_add_f32 v35, v35, v183
    v_add_f32 v34, v34, v184
    v_add_f32 v35, v35, v185
    v_add_f32 v34, v34, v186
    v_add_f32 v35, v35, v187
    v_add_f32 v34, v34, v188
    v_add_f32 v35, v35, v189
    v_add_f32 v34, v34, v190
    v_add_f32 v35, v35, v191
    s_nop 1
    v_mov_b32_dpp v31, v34 quad_perm:[1,0,3,2] row_mask:0xf bank_mask:0xf
    v_mov_b32_dpp v32, v35 quad_perm:[1,0,3,2] row_mask:0xf bank_mask:0xf
    v_add_f32 v34, v34, v31
    v_add_f32 v35, v35, v32
    v_mul_f32 v34, 0x3a800000, v34
    v_mul_f32 v35, 0x3a800000, v35
    v_fma_f32 v35, -v34, v34, v35
    v_max_f32 v35, 0, v35
    v_add_f32 v35, 0x3727c5ac, v35
    v_rsq_f32 v35, v35
    s_nop 0
    v_mul_f32 v34, v34, v35
    v_sub_f32 v34, 0, v34
    v_lshlrev_b32 v31, 3, v26
    v_add_u32 v31, 94208, v31
    ds_write_b64 v31, v[34:35]
    s_waitcnt lgkmcnt(0)
    s_barrier
    v_lshlrev_b32 v31, 3, v1
    v_add_u32 v31, 94208, v31
    ds_read_b64 v[26:27], v31 offset:0
    ds_read_b64 v[28:29], v31 offset:256
    ds_read_b64 v[30:31], v31 offset:512
    ds_read_b64 v[32:33], v31 offset:768
    s_waitcnt lgkmcnt(0)
    v_mov_b32 v160, 0
    v_mov_b32 v161, 0
    v_mov_b32 v162, 0
    v_mov_b32 v163, 0
    v_mov_b32 v164, 0
    v_mov_b32 v165, 0
    v_mov_b32 v166, 0
    v_mov_b32 v167, 0
    v_mov_b32 v168, 0
    v_mov_b32 v169, 0
    v_mov_b32 v170, 0
    v_mov_b32 v171, 0
    v_mov_b32 v172, 0
    v_mov_b32 v173, 0
    v_mov_b32 v174, 0
    v_mov_b32 v175, 0
    v_mov_b32 v176, 0
    v_mov_b32 v177, 0
    v_mov_b32 v178, 0
    v_mov_b32 v179, 0
    v_mov_b32 v180, 0
    v_mov_b32 v181, 0
    v_mov_b32 v182, 0
    v_mov_b32 v183, 0
    v_mov_b32 v184, 0
    v_mov_b32 v185, 0
    v_mov_b32 v186, 0
    v_mov_b32 v187, 0
    v_mov_b32 v188, 0
    v_mov_b32 v189, 0
    v_mov_b32 v190, 0
    v_mov_b32 v191, 0
    v_mov_b32 v192, 0
    v_mov_b32 v193, 0
    v_mov_b32 v194, 0
    v_mov_b32 v195, 0
    v_mov_b32 v196, 0
    v_mov_b32 v197, 0
    v_mov_b32 v198, 0
    v_mov_b32 v199, 0
    v_mov_b32 v200, 0
    v_mov_b32 v201, 0
    v_mov_b32 v202, 0
    v_mov_b32 v203, 0
    v_mov_b32 v204, 0
    v_mov_b32 v205, 0
    v_mov_b32 v206, 0
    v_mov_b32 v207, 0
    v_mov_b32 v208, 0
    v_mov_b32 v209, 0
    v_mov_b32 v210, 0
    v_mov_b32 v211, 0
    v_mov_b32 v212, 0
    v_mov_b32 v213, 0
    v_mov_b32 v214, 0
    v_mov_b32 v215, 0
    v_mov_b32 v216, 0
    v_mov_b32 v217, 0
    v_mov_b32 v218, 0
    v_mov_b32 v219, 0
    v_mov_b32 v220, 0
    v_mov_b32 v221, 0
    v_mov_b32 v222, 0
    v_mov_b32 v223, 0
    v_mov_b32 v224, 0
    v_mov_b32 v225, 0
    v_mov_b32 v226, 0
    v_mov_b32 v227, 0
    v_mov_b32 v228, 0
    v_mov_b32 v229, 0
    v_mov_b32 v230, 0
    v_mov_b32 v231, 0
    v_mov_b32 v232, 0
    v_mov_b32 v233, 0
    v_mov_b32 v234, 0
    v_mov_b32 v235, 0
    v_mov_b32 v236, 0
    v_mov_b32 v237, 0
    v_mov_b32 v238, 0
    v_mov_b32 v239, 0
    v_mov_b32 v240, 0
    v_mov_b32 v241, 0
    v_mov_b32 v242, 0
    v_mov_b32 v243, 0
    v_mov_b32 v244, 0
    v_mov_b32 v245, 0
    v_mov_b32 v246, 0
    v_mov_b32 v247, 0
    v_mov_b32 v248, 0
    v_mov_b32 v249, 0
    v_mov_b32 v250, 0
    v_mov_b32 v251, 0
    v_mov_b32 v252, 0
    v_mov_b32 v253, 0
    v_mov_b32 v254, 0
    v_mov_b32 v255, 0
    s_waitcnt vmcnt(10)
    v_lshlrev_b32 v36, 16, v40
    v_and_b32 v37, 0xffff0000, v40
    v_fma_f32 v36, v36, v27, v26
    v_fma_f32 v37, v37, v27, v26
    v_cvt_pk_bf16_f32 v40, v36, v37
    v_lshlrev_b32 v36, 16, v41
    v_and_b32 v37, 0xffff0000, v41
    v_fma_f32 v36, v36, v27, v26
    v_fma_f32 v37, v37, v27, v26
    v_cvt_pk_bf16_f32 v41, v36, v37
    v_lshlrev_b32 v36, 16, v42
    v_and_b32 v37, 0xffff0000, v42
    v_fma_f32 v36, v36, v27, v26
    v_fma_f32 v37, v37, v27, v26
    v_cvt_pk_bf16_f32 v42, v36, v37
    v_lshlrev_b32 v36, 16, v43
    v_and_b32 v37, 0xffff0000, v43
    v_fma_f32 v36, v36, v27, v26
    v_fma_f32 v37, v37, v27, v26
    v_cvt_pk_bf16_f32 v43, v36, v37
    ds_write_b128 v14, v[40:43] offset:0
    v_lshlrev_b32 v36, 16, v44
    v_and_b32 v37, 0xffff0000, v44
    v_fma_f32 v36, v36, v29, v28
    v_fma_f32 v37, v37, v29, v28
    v_cvt_pk_bf16_f32 v44, v36, v37
    v_lshlrev_b32 v36, 16, v45
    v_and_b32 v37, 0xffff0000, v45
    v_fma_f32 v36, v36, v29, v28
    v_fma_f32 v37, v37, v29, v28
    v_cvt_pk_bf16_f32 v45, v36, v37
    v_lshlrev_b32 v36, 16, v46
    v_and_b32 v37, 0xffff0000, v46
    v_fma_f32 v36, v36, v29, v28
    v_fma_f32 v37, v37, v29, v28
    v_cvt_pk_bf16_f32 v46, v36, v37
    v_lshlrev_b32 v36, 16, v47
    v_and_b32 v37, 0xffff0000, v47
    v_fma_f32 v36, v36, v29, v28
    v_fma_f32 v37, v37, v29, v28
    v_cvt_pk_bf16_f32 v47, v36, v37
    ds_write_b128 v14, v[44:47] offset:4608
    v_lshlrev_b32 v36, 16, v48
    v_and_b32 v37, 0xffff0000, v48
    v_fma_f32 v36, v36, v31, v30
    v_fma_f32 v37, v37, v31, v30
    v_cvt_pk_bf16_f32 v48, v36, v37
    v_lshlrev_b32 v36, 16, v49
    v_and_b32 v37, 0xffff0000, v49
    v_fma_f32 v36, v36, v31, v30
    v_fma_f32 v37, v37, v31, v30
    v_cvt_pk_bf16_f32 v49, v36, v37
    v_lshlrev_b32 v36, 16, v50
    v_and_b32 v37, 0xffff0000, v50
    v_fma_f32 v36, v36, v31, v30
    v_fma_f32 v37, v37, v31, v30
    v_cvt_pk_bf16_f32 v50, v36, v37
    v_lshlrev_b32 v36, 16, v51
    v_and_b32 v37, 0xffff0000, v51
    v_fma_f32 v36, v36, v31, v30
    v_fma_f32 v37, v37, v31, v30
    v_cvt_pk_bf16_f32 v51, v36, v37
    ds_write_b128 v14, v[48:51] offset:9216
    v_lshlrev_b32 v36, 16, v52
    v_and_b32 v37, 0xffff0000, v52
    v_fma_f32 v36, v36, v33, v32
    v_fma_f32 v37, v37, v33, v32
    v_cvt_pk_bf16_f32 v52, v36, v37
    v_lshlrev_b32 v36, 16, v53
    v_and_b32 v37, 0xffff0000, v53
    v_fma_f32 v36, v36, v33, v32
    v_fma_f32 v37, v37, v33, v32
    v_cvt_pk_bf16_f32 v53, v36, v37
    v_lshlrev_b32 v36, 16, v54
    v_and_b32 v37, 0xffff0000, v54
    v_fma_f32 v36, v36, v33, v32
    v_fma_f32 v37, v37, v33, v32
    v_cvt_pk_bf16_f32 v54, v36, v37
    v_lshlrev_b32 v36, 16, v55
    v_and_b32 v37, 0xffff0000, v55
    v_fma_f32 v36, v36, v33, v32
    v_fma_f32 v37, v37, v33, v32
    v_cvt_pk_bf16_f32 v55, v36, v37
    ds_write_b128 v14, v[52:55] offset:13824
    ds_write_b128 v15, v[56:59] offset:0
    ds_write_b128 v15, v[60:63] offset:128
    ds_write_b128 v15, v[64:67] offset:256
    ds_write_b128 v15, v[68:71] offset:14336
    ds_write_b128 v15, v[72:75] offset:14464
    ds_write_b128 v15, v[76:79] offset:14592
    s_waitcnt lgkmcnt(0)
    s_barrier
    ds_read_b128 v[120:123], v22 offset:0
    ds_read_b128 v[124:127], v22 offset:4608
    ds_read_b64_tr_b16 v[136:137], v23 offset:0
    ds_read_b64_tr_b16 v[138:139], v23 offset:1792
    ds_read_b64_tr_b16 v[140:141], v23 offset:128
    ds_read_b64_tr_b16 v[142:143], v23 offset:1920
    ds_read_b64_tr_b16 v[144:145], v23 offset:256
    ds_read_b64_tr_b16 v[146:147], v23 offset:2048
    s_mov_b32 s20, 0
L_qkv0_loop:
    s_waitcnt lgkmcnt(0)
    v_mfma_f32_32x32x16_bf16 v[160:175], v[136:139], v[120:123], v[160:175]
    ds_read_b128 v[128:131], v22 offset:32
    ds_read_b128 v[132:135], v22 offset:4640
    ds_read_b64_tr_b16 v[148:149], v23 offset:7168
    ds_read_b64_tr_b16 v[150:151], v23 offset:8960
    ds_read_b64_tr_b16 v[152:153], v23 offset:7296
    ds_read_b64_tr_b16 v[154:155], v23 offset:9088
    ds_read_b64_tr_b16 v[156:157], v23 offset:7424
    ds_read_b64_tr_b16 v[158:159], v23 offset:9216
    v_mfma_f32_32x32x16_bf16 v[176:191], v[120:123], v[140:143], v[176:191]
    global_load_dwordx4 v[40:43], v4, s[4:5]
    global_load_dwordx4 v[44:47], v5, s[4:5]
    global_load_dwordx4 v[48:51], v6, s[4:5]
    global_load_dwordx4 v[52:55], v7, s[4:5]
    global_load_dwordx4 v[56:59], v8, s[6:7]
    global_load_dwordx4 v[60:63], v9, s[6:7]
    global_load_dwordx4 v[64:67], v10, s[6:7]
    global_load_dwordx4 v[68:71], v11, s[6:7]
    v_mfma_f32_32x32x16_bf16 v[192:207], v[120:123], v[144:147], v[192:207]
    global_load_dwordx4 v[72:75], v12, s[6:7]
    global_load_dwordx4 v[76:79], v13, s[6:7]
    s_add_u32 s4, s4, 128
    s_addc_u32 s5, s5, 0
    s_add_u32 s6, s6, 393216
    s_addc_u32 s7, s7, 0
    s_waitcnt vmcnt(10)
    v_mfma_f32_32x32x16_bf16 v[208:223], v[136:139], v[124:127], v[208:223]
    v_lshlrev_b32 v36, 16, v80
    v_and_b32 v37, 0xffff0000, v80
    v_fma_f32 v36, v36, v27, v26
    v_fma_f32 v37, v37, v27, v26
    v_cvt_pk_bf16_f32 v80, v36, v37
    v_lshlrev_b32 v36, 16, v81
    v_and_b32 v37, 0xffff0000, v81
    v_mfma_f32_32x32x16_bf16 v[224:239], v[124:127], v[140:143], v[224:239]
    v_fma_f32 v36, v36, v27, v26
    v_fma_f32 v37, v37, v27, v26
    v_cvt_pk_bf16_f32 v81, v36, v37
    v_lshlrev_b32 v36, 16, v82
    v_and_b32 v37, 0xffff0000, v82
    v_fma_f32 v36, v36, v27, v26
    v_fma_f32 v37, v37, v27, v26
    v_mfma_f32_32x32x16_bf16 v[240:255], v[124:127], v[144:147], v[240:255]
    v_cvt_pk_bf16_f32 v82, v36, v37
    v_lshlrev_b32 v36, 16, v83
    v_and_b32 v37, 0xffff0000, v83
    v_fma_f32 v36, v36, v27, v26
    v_fma_f32 v37, v37, v27, v26
    v_cvt_pk_bf16_f32 v83, v36, v37
    ds_write_b128 v14, v[80:83] offset:47104
    s_waitcnt lgkmcnt(1)
    v_mfma_f32_32x32x16_bf16 v[160:175], v[148:151], v[128:131], v[160:175]
    ds_read_b128 v[120:123], v22 offset:64
    ds_read_b128 v[124:127], v22 offset:4672
    ds_read_b64_tr_b16 v[136:137], v23 offset:14336
    ds_read_b64_tr_b16 v[138:139], v23 offset:16128
    ds_read_b64_tr_b16 v[140:141], v23 offset:14464
    ds_read_b64_tr_b16 v[142:143], v23 offset:16256
    ds_read_b64_tr_b16 v[144:145], v23 offset:14592
    ds_read_b64_tr_b16 v[146:147], v23 offset:16384
    v_lshlrev_b32 v36, 16, v84
    v_mfma_f32_32x32x16_bf16 v[176:191], v[128:131], v[152:155], v[176:191]
    v_and_b32 v37, 0xffff0000, v84
    v_fma_f32 v36, v36, v29, v28
    v_fma_f32 v37, v37, v29, v28
    v_cvt_pk_bf16_f32 v84, v36, v37
    v_lshlrev_b32 v36, 16, v85
    v_and_b32 v37, 0xffff0000, v85
    v_fma_f32 v36, v36, v29, v28
    v_fma_f32 v37, v37, v29, v28
    v_cvt_pk_bf16_f32 v85, v36, v37
    v_mfma_f32_32x32x16_bf16 v[192:207], v[128:131], v[156:159], v[192:207]
    v_lshlrev_b32 v36, 16, v86
    v_and_b32 v37, 0xffff0000, v86
    v_fma_f32 v36, v36, v29, v28
    v_fma_f32 v37, v37, v29, v28
    v_cvt_pk_bf16_f32 v86, v36, v37
    v_lshlrev_b32 v36, 16, v87
    v_and_b32 v37, 0xffff0000, v87
    v_fma_f32 v36, v36, v29, v28
    v_mfma_f32_32x32x16_bf16 v[208:223], v[148:151], v[132:135], v[208:223]
    v_fma_f32 v37, v37, v29, v28
    v_cvt_pk_bf16_f32 v87, v36, v37
    ds_write_b128 v14, v[84:87] offset:51712
    v_lshlrev_b32 v36, 16, v88
    v_and_b32 v37, 0xffff0000, v88
    v_fma_f32 v36, v36, v31, v30
    v_fma_f32 v37, v37, v31, v30
    v_cvt_pk_bf16_f32 v88, v36, v37
    v_mfma_f32_32x32x16_bf16 v[224:239], v[132:135], v[152:155], v[224:239]
    v_lshlrev_b32 v36, 16, v89
    v_and_b32 v37, 0xffff0000, v89
    v_fma_f32 v36, v36, v31, v30
    v_fma_f32 v37, v37, v31, v30
    v_cvt_pk_bf16_f32 v89, v36, v37
    v_lshlrev_b32 v36, 16, v90
    v_and_b32 v37, 0xffff0000, v90
    v_fma_f32 v36, v36, v31, v30
    v_mfma_f32_32x32x16_bf16 v[240:255], v[132:135], v[156:159], v[240:255]
    v_fma_f32 v37, v37, v31, v30
    v_cvt_pk_bf16_f32 v90, v36, v37
    v_lshlrev_b32 v36, 16, v91
    v_and_b32 v37, 0xffff0000, v91
    v_fma_f32 v36, v36, v31, v30
    v_fma_f32 v37, v37, v31, v30
    v_cvt_pk_bf16_f32 v91, v36, v37
    ds_write_b128 v14, v[88:91] offset:56320
    s_waitcnt lgkmcnt(2)
    v_mfma_f32_32x32x16_bf16 v[160:175], v[136:139], v[120:123], v[160:175]
    ds_read_b128 v[128:131], v22 offset:96
    ds_read_b128 v[132:135], v22 offset:4704
    ds_read_b64_tr_b16 v[148:149], v23 offset:21504
    ds_read_b64_tr_b16 v[150:151], v23 offset:23296
    ds_read_b64_tr_b16 v[152:153], v23 offset:21632
    ds_read_b64_tr_b16 v[154:155], v23 offset:23424
    v_mfma_f32_32x32x16_bf16 v[176:191], v[120:123], v[140:143], v[176:191]
    ds_read_b64_tr_b16 v[156:157], v23 offset:21760
    ds_read_b64_tr_b16 v[158:159], v23 offset:23552
    v_lshlrev_b32 v36, 16, v92
    v_and_b32 v37, 0xffff0000, v92
    v_fma_f32 v36, v36, v33, v32
    v_fma_f32 v37, v37, v33, v32
    v_mfma_f32_32x32x16_bf16 v[192:207], v[120:123], v[144:147], v[192:207]
    v_cvt_pk_bf16_f32 v92, v36, v37
    v_lshlrev_b32 v36, 16, v93
    v_and_b32 v37, 0xffff0000, v93
    v_fma_f32 v36, v36, v33, v32
    v_fma_f32 v37, v37, v33, v32
    v_cvt_pk_bf16_f32 v93, v36, v37
    v_mfma_f32_32x32x16_bf16 v[208:223], v[136:139], v[124:127], v[208:223]
    v_lshlrev_b32 v36, 16, v94
    v_and_b32 v37, 0xffff0000, v94
    v_fma_f32 v36, v36, v33, v32
    v_fma_f32 v37, v37, v33, v32
    v_cvt_pk_bf16_f32 v94, v36, v37
    v_lshlrev_b32 v36, 16, v95
    v_mfma_f32_32x32x16_bf16 v[224:239], v[124:127], v[140:143], v[224:239]
    v_and_b32 v37, 0xffff0000, v95
    v_fma_f32 v36, v36, v33, v32
    v_fma_f32 v37, v37, v33, v32
    v_cvt_pk_bf16_f32 v95, v36, v37
    ds_write_b128 v14, v[92:95] offset:60928
    ds_write_b128 v15, v[96:99] offset:47104
    v_mfma_f32_32x32x16_bf16 v[240:255], v[124:127], v[144:147], v[240:255]
    ds_write_b128 v15, v[100:103] offset:47232
    ds_write_b128 v15, v[104:107] offset:47360
    ds_write_b128 v15, v[108:111] offset:61440
    ds_write_b128 v15, v[112:115] offset:61568
    ds_write_b128 v15, v[116:119] offset:61696
    s_waitcnt lgkmcnt(0)
    s_barrier
    s_waitcnt lgkmcnt(7)
    v_mfma_f32_32x32x16_bf16 v[160:175], v[148:151], v[128:131], v[160:175]
    ds_read_b128 v[120:123], v24 offset:0
    ds_read_b128 v[124:127], v24 offset:4608
    v_mfma_f32_32x32x16_bf16 v[176:191], v[128:131], v[152:155], v[176:191]
    ds_read_b64_tr_b16 v[136:137], v25 offset:0
    ds_read_b64_tr_b16 v[138:139], v25 offset:1792
    v_mfma_f32_32x32x16_bf16 v[192:207], v[128:131], v[156:159], v[192:207]
    ds_read_b64_tr_b16 v[140:141], v25 offset:128
    v_mfma_f32_32x32x16_bf16 v[208:223], v[148:151], v[132:135], v[208:223]
    ds_read_b64_tr_b16 v[142:143], v25 offset:1920
    v_mfma_f32_32x32x16_bf16 v[224:239], v[132:135], v[152:155], v[224:239]
    ds_read_b64_tr_b16 v[144:145], v25 offset:256
    v_mfma_f32_32x32x16_bf16 v[240:255], v[132:135], v[156:159], v[240:255]
    ds_read_b64_tr_b16 v[146:147], v25 offset:2048
    s_waitcnt lgkmcnt(0)
    v_mfma_f32_32x32x16_bf16 v[160:175], v[136:139], v[120:123], v[160:175]
    ds_read_b128 v[128:131], v24 offset:32
    ds_read_b128 v[132:135], v24 offset:4640
    ds_read_b64_tr_b16 v[148:149], v25 offset:7168
    ds_read_b64_tr_b16 v[150:151], v25 offset:8960
    ds_read_b64_tr_b16 v[152:153], v25 offset:7296
    ds_read_b64_tr_b16 v[154:155], v25 offset:9088
    ds_read_b64_tr_b16 v[156:157], v25 offset:7424
    ds_read_b64_tr_b16 v[158:159], v25 offset:9216
    v_mfma_f32_32x32x16_bf16 v[176:191], v[120:123], v[140:143], v[176:191]
    global_load_dwordx4 v[80:83], v4, s[4:5]
    global_load_dwordx4 v[84:87], v5, s[4:5]
    global_load_dwordx4 v[88:91], v6, s[4:5]
    global_load_dwordx4 v[92:95], v7, s[4:5]
    global_load_dwordx4 v[96:99], v8, s[6:7]
    global_load_dwordx4 v[100:103], v9, s[6:7]
    global_load_dwordx4 v[104:107], v10, s[6:7]
    global_load_dwordx4 v[108:111], v11, s[6:7]
    v_mfma_f32_32x32x16_bf16 v[192:207], v[120:123], v[144:147], v[192:207]
    global_load_dwordx4 v[112:115], v12, s[6:7]
    global_load_dwordx4 v[116:119], v13, s[6:7]
    s_add_u32 s4, s4, 128
    s_addc_u32 s5, s5, 0
    s_add_u32 s6, s6, 393216
    s_addc_u32 s7, s7, 0
    s_waitcnt vmcnt(10)
    v_mfma_f32_32x32x16_bf16 v[208:223], v[136:139], v[124:127], v[208:223]
    v_lshlrev_b32 v36, 16, v40
    v_and_b32 v37, 0xffff0000, v40
    v_fma_f32 v36, v36, v27, v26
    v_fma_f32 v37, v37, v27, v26
    v_cvt_pk_bf16_f32 v40, v36, v37
    v_lshlrev_b32 v36, 16, v41
    v_and_b32 v37, 0xffff0000, v41
    v_mfma_f32_32x32x16_bf16 v[224:239], v[124:127], v[140:143], v[224:239]
    v_fma_f32 v36, v36, v27, v26
    v_fma_f32 v37, v37, v27, v26
    v_cvt_pk_bf16_f32 v41, v36, v37
    v_lshlrev_b32 v36, 16, v42
    v_and_b32 v37, 0xffff0000, v42
    v_fma_f32 v36, v36, v27, v26
    v_fma_f32 v37, v37, v27, v26
    v_mfma_f32_32x32x16_bf16 v[240:255], v[124:127], v[144:147], v[240:255]
    v_cvt_pk_bf16_f32 v42, v36, v37
    v_lshlrev_b32 v36, 16, v43
    v_and_b32 v37, 0xffff0000, v43
    v_fma_f32 v36, v36, v27, v26
    v_fma_f32 v37, v37, v27, v26
    v_cvt_pk_bf16_f32 v43, v36, v37
    ds_write_b128 v14, v[40:43] offset:0
    s_waitcnt lgkmcnt(1)
    v_mfma_f32_32x32x16_bf16 v[160:175], v[148:151], v[128:131], v[160:175]
    ds_read_b128 v[120:123], v24 offset:64
    ds_read_b128 v[124:127], v24 offset:4672
    ds_read_b64_tr_b16 v[136:137], v25 offset:14336
    ds_read_b64_tr_b16 v[138:139], v25 offset:16128
    ds_read_b64_tr_b16 v[140:141], v25 offset:14464
    ds_read_b64_tr_b16 v[142:143], v25 offset:16256
    ds_read_b64_tr_b16 v[144:145], v25 offset:14592
    ds_read_b64_tr_b16 v[146:147], v25 offset:16384
    v_lshlrev_b32 v36, 16, v44
    v_mfma_f32_32x32x16_bf16 v[176:191], v[128:131], v[152:155], v[176:191]
    v_and_b32 v37, 0xffff0000, v44
    v_fma_f32 v36, v36, v29, v28
    v_fma_f32 v37, v37, v29, v28
    v_cvt_pk_bf16_f32 v44, v36, v37
    v_lshlrev_b32 v36, 16, v45
    v_and_b32 v37, 0xffff0000, v45
    v_fma_f32 v36, v36, v29, v28
    v_fma_f32 v37, v37, v29, v28
    v_cvt_pk_bf16_f32 v45, v36, v37
    v_mfma_f32_32x32x16_bf16 v[192:207], v[128:131], v[156:159], v[192:207]
    v_lshlrev_b32 v36, 16, v46
    v_and_b32 v37, 0xffff0000, v46
    v_fma_f32 v36, v36, v29, v28
    v_fma_f32 v37, v37, v29, v28
    v_cvt_pk_bf16_f32 v46, v36, v37
    v_lshlrev_b32 v36, 16, v47
    v_and_b32 v37, 0xffff0000, v47
    v_fma_f32 v36, v36, v29, v28
    v_mfma_f32_32x32x16_bf16 v[208:223], v[148:151], v[132:135], v[208:223]
    v_fma_f32 v37, v37, v29, v28
    v_cvt_pk_bf16_f32 v47, v36, v37
    ds_write_b128 v14, v[44:47] offset:4608
    v_lshlrev_b32 v36, 16, v48
    v_and_b32 v37, 0xffff0000, v48
    v_fma_f32 v36, v36, v31, v30
    v_fma_f32 v37, v37, v31, v30
    v_cvt_pk_bf16_f32 v48, v36, v37
    v_mfma_f32_32x32x16_bf16 v[224:239], v[132:135], v[152:155], v[224:239]
    v_lshlrev_b32 v36, 16, v49
    v_and_b32 v37, 0xffff0000, v49
    v_fma_f32 v36, v36, v31, v30
    v_fma_f32 v37, v37, v31, v30
    v_cvt_pk_bf16_f32 v49, v36, v37
    v_lshlrev_b32 v36, 16, v50
    v_and_b32 v37, 0xffff0000, v50
    v_fma_f32 v36, v36, v31, v30
    v_mfma_f32_32x32x16_bf16 v[240:255], v[132:135], v[156:159], v[240:255]
    v_fma_f32 v37, v37, v31, v30
    v_cvt_pk_bf16_f32 v50, v36, v37
    v_lshlrev_b32 v36, 16, v51
    v_and_b32 v37, 0xffff0000, v51
    v_fma_f32 v36, v36, v31, v30
    v_fma_f32 v37, v37, v31, v30
    v_cvt_pk_bf16_f32 v51, v36, v37
    ds_write_b128 v14, v[48:51] offset:9216
    s_waitcnt lgkmcnt(2)
    v_mfma_f32_32x32x16_bf16 v[160:175], v[136:139], v[120:123], v[160:175]
    ds_read_b128 v[128:131], v24 offset:96
    ds_read_b128 v[132:135], v24 offset:4704
    ds_read_b64_tr_b16 v[148:149], v25 offset:21504
    ds_read_b64_tr_b16 v[150:151], v25 offset:23296
    ds_read_b64_tr_b16 v[152:153], v25 offset:21632
    ds_read_b64_tr_b16 v[154:155], v25 offset:23424
    v_mfma_f32_32x32x16_bf16 v[176:191], v[120:123], v[140:143], v[176:191]
    ds_read_b64_tr_b16 v[156:157], v25 offset:21760
    ds_read_b64_tr_b16 v[158:159], v25 offset:23552
    v_lshlrev_b32 v36, 16, v52
    v_and_b32 v37, 0xffff0000, v52
    v_fma_f32 v36, v36, v33, v32
    v_fma_f32 v37, v37, v33, v32
    v_mfma_f32_32x32x16_bf16 v[192:207], v[120:123], v[144:147], v[192:207]
    v_cvt_pk_bf16_f32 v52, v36, v37
    v_lshlrev_b32 v36, 16, v53
    v_and_b32 v37, 0xffff0000, v53
    v_fma_f32 v36, v36, v33, v32
    v_fma_f32 v37, v37, v33, v32
    v_cvt_pk_bf16_f32 v53, v36, v37
    v_mfma_f32_32x32x16_bf16 v[208:223], v[136:139], v[124:127], v[208:223]
    v_lshlrev_b32 v36, 16, v54
    v_and_b32 v37, 0xffff0000, v54
    v_fma_f32 v36, v36, v33, v32
    v_fma_f32 v37, v37, v33, v32
    v_cvt_pk_bf16_f32 v54, v36, v37
    v_lshlrev_b32 v36, 16, v55
    v_mfma_f32_32x32x16_bf16 v[224:239], v[124:127], v[140:143], v[224:239]
    v_and_b32 v37, 0xffff0000, v55
    v_fma_f32 v36, v36, v33, v32
    v_fma_f32 v37, v37, v33, v32
    v_cvt_pk_bf16_f32 v55, v36, v37
    ds_write_b128 v14, v[52:55] offset:13824
    ds_write_b128 v15, v[56:59] offset:0
    v_mfma_f32_32x32x16_bf16 v[240:255], v[124:127], v[144:147], v[240:255]
    ds_write_b128 v15, v[60:63] offset:128
    ds_write_b128 v15, v[64:67] offset:256
    ds_write_b128 v15, v[68:71] offset:14336
    ds_write_b128 v15, v[72:75] offset:14464
    ds_write_b128 v15, v[76:79] offset:14592
    s_waitcnt lgkmcnt(0)
    s_barrier
    s_waitcnt lgkmcnt(7)
    v_mfma_f32_32x32x16_bf16 v[160:175], v[148:151], v[128:131], v[160:175]
    ds_read_b128 v[120:123], v22 offset:0
    ds_read_b128 v[124:127], v22 offset:4608
    v_mfma_f32_32x32x16_bf16 v[176:191], v[128:131], v[152:155], v[176:191]
    ds_read_b64_tr_b16 v[136:137], v23 offset:0
    ds_read_b64_tr_b16 v[138:139], v23 offset:1792
    v_mfma_f32_32x32x16_bf16 v[192:207], v[128:131], v[156:159], v[192:207]
    ds_read_b64_tr_b16 v[140:141], v23 offset:128
    v_mfma_f32_32x32x16_bf16 v[208:223], v[148:151], v[132:135], v[208:223]
    ds_read_b64_tr_b16 v[142:143], v23 offset:1920
    v_mfma_f32_32x32x16_bf16 v[224:239], v[132:135], v[152:155], v[224:239]
    ds_read_b64_tr_b16 v[144:145], v23 offset:256
    v_mfma_f32_32x32x16_bf16 v[240:255], v[132:135], v[156:159], v[240:255]
    ds_read_b64_tr_b16 v[146:147], v23 offset:2048
    s_add_u32 s20, s20, 2
    s_cmp_lt_u32 s20, 14
    s_cbranch_scc1 L_qkv0_loop
    s_waitcnt lgkmcnt(0)
    v_mfma_f32_32x32x16_bf16 v[160:175], v[136:139], v[120:123], v[160:175]
    ds_read_b128 v[128:131], v22 offset:32
    ds_read_b128 v[132:135], v22 offset:4640
    ds_read_b64_tr_b16 v[148:149], v23 offset:7168
    ds_read_b64_tr_b16 v[150:151], v23 offset:8960
    ds_read_b64_tr_b16 v[152:153], v23 offset:7296
    v_mfma_f32_32x32x16_bf16 v[176:191], v[120:123], v[140:143], v[176:191]
    ds_read_b64_tr_b16 v[154:155], v23 offset:9088
    ds_read_b64_tr_b16 v[156:157], v23 offset:7424
    ds_read_b64_tr_b16 v[158:159], v23 offset:9216
    s_waitcnt vmcnt(0)
    v_lshlrev_b32 v36, 16, v80
    v_mfma_f32_32x32x16_bf16 v[192:207], v[120:123], v[144:147], v[192:207]
    v_and_b32 v37, 0xffff0000, v80
    v_fma_f32 v36, v36, v27, v26
    v_fma_f32 v37, v37, v27, v26
    v_cvt_pk_bf16_f32 v80, v36, v37
    v_lshlrev_b32 v36, 16, v81
    v_mfma_f32_32x32x16_bf16 v[208:223], v[136:139], v[124:127], v[208:223]
    v_and_b32 v37, 0xffff0000, v81
    v_fma_f32 v36, v36, v27, v26
    v_fma_f32 v37, v37, v27, v26
    v_cvt_pk_bf16_f32 v81, v36, v37
    v_lshlrev_b32 v36, 16, v82
    v_mfma_f32_32x32x16_bf16 v[224:239], v[124:127], v[140:143], v[224:239]
    v_and_b32 v37, 0xffff0000, v82
    v_fma_f32 v36, v36, v27, v26
    v_fma_f32 v37, v37, v27, v26
    v_cvt_pk_bf16_f32 v82, v36, v37
    v_lshlrev_b32 v36, 16, v83
    v_mfma_f32_32x32x16_bf16 v[240:255], v[124:127], v[144:147], v[240:255]
    v_and_b32 v37, 0xffff0000, v83
    v_fma_f32 v36, v36, v27, v26
    v_fma_f32 v37, v37, v27, v26
    v_cvt_pk_bf16_f32 v83, v36, v37
    ds_write_b128 v14, v[80:83] offset:47104
    s_waitcnt lgkmcnt(1)
    v_mfma_f32_32x32x16_bf16 v[160:175], v[148:151], v[128:131], v[160:175]
    ds_read_b128 v[120:123], v22 offset:64
    ds_read_b128 v[124:127], v22 offset:4672
    ds_read_b64_tr_b16 v[136:137], v23 offset:14336
    ds_read_b64_tr_b16 v[138:139], v23 offset:16128
    ds_read_b64_tr_b16 v[140:141], v23 offset:14464
    ds_read_b64_tr_b16 v[142:143], v23 offset:16256
    ds_read_b64_tr_b16 v[144:145], v23 offset:14592
    ds_read_b64_tr_b16 v[146:147], v23 offset:16384
    v_lshlrev_b32 v36, 16, v84
    v_mfma_f32_32x32x16_bf16 v[176:191], v[128:131], v[152:155], v[176:191]
    v_and_b32 v37, 0xffff0000, v84
    v_fma_f32 v36, v36, v29, v28
    v_fma_f32 v37, v37, v29, v28
    v_cvt_pk_bf16_f32 v84, v36, v37
    v_lshlrev_b32 v36, 16, v85
    v_and_b32 v37, 0xffff0000, v85
    v_fma_f32 v36, v36, v29, v28
    v_fma_f32 v37, v37, v29, v28
    v_cvt_pk_bf16_f32 v85, v36, v37
    v_mfma_f32_32x32x16_bf16 v[192:207], v[128:131], v[156:159], v[192:207]
    v_lshlrev_b32 v36, 16, v86
    v_and_b32 v37, 0xffff0000, v86
    v_fma_f32 v36, v36, v29, v28
    v_fma_f32 v37, v37, v29, v28
    v_cvt_pk_bf16_f32 v86, v36, v37
    v_lshlrev_b32 v36, 16, v87
    v_and_b32 v37, 0xffff0000, v87
    v_fma_f32 v36, v36, v29, v28
    v_mfma_f32_32x32x16_bf16 v[208:223], v[148:151], v[132:135], v[208:223]
    v_fma_f32 v37, v37, v29, v28
    v_cvt_pk_bf16_f32 v87, v36, v37
    ds_write_b128 v14, v[84:87] offset:51712
    v_lshlrev_b32 v36, 16, v88
    v_and_b32 v37, 0xffff0000, v88
    v_fma_f32 v36, v36, v31, v30
    v_fma_f32 v37, v37, v31, v30
    v_cvt_pk_bf16_f32 v88, v36, v37
    v_mfma_f32_32x32x16_bf16 v[224:239], v[132:135], v[152:155], v[224:239]
    v_lshlrev_b32 v36, 16, v89
    v_and_b32 v37, 0xffff0000, v89
    v_fma_f32 v36, v36, v31, v30
    v_fma_f32 v37, v37, v31, v30
    v_cvt_pk_bf16_f32 v89, v36, v37
    v_lshlrev_b32 v36, 16, v90
    v_and_b32 v37, 0xffff0000, v90
    v_fma_f32 v36, v36, v31, v30
    v_mfma_f32_32x32x16_bf16 v[240:255], v[132:135], v[156:159], v[240:255]
    v_fma_f32 v37, v37, v31, v30
    v_cvt_pk_bf16_f32 v90, v36, v37
    v_lshlrev_b32 v36, 16, v91
    v_and_b32 v37, 0xffff0000, v91
    v_fma_f32 v36, v36, v31, v30
    v_fma_f32 v37, v37, v31, v30
    v_cvt_pk_bf16_f32 v91, v36, v37
    ds_write_b128 v14, v[88:91] offset:56320
    s_waitcnt lgkmcnt(2)
    v_mfma_f32_32x32x16_bf16 v[160:175], v[136:139], v[120:123], v[160:175]
    ds_read_b128 v[128:131], v22 offset:96
    ds_read_b128 v[132:135], v22 offset:4704
    ds_read_b64_tr_b16 v[148:149], v23 offset:21504
    ds_read_b64_tr_b16 v[150:151], v23 offset:23296
    ds_read_b64_tr_b16 v[152:153], v23 offset:21632
    ds_read_b64_tr_b16 v[154:155], v23 offset:23424
    v_mfma_f32_32x32x16_bf16 v[176:191], v[120:123], v[140:143], v[176:191]
    ds_read_b64_tr_b16 v[156:157], v23 offset:21760
    ds_read_b64_tr_b16 v[158:159], v23 offset:23552
    v_lshlrev_b32 v36, 16, v92
    v_and_b32 v37, 0xffff0000, v92
    v_fma_f32 v36, v36, v33, v32
    v_fma_f32 v37, v37, v33, v32
    v_mfma_f32_32x32x16_bf16 v[192:207], v[120:123], v[144:147], v[192:207]
    v_cvt_pk_bf16_f32 v92, v36, v37
    v_lshlrev_b32 v36, 16, v93
    v_and_b32 v37, 0xffff0000, v93
    v_fma_f32 v36, v36, v33, v32
    v_fma_f32 v37, v37, v33, v32
    v_cvt_pk_bf16_f32 v93, v36, v37
    v_mfma_f32_32x32x16_bf16 v[208:223], v[136:139], v[124:127], v[208:223]
    v_lshlrev_b32 v36, 16, v94
    v_and_b32 v37, 0xffff0000, v94
    v_fma_f32 v36, v36, v33, v32
    v_fma_f32 v37, v37, v33, v32
    v_cvt_pk_bf16_f32 v94, v36, v37
    v_lshlrev_b32 v36, 16, v95
    v_mfma_f32_32x32x16_bf16 v[224:239], v[124:127], v[140:143], v[224:239]
    v_and_b32 v37, 0xffff0000, v95
    v_fma_f32 v36, v36, v33, v32
    v_fma_f32 v37, v37, v33, v32
    v_cvt_pk_bf16_f32 v95, v36, v37
    ds_write_b128 v14, v[92:95] offset:60928
    ds_write_b128 v15, v[96:99] offset:47104
    v_mfma_f32_32x32x16_bf16 v[240:255], v[124:127], v[144:147], v[240:255]
    ds_write_b128 v15, v[100:103] offset:47232
    ds_write_b128 v15, v[104:107] offset:47360
    ds_write_b128 v15, v[108:111] offset:61440
    ds_write_b128 v15, v[112:115] offset:61568
    ds_write_b128 v15, v[116:119] offset:61696
    s_waitcnt lgkmcnt(0)
    s_barrier
    s_waitcnt lgkmcnt(7)
    v_mfma_f32_32x32x16_bf16 v[160:175], v[148:151], v[128:131], v[160:175]
    ds_read_b128 v[120:123], v24 offset:0
    ds_read_b128 v[124:127], v24 offset:4608
    v_mfma_f32_32x32x16_bf16 v[176:191], v[128:131], v[152:155], v[176:191]
    ds_read_b64_tr_b16 v[136:137], v25 offset:0
    ds_read_b64_tr_b16 v[138:139], v25 offset:1792
    v_mfma_f32_32x32x16_bf16 v[192:207], v[128:131], v[156:159], v[192:207]
    ds_read_b64_tr_b16 v[140:141], v25 offset:128
    v_mfma_f32_32x32x16_bf16 v[208:223], v[148:151], v[132:135], v[208:223]
    ds_read_b64_tr_b16 v[142:143], v25 offset:1920
    v_mfma_f32_32x32x16_bf16 v[224:239], v[132:135], v[152:155], v[224:239]
    ds_read_b64_tr_b16 v[144:145], v25 offset:256
    v_mfma_f32_32x32x16_bf16 v[240:255], v[132:135], v[156:159], v[240:255]
    ds_read_b64_tr_b16 v[146:147], v25 offset:2048
    s_waitcnt lgkmcnt(0)
    v_mfma_f32_32x32x16_bf16 v[160:175], v[136:139], v[120:123], v[160:175]
    ds_read_b128 v[128:131], v24 offset:32
    ds_read_b128 v[132:135], v24 offset:4640
    v_mfma_f32_32x32x16_bf16 v[176:191], v[120:123], v[140:143], v[176:191]
    ds_read_b64_tr_b16 v[148:149], v25 offset:7168
    ds_read_b64_tr_b16 v[150:151], v25 offset:8960
    v_mfma_f32_32x32x16_bf16 v[192:207], v[120:123], v[144:147], v[192:207]
    ds_read_b64_tr_b16 v[152:153], v25 offset:7296
    v_mfma_f32_32x32x16_bf16 v[208:223], v[136:139], v[124:127], v[208:223]
    ds_read_b64_tr_b16 v[154:155], v25 offset:9088
    v_mfma_f32_32x32x16_bf16 v[224:239], v[124:127], v[140:143], v[224:239]
    ds_read_b64_tr_b16 v[156:157], v25 offset:7424
    v_mfma_f32_32x32x16_bf16 v[240:255], v[124:127], v[144:147], v[240:255]
    ds_read_b64_tr_b16 v[158:159], v25 offset:9216
    s_waitcnt lgkmcnt(0)
    v_mfma_f32_32x32x16_bf16 v[160:175], v[148:151], v[128:131], v[160:175]
    ds_read_b128 v[120:123], v24 offset:64
    ds_read_b128 v[124:127], v24 offset:4672
    v_mfma_f32_32x32x16_bf16 v[176:191], v[128:131], v[152:155], v[176:191]
    ds_read_b64_tr_b16 v[136:137], v25 offset:14336
    ds_read_b64_tr_b16 v[138:139], v25 offset:16128
    v_mfma_f32_32x32x16_bf16 v[192:207], v[128:131], v[156:159], v[192:207]
    ds_read_b64_tr_b16 v[140:141], v25 offset:14464
    v_mfma_f32_32x32x16_bf16 v[208:223], v[148:151], v[132:135], v[208:223]
    ds_read_b64_tr_b16 v[142:143], v25 offset:16256
    v_mfma_f32_32x32x16_bf16 v[224:239], v[132:135], v[152:155], v[224:239]
    ds_read_b64_tr_b16 v[144:145], v25 offset:14592
    v_mfma_f32_32x32x16_bf16 v[240:255], v[132:135], v[156:159], v[240:255]
    ds_read_b64_tr_b16 v[146:147], v25 offset:16384
    s_waitcnt lgkmcnt(0)
    v_mfma_f32_32x32x16_bf16 v[160:175], v[136:139], v[120:123], v[160:175]
    ds_read_b128 v[128:131], v24 offset:96
    ds_read_b128 v[132:135], v24 offset:4704
    v_mfma_f32_32x32x16_bf16 v[176:191], v[120:123], v[140:143], v[176:191]
    ds_read_b64_tr_b16 v[148:149], v25 offset:21504
    ds_read_b64_tr_b16 v[150:151], v25 offset:23296
    v_mfma_f32_32x32x16_bf16 v[192:207], v[120:123], v[144:147], v[192:207]
    ds_read_b64_tr_b16 v[152:153], v25 offset:21632
    v_mfma_f32_32x32x16_bf16 v[208:223], v[136:139], v[124:127], v[208:223]
    ds_read_b64_tr_b16 v[154:155], v25 offset:23424
    v_mfma_f32_32x32x16_bf16 v[224:239], v[124:127], v[140:143], v[224:239]
    ds_read_b64_tr_b16 v[156:157], v25 offset:21760
    v_mfma_f32_32x32x16_bf16 v[240:255], v[124:127], v[144:147], v[240:255]
    ds_read_b64_tr_b16 v[158:159], v25 offset:23552
    s_waitcnt lgkmcnt(0)
    v_mfma_f32_32x32x16_bf16 v[160:175], v[148:151], v[128:131], v[160:175]
    v_mfma_f32_32x32x16_bf16 v[176:191], v[128:131], v[152:155], v[176:191]
    v_mfma_f32_32x32x16_bf16 v[192:207], v[128:131], v[156:159], v[192:207]
    v_mfma_f32_32x32x16_bf16 v[208:223], v[148:151], v[132:135], v[208:223]
    v_mfma_f32_32x32x16_bf16 v[224:239], v[132:135], v[152:155], v[224:239]
    v_mfma_f32_32x32x16_bf16 v[240:255], v[132:135], v[156:159], v[240:255]
    s_nop 15
    s_nop 7
    s_load_dwordx2 s[14:15], s[0:1], 64
    s_waitcnt lgkmcnt(0)
    s_add_u32 s14, s14, 0
    s_addc_u32 s15, s15, 0
    s_barrier
    s_lshl_b32 s12, s9, 1
    v_add_u32 v26, s12, v19
    v_lshl_add_u32 v27, v18, 6, s10
    v_mul_u32_u24 v24, 15360, v17
    v_mul_u32_u24 v22, 80, v20
    v_add_u32 v22, v22, v24
    v_lshl_add_u32 v22, v21, 3, v22
    v_mul_u32_u24 v23, 144, v20
    v_add_u32 v23, v23, v24
    v_lshl_add_u32 v23, v21, 4, v23
    v_lshrrev_b32 v25, 2, v16
    v_mul_u32_u24 v25, 80, v25
    v_and_b32 v30, 3, v16
    v_lshl_add_u32 v25, v30, 4, v25
    v_add_u32 v25, v25, v24
    v_lshrrev_b32 v31, 3, v16
    v_mul_u32_u24 v31, 144, v31
    v_and_b32 v30, 7, v16
    v_lshl_add_u32 v31, v30, 4, v31
    v_add_u32 v31, v31, v24
    v_mov_b32 v15, v31
    v_lshlrev_b32 v28, 11, v26
    v_add_u32 v28, v28, v27
    v_lshlrev_b32 v28, 6, v28
    v_lshl_add_u32 v28, v16, 4, v28
    v_lshrrev_b32 v29, 5, v27
    v_lshl_add_u32 v29, v26, 6, v29
    v_bfe_u32 v30, v16, 2, 1
    v_add_u32 v29, v29, v30
    v_lshrrev_b32 v30, 3, v16
    v_lshl_add_u32 v29, v29, 5, v30
    v_lshlrev_b32 v29, 6, v29
    v_and_b32 v30, 3, v16
    v_lshl_add_u32 v29, v30, 4, v29
    v_mov_b32 v100, 0
    v_mov_b32 v101, 0
    v_mov_b32 v102, 0
    v_mov_b32 v103, 0
    v_mov_b32 v104, 0
    v_mov_b32 v105, 0
    v_mov_b32 v106, 0
    v_mov_b32 v107, 0
    v_mov_b32 v108, 0
    v_mov_b32 v109, 0
    v_mov_b32 v110, 0
    v_mov_b32 v111, 0
    v_mov_b32 v112, 0
    v_mov_b32 v113, 0
    v_mov_b32 v114, 0
    v_mov_b32 v115, 0
    v_mov_b32 v99, 0
    v_mul_f32 v30, 0x3fb8aa3b, v160
    v_exp_f32 v30, v30
    v_add_f32 v31, 1.0, v160
    v_cmp_lt_f32 vcc, 0, v160
    s_nop 1
    v_cndmask_b32 v30, v30, v31, vcc
    v_add_f32 v160, 0x358637bd, v30
    v_mul_f32 v30, 0x3fb8aa3b, v161
    v_exp_f32 v30, v30
    v_add_f32 v31, 1.0, v161
    v_cmp_lt_f32 vcc, 0, v161
    s_nop 1
    v_cndmask_b32 v30, v30, v31, vcc
    v_add_f32 v161, 0x358637bd, v30
    v_mul_f32 v30, 0x3fb8aa3b, v162
    v_exp_f32 v30, v30
    v_add_f32 v31, 1.0, v162
    v_cmp_lt_f32 vcc, 0, v162
    s_nop 1
    v_cndmask_b32 v30, v30, v31, vcc
    v_add_f32 v162, 0x358637bd, v30
    v_mul_f32 v30, 0x3fb8aa3b, v163
    v_exp_f32 v30, v30
    v_add_f32 v31, 1.0, v163
    v_cmp_lt_f32 vcc, 0, v163
    s_nop 1
    v_cndmask_b32 v30, v30, v31, vcc
    v_add_f32 v163, 0x358637bd, v30
    v_mul_f32 v30, 0x3fb8aa3b, v164
    v_exp_f32 v30, v30
    v_add_f32 v31, 1.0, v164
    v_cmp_lt_f32 vcc, 0, v164
    s_nop 1
    v_cndmask_b32 v30, v30, v31, vcc
    v_add_f32 v164, 0x358637bd, v30
    v_mul_f32 v30, 0x3fb8aa3b, v165
    v_exp_f32 v30, v30
    v_add_f32 v31, 1.0, v165
    v_cmp_lt_f32 vcc, 0, v165
    s_nop 1
    v_cndmask_b32 v30, v30, v31, vcc
    v_add_f32 v165, 0x358637bd, v30
    v_mul_f32 v30, 0x3fb8aa3b, v166
    v_exp_f32 v30, v30
    v_add_f32 v31, 1.0, v166
    v_cmp_lt_f32 vcc, 0, v166
    s_nop 1
    v_cndmask_b32 v30, v30, v31, vcc
    v_add_f32 v166, 0x358637bd, v30
    v_mul_f32 v30, 0x3fb8aa3b, v167
    v_exp_f32 v30, v30
    v_add_f32 v31, 1.0, v167
    v_cmp_lt_f32 vcc, 0, v167
    s_nop 1
    v_cndmask_b32 v30, v30, v31, vcc
    v_add_f32 v167, 0x358637bd, v30
    v_mul_f32 v30, 0x3fb8aa3b, v168
    v_exp_f32 v30, v30
    v_add_f32 v31, 1.0, v168
    v_cmp_lt_f32 vcc, 0, v168
    s_nop 1
    v_cndmask_b32 v30, v30, v31, vcc
    v_add_f32 v168, 0x358637bd, v30
    v_mul_f32 v30, 0x3fb8aa3b, v169
    v_exp_f32 v30, v30
    v_add_f32 v31, 1.0, v169
    v_cmp_lt_f32 vcc, 0, v169
    s_nop 1
    v_cndmask_b32 v30, v30, v31, vcc
    v_add_f32 v169, 0x358637bd, v30
    v_mul_f32 v30, 0x3fb8aa3b, v170
    v_exp_f32 v30, v30
    v_add_f32 v31, 1.0, v170
    v_cmp_lt_f32 vcc, 0, v170
    s_nop 1
    v_cndmask_b32 v30, v30, v31, vcc
    v_add_f32 v170, 0x358637bd, v30
    v_mul_f32 v30, 0x3fb8aa3b, v171
    v_exp_f32 v30, v30
    v_add_f32 v31, 1.0, v171
    v_cmp_lt_f32 vcc, 0, v171
    s_nop 1
    v_cndmask_b32 v30, v30, v31, vcc
    v_add_f32 v171, 0x358637bd, v30
    v_mul_f32 v30, 0x3fb8aa3b, v172
    v_exp_f32 v30, v30
    v_add_f32 v31, 1.0, v172
    v_cmp_lt_f32 vcc, 0, v172
    s_nop 1
    v_cndmask_b32 v30, v30, v31, vcc
    v_add_f32 v172, 0x358637bd, v30
    v_mul_f32 v30, 0x3fb8aa3b, v173
    v_exp_f32 v30, v30
    v_add_f32 v31, 1.0, v173
    v_cmp_lt_f32 vcc, 0, v173
    s_nop 1
    v_cndmask_b32 v30, v30, v31, vcc
    v_add_f32 v173, 0x358637bd, v30
    v_mul_f32 v30, 0x3fb8aa3b, v174
    v_exp_f32 v30, v30
    v_add_f32 v31, 1.0, v174
    v_cmp_lt_f32 vcc, 0, v174
    s_nop 1
    v_cndmask_b32 v30, v30, v31, vcc
    v_add_f32 v174, 0x358637bd, v30
    v_mul_f32 v30, 0x3fb8aa3b, v175
    v_exp_f32 v30, v30
    v_add_f32 v31, 1.0, v175
    v_cmp_lt_f32 vcc, 0, v175
    s_nop 1
    v_cndmask_b32 v30, v30, v31, vcc
    v_add_f32 v175, 0x358637bd, v30
    v_cvt_pk_bf16_f32 v32, v160, v161
    v_cvt_pk_bf16_f32 v33, v162, v163
    v_cvt_pk_bf16_f32 v34, v164, v165
    v_cvt_pk_bf16_f32 v35, v166, v167
    v_cvt_pk_bf16_f32 v36, v168, v169
    v_cvt_pk_bf16_f32 v37, v170, v171
    v_cvt_pk_bf16_f32 v38, v172, v173
    v_cvt_pk_bf16_f32 v39, v174, v175
    ds_write_b64 v22, v[32:33] offset:0
    ds_write_b64 v22, v[34:35] offset:16
    ds_write_b64 v22, v[36:37] offset:32
    ds_write_b64 v22, v[38:39] offset:48
    v_mul_f32 v30, 0x3fb8aa3b, v208
    v_exp_f32 v30, v30
    v_add_f32 v31, 1.0, v208
    v_cmp_lt_f32 vcc, 0, v208
    s_nop 1
    v_cndmask_b32 v30, v30, v31, vcc
    v_add_f32 v208, 0x358637bd, v30
    v_mul_f32 v30, 0x3fb8aa3b, v209
    v_exp_f32 v30, v30
    v_add_f32 v31, 1.0, v209
    v_cmp_lt_f32 vcc, 0, v209
    s_nop 1
    v_cndmask_b32 v30, v30, v31, vcc
    v_add_f32 v209, 0x358637bd, v30
    v_mul_f32 v30, 0x3fb8aa3b, v210
    v_exp_f32 v30, v30
    v_add_f32 v31, 1.0, v210
    v_cmp_lt_f32 vcc, 0, v210
    s_nop 1
    v_cndmask_b32 v30, v30, v31, vcc
    v_add_f32 v210, 0x358637bd, v30
    v_mul_f32 v30, 0x3fb8aa3b, v211
    v_exp_f32 v30, v30
    v_add_f32 v31, 1.0, v211
    v_cmp_lt_f32 vcc, 0, v211
    s_nop 1
    v_cndmask_b32 v30, v30, v31, vcc
    v_add_f32 v211, 0x358637bd, v30
    v_mul_f32 v30, 0x3fb8aa3b, v212
    v_exp_f32 v30, v30
    v_add_f32 v31, 1.0, v212
    v_cmp_lt_f32 vcc, 0, v212
    s_nop 1
    v_cndmask_b32 v30, v30, v31, vcc
    v_add_f32 v212, 0x358637bd, v30
    v_mul_f32 v30, 0x3fb8aa3b, v213
    v_exp_f32 v30, v30
    v_add_f32 v31, 1.0, v213
    v_cmp_lt_f32 vcc, 0, v213
    s_nop 1
    v_cndmask_b32 v30, v30, v31, vcc
    v_add_f32 v213, 0x358637bd, v30
    v_mul_f32 v30, 0x3fb8aa3b, v214
    v_exp_f32 v30, v30
    v_add_f32 v31, 1.0, v214
    v_cmp_lt_f32 vcc, 0, v214
    s_nop 1
    v_cndmask_b32 v30, v30, v31, vcc
    v_add_f32 v214, 0x358637bd, v30
    v_mul_f32 v30, 0x3fb8aa3b, v215
    v_exp_f32 v30, v30
    v_add_f32 v31, 1.0, v215
    v_cmp_lt_f32 vcc, 0, v215
    s_nop 1
    v_cndmask_b32 v30, v30, v31, vcc
    v_add_f32 v215, 0x358637bd, v30
    v_mul_f32 v30, 0x3fb8aa3b, v216
    v_exp_f32 v30, v30
    v_add_f32 v31, 1.0, v216
    v_cmp_lt_f32 vcc, 0, v216
    s_nop 1
    v_cndmask_b32 v30, v30, v31, vcc
    v_add_f32 v216, 0x358637bd, v30
    v_mul_f32 v30, 0x3fb8aa3b, v217
    v_exp_f32 v30, v30
    v_add_f32 v31, 1.0, v217
    v_cmp_lt_f32 vcc, 0, v217
    s_nop 1
    v_cndmask_b32 v30, v30, v31, vcc
    v_add_f32 v217, 0x358637bd, v30
    v_mul_f32 v30, 0x3fb8aa3b, v218
    v_exp_f32 v30, v30
    v_add_f32 v31, 1.0, v218
    v_cmp_lt_f32 vcc, 0, v218
    s_nop 1
    v_cndmask_b32 v30, v30, v31, vcc
    v_add_f32 v218, 0x358637bd, v30
    v_mul_f32 v30, 0x3fb8aa3b, v219
    v_exp_f32 v30, v30
    v_add_f32 v31, 1.0, v219
    v_cmp_lt_f32 vcc, 0, v219
    s_nop 1
    v_cndmask_b32 v30, v30, v31, vcc
    v_add_f32 v219, 0x358637bd, v30
    v_mul_f32 v30, 0x3fb8aa3b, v220
    v_exp_f32 v30, v30
    v_add_f32 v31, 1.0, v220
    v_cmp_lt_f32 vcc, 0, v220
    s_nop 1
    v_cndmask_b32 v30, v30, v31, vcc
    v_add_f32 v220, 0x358637bd, v30
    v_mul_f32 v30, 0x3fb8aa3b, v221
    v_exp_f32 v30, v30
    v_add_f32 v31, 1.0, v221
    v_cmp_lt_f32 vcc, 0, v221
    s_nop 1
    v_cndmask_b32 v30, v30, v31, vcc
    v_add_f32 v221, 0x358637bd, v30
    v_mul_f32 v30, 0x3fb8aa3b, v222
    v_exp_f32 v30, v30
    v_add_f32 v31, 1.0, v222
    v_cmp_lt_f32 vcc, 0, v222
    s_nop 1
    v_cndmask_b32 v30, v30, v31, vcc
    v_add_f32 v222, 0x358637bd, v30
    v_mul_f32 v30, 0x3fb8aa3b, v223
    v_exp_f32 v30, v30
    v_add_f32 v31, 1.0, v223
    v_cmp_lt_f32 vcc, 0, v223
    s_nop 1
    v_cndmask_b32 v30, v30, v31, vcc
    v_add_f32 v223, 0x358637bd, v30
    v_cvt_pk_bf16_f32 v32, v208, v209
    v_cvt_pk_bf16_f32 v33, v210, v211
    v_cvt_pk_bf16_f32 v34, v212, v213
    v_cvt_pk_bf16_f32 v35, v214, v215
    v_cvt_pk_bf16_f32 v36, v216, v217
    v_cvt_pk_bf16_f32 v37, v218, v219
    v_cvt_pk_bf16_f32 v38, v220, v221
    v_cvt_pk_bf16_f32 v39, v222, v223
    ds_write_b64 v22, v[32:33] offset:2560
    ds_write_b64 v22, v[34:35] offset:2576
    ds_write_b64 v22, v[36:37] offset:2592
    ds_write_b64 v22, v[38:39] offset:2608
    v_mul_f32 v30, 0x3fb8aa3b, v176
    v_exp_f32 v30, v30
    v_add_f32 v31, 1.0, v176
    v_cmp_lt_f32 vcc, 0, v176
    s_nop 1
    v_cndmask_b32 v30, v30, v31, vcc
    v_add_f32 v176, 0x358637bd, v30
    v_mul_f32 v30, 0x3fb8aa3b, v177
    v_exp_f32 v30, v30
    v_add_f32 v31, 1.0, v177
    v_cmp_lt_f32 vcc, 0, v177
    s_nop 1
    v_cndmask_b32 v30, v30, v31, vcc
    v_add_f32 v177, 0x358637bd, v30
    v_mul_f32 v30, 0x3fb8aa3b, v178
    v_exp_f32 v30, v30
    v_add_f32 v31, 1.0, v178
    v_cmp_lt_f32 vcc, 0, v178
    s_nop 1
    v_cndmask_b32 v30, v30, v31, vcc
    v_add_f32 v178, 0x358637bd, v30
    v_mul_f32 v30, 0x3fb8aa3b, v179
    v_exp_f32 v30, v30
    v_add_f32 v31, 1.0, v179
    v_cmp_lt_f32 vcc, 0, v179
    s_nop 1
    v_cndmask_b32 v30, v30, v31, vcc
    v_add_f32 v179, 0x358637bd, v30
    v_mul_f32 v30, 0x3fb8aa3b, v180
    v_exp_f32 v30, v30
    v_add_f32 v31, 1.0, v180
    v_cmp_lt_f32 vcc, 0, v180
    s_nop 1
    v_cndmask_b32 v30, v30, v31, vcc
    v_add_f32 v180, 0x358637bd, v30
    v_mul_f32 v30, 0x3fb8aa3b, v181
    v_exp_f32 v30, v30
    v_add_f32 v31, 1.0, v181
    v_cmp_lt_f32 vcc, 0, v181
    s_nop 1
    v_cndmask_b32 v30, v30, v31, vcc
    v_add_f32 v181, 0x358637bd, v30
    v_mul_f32 v30, 0x3fb8aa3b, v182
    v_exp_f32 v30, v30
    v_add_f32 v31, 1.0, v182
    v_cmp_lt_f32 vcc, 0, v182
    s_nop 1
    v_cndmask_b32 v30, v30, v31, vcc
    v_add_f32 v182, 0x358637bd, v30
    v_mul_f32 v30, 0x3fb8aa3b, v183
    v_exp_f32 v30, v30
    v_add_f32 v31, 1.0, v183
    v_cmp_lt_f32 vcc, 0, v183
    s_nop 1
    v_cndmask_b32 v30, v30, v31, vcc
    v_add_f32 v183, 0x358637bd, v30
    v_mul_f32 v30, 0x3fb8aa3b, v184
    v_exp_f32 v30, v30
    v_add_f32 v31, 1.0, v184
    v_cmp_lt_f32 vcc, 0, v184
    s_nop 1
    v_cndmask_b32 v30, v30, v31, vcc
    v_add_f32 v184, 0x358637bd, v30
    v_mul_f32 v30, 0x3fb8aa3b, v185
    v_exp_f32 v30, v30
    v_add_f32 v31, 1.0, v185
    v_cmp_lt_f32 vcc, 0, v185
    s_nop 1
    v_cndmask_b32 v30, v30, v31, vcc
    v_add_f32 v185, 0x358637bd, v30
    v_mul_f32 v30, 0x3fb8aa3b, v186
    v_exp_f32 v30, v30
    v_add_f32 v31, 1.0, v186
    v_cmp_lt_f32 vcc, 0, v186
    s_nop 1
    v_cndmask_b32 v30, v30, v31, vcc
    v_add_f32 v186, 0x358637bd, v30
    v_mul_f32 v30, 0x3fb8aa3b, v187
    v_exp_f32 v30, v30
    v_add_f32 v31, 1.0, v187
    v_cmp_lt_f32 vcc, 0, v187
    s_nop 1
    v_cndmask_b32 v30, v30, v31, vcc
    v_add_f32 v187, 0x358637bd, v30
    v_mul_f32 v30, 0x3fb8aa3b, v188
    v_exp_f32 v30, v30
    v_add_f32 v31, 1.0, v188
    v_cmp_lt_f32 vcc, 0, v188
    s_nop 1
    v_cndmask_b32 v30, v30, v31, vcc
    v_add_f32 v188, 0x358637bd, v30
    v_mul_f32 v30, 0x3fb8aa3b, v189
    v_exp_f32 v30, v30
    v_add_f32 v31, 1.0, v189
    v_cmp_lt_f32 vcc, 0, v189
    s_nop 1
    v_cndmask_b32 v30, v30, v31, vcc
    v_add_f32 v189, 0x358637bd, v30
    v_mul_f32 v30, 0x3fb8aa3b, v190
    v_exp_f32 v30, v30
    v_add_f32 v31, 1.0, v190
    v_cmp_lt_f32 vcc, 0, v190
    s_nop 1
    v_cndmask_b32 v30, v30, v31, vcc
    v_add_f32 v190, 0x358637bd, v30
    v_mul_f32 v30, 0x3fb8aa3b, v191
    v_exp_f32 v30, v30
    v_add_f32 v31, 1.0, v191
    v_cmp_lt_f32 vcc, 0, v191
    s_nop 1
    v_cndmask_b32 v30, v30, v31, vcc
    v_add_f32 v191, 0x358637bd, v30
    v_cvt_pk_bf16_f32 v120, v176, v177
    v_cvt_pk_bf16_f32 v121, v178, v179
    v_cvt_pk_bf16_f32 v122, v180, v181
    v_cvt_pk_bf16_f32 v123, v182, v183
    v_cvt_pk_bf16_f32 v124, v184, v185
    v_cvt_pk_bf16_f32 v125, v186, v187
    v_cvt_pk_bf16_f32 v126, v188, v189
    v_cvt_pk_bf16_f32 v127, v190, v191
    v_lshlrev_b32 v30, 16, v120
    v_and_b32 v31, 0xffff0000, v120
    v_add_f32 v99, v99, v30
    v_add_f32 v99, v99, v31
    v_lshlrev_b32 v30, 16, v121
    v_and_b32 v31, 0xffff0000, v121
    v_add_f32 v99, v99, v30
    v_add_f32 v99, v99, v31
    v_lshlrev_b32 v30, 16, v122
    v_and_b32 v31, 0xffff0000, v122
    v_add_f32 v99, v99, v30
    v_add_f32 v99, v99, v31
    v_lshlrev_b32 v30, 16, v123
    v_and_b32 v31, 0xffff0000, v123
    v_add_f32 v99, v99, v30
    v_add_f32 v99, v99, v31
    v_lshlrev_b32 v30, 16, v124
    v_and_b32 v31, 0xffff0000, v124
    v_add_f32 v99, v99, v30
    v_add_f32 v99, v99, v31
    v_lshlrev_b32 v30, 16, v125
    v_and_b32 v31, 0xffff0000, v125
    v_add_f32 v99, v99, v30
    v_add_f32 v99, v99, v31
    v_lshlrev_b32 v30, 16, v126
    v_and_b32 v31, 0xffff0000, v126
    v_add_f32 v99, v99, v30
    v_add_f32 v99, v99, v31
    v_lshlrev_b32 v30, 16, v127
    v_and_b32 v31, 0xffff0000, v127
    v_add_f32 v99, v99, v30
    v_add_f32 v99, v99, v31
    v_mul_f32 v30, 0x3fb8aa3b, v224
    v_exp_f32 v30, v30
    v_add_f32 v31, 1.0, v224
    v_cmp_lt_f32 vcc, 0, v224
    s_nop 1
    v_cndmask_b32 v30, v30, v31, vcc
    v_add_f32 v224, 0x358637bd, v30
    v_mul_f32 v30, 0x3fb8aa3b, v225
    v_exp_f32 v30, v30
    v_add_f32 v31, 1.0, v225
    v_cmp_lt_f32 vcc, 0, v225
    s_nop 1
    v_cndmask_b32 v30, v30, v31, vcc
    v_add_f32 v225, 0x358637bd, v30
    v_mul_f32 v30, 0x3fb8aa3b, v226
    v_exp_f32 v30, v30
    v_add_f32 v31, 1.0, v226
    v_cmp_lt_f32 vcc, 0, v226
    s_nop 1
    v_cndmask_b32 v30, v30, v31, vcc
    v_add_f32 v226, 0x358637bd, v30
    v_mul_f32 v30, 0x3fb8aa3b, v227
    v_exp_f32 v30, v30
    v_add_f32 v31, 1.0, v227
    v_cmp_lt_f32 vcc, 0, v227
    s_nop 1
    v_cndmask_b32 v30, v30, v31, vcc
    v_add_f32 v227, 0x358637bd, v30
    v_mul_f32 v30, 0x3fb8aa3b, v228
    v_exp_f32 v30, v30
    v_add_f32 v31, 1.0, v228
    v_cmp_lt_f32 vcc, 0, v228
    s_nop 1
    v_cndmask_b32 v30, v30, v31, vcc
    v_add_f32 v228, 0x358637bd, v30
    v_mul_f32 v30, 0x3fb8aa3b, v229
    v_exp_f32 v30, v30
    v_add_f32 v31, 1.0, v229
    v_cmp_lt_f32 vcc, 0, v229
    s_nop 1
    v_cndmask_b32 v30, v30, v31, vcc
    v_add_f32 v229, 0x358637bd, v30
    v_mul_f32 v30, 0x3fb8aa3b, v230
    v_exp_f32 v30, v30
    v_add_f32 v31, 1.0, v230
    v_cmp_lt_f32 vcc, 0, v230
    s_nop 1
    v_cndmask_b32 v30, v30, v31, vcc
    v_add_f32 v230, 0x358637bd, v30
    v_mul_f32 v30, 0x3fb8aa3b, v231
    v_exp_f32 v30, v30
    v_add_f32 v31, 1.0, v231
    v_cmp_lt_f32 vcc, 0, v231
    s_nop 1
    v_cndmask_b32 v30, v30, v31, vcc
    v_add_f32 v231, 0x358637bd, v30
    v_mul_f32 v30, 0x3fb8aa3b, v232
    v_exp_f32 v30, v30
    v_add_f32 v31, 1.0, v232
    v_cmp_lt_f32 vcc, 0, v232
    s_nop 1
    v_cndmask_b32 v30, v30, v31, vcc
    v_add_f32 v232, 0x358637bd, v30
    v_mul_f32 v30, 0x3fb8aa3b, v233
    v_exp_f32 v30, v30
    v_add_f32 v31, 1.0, v233
    v_cmp_lt_f32 vcc, 0, v233
    s_nop 1
    v_cndmask_b32 v30, v30, v31, vcc
    v_add_f32 v233, 0x358637bd, v30
    v_mul_f32 v30, 0x3fb8aa3b, v234
    v_exp_f32 v30, v30
    v_add_f32 v31, 1.0, v234
    v_cmp_lt_f32 vcc, 0, v234
    s_nop 1
    v_cndmask_b32 v30, v30, v31, vcc
    v_add_f32 v234, 0x358637bd, v30
    v_mul_f32 v30, 0x3fb8aa3b, v235
    v_exp_f32 v30, v30
    v_add_f32 v31, 1.0, v235
    v_cmp_lt_f32 vcc, 0, v235
    s_nop 1
    v_cndmask_b32 v30, v30, v31, vcc
    v_add_f32 v235, 0x358637bd, v30
    v_mul_f32 v30, 0x3fb8aa3b, v236
    v_exp_f32 v30, v30
    v_add_f32 v31, 1.0, v236
    v_cmp_lt_f32 vcc, 0, v236
    s_nop 1
    v_cndmask_b32 v30, v30, v31, vcc
    v_add_f32 v236, 0x358637bd, v30
    v_mul_f32 v30, 0x3fb8aa3b, v237
    v_exp_f32 v30, v30
    v_add_f32 v31, 1.0, v237
    v_cmp_lt_f32 vcc, 0, v237
    s_nop 1
    v_cndmask_b32 v30, v30, v31, vcc
    v_add_f32 v237, 0x358637bd, v30
    v_mul_f32 v30, 0x3fb8aa3b, v238
    v_exp_f32 v30, v30
    v_add_f32 v31, 1.0, v238
    v_cmp_lt_f32 vcc, 0, v238
    s_nop 1
    v_cndmask_b32 v30, v30, v31, vcc
    v_add_f32 v238, 0x358637bd, v30
    v_mul_f32 v30, 0x3fb8aa3b, v239
    v_exp_f32 v30, v30
    v_add_f32 v31, 1.0, v239
    v_cmp_lt_f32 vcc, 0, v239
    s_nop 1
    v_cndmask_b32 v30, v30, v31, vcc
    v_add_f32 v239, 0x358637bd, v30
    v_cvt_pk_bf16_f32 v128, v224, v225
    v_cvt_pk_bf16_f32 v129, v226, v227
    v_cvt_pk_bf16_f32 v130, v228, v229
    v_cvt_pk_bf16_f32 v131, v230, v231
    v_cvt_pk_bf16_f32 v132, v232, v233
    v_cvt_pk_bf16_f32 v133, v234, v235
    v_cvt_pk_bf16_f32 v134, v236, v237
    v_cvt_pk_bf16_f32 v135, v238, v239
    v_lshlrev_b32 v30, 16, v128
    v_and_b32 v31, 0xffff0000, v128
    v_add_f32 v99, v99, v30
    v_add_f32 v99, v99, v31
    v_lshlrev_b32 v30, 16, v129
    v_and_b32 v31, 0xffff0000, v129
    v_add_f32 v99, v99, v30
    v_add_f32 v99, v99, v31
    v_lshlrev_b32 v30, 16, v130
    v_and_b32 v31, 0xffff0000, v130
    v_add_f32 v99, v99, v30
    v_add_f32 v99, v99, v31
    v_lshlrev_b32 v30, 16, v131
    v_and_b32 v31, 0xffff0000, v131
    v_add_f32 v99, v99, v30
    v_add_f32 v99, v99, v31
    v_lshlrev_b32 v30, 16, v132
    v_and_b32 v31, 0xffff0000, v132
    v_add_f32 v99, v99, v30
    v_add_f32 v99, v99, v31
    v_lshlrev_b32 v30, 16, v133
    v_and_b32 v31, 0xffff0000, v133
    v_add_f32 v99, v99, v30
    v_add_f32 v99, v99, v31
    v_lshlrev_b32 v30, 16, v134
    v_and_b32 v31, 0xffff0000, v134
    v_add_f32 v99, v99, v30
    v_add_f32 v99, v99, v31
    v_lshlrev_b32 v30, 16, v135
    v_and_b32 v31, 0xffff0000, v135
    v_add_f32 v99, v99, v30
    v_add_f32 v99, v99, v31
    v_cvt_pk_bf16_f32 v136, v192, v193
    v_cvt_pk_bf16_f32 v137, v194, v195
    v_cvt_pk_bf16_f32 v138, v196, v197
    v_cvt_pk_bf16_f32 v139, v198, v199
    v_cvt_pk_bf16_f32 v140, v200, v201
    v_cvt_pk_bf16_f32 v141, v202, v203
    v_cvt_pk_bf16_f32 v142, v204, v205
    v_cvt_pk_bf16_f32 v143, v206, v207
    v_cvt_pk_bf16_f32 v144, v240, v241
    v_cvt_pk_bf16_f32 v145, v242, v243
    v_cvt_pk_bf16_f32 v146, v244, v245
    v_cvt_pk_bf16_f32 v147, v246, v247
    v_cvt_pk_bf16_f32 v148, v248, v249
    v_cvt_pk_bf16_f32 v149, v250, v251
    v_cvt_pk_bf16_f32 v150, v252, v253
    v_cvt_pk_bf16_f32 v151, v254, v255
    s_nop 1
    v_mfma_f32_32x32x16_bf16 v[100:115], v[120:123], v[136:139], v[100:115]
    v_mfma_f32_32x32x16_bf16 v[100:115], v[124:127], v[140:143], v[100:115]
    v_mfma_f32_32x32x16_bf16 v[100:115], v[128:131], v[144:147], v[100:115]
    v_mfma_f32_32x32x16_bf16 v[100:115], v[132:135], v[148:151], v[100:115]
    s_lshl_b32 s13, s8, 1
    v_lshl_add_u32 v30, v26, 5, s13
    v_add_u32 v30, v30, v18
    v_lshlrev_b32 v31, 8, v30
    v_lshl_add_u32 v31, v16, 2, v31
    v_add_u32 v31, 16777216, v31
    global_store_dword v31, v99, s[14:15]
    v_lshlrev_b32 v30, 12, v30
    v_lshl_add_u32 v30, v16, 6, v30
    v_add_u32 v30, 12582912, v30
    s_waitcnt lgkmcnt(0)
    ds_read_b128 v[40:43], v25 offset:0
    ds_read_b128 v[44:47], v25 offset:1280
    ds_read_b128 v[48:51], v25 offset:2560
    ds_read_b128 v[52:55], v25 offset:3840
    s_nop 7
    s_nop 7
    global_store_dwordx4 v30, v[100:103], s[14:15] offset:0
    global_store_dwordx4 v30, v[104:107], s[14:15] offset:16
    global_store_dwordx4 v30, v[108:111], s[14:15] offset:32
    global_store_dwordx4 v30, v[112:115], s[14:15] offset:48
    s_waitcnt lgkmcnt(0)
    v_add_u32 v30, 8388608, v28
    global_store_dwordx4 v30, v[40:43], s[14:15]
    v_add_u32 v30, 8389632, v28
    global_store_dwordx4 v30, v[44:47], s[14:15]
    v_add_u32 v30, 8390656, v28
    global_store_dwordx4 v30, v[48:51], s[14:15]
    v_add_u32 v30, 8391680, v28
    global_store_dwordx4 v30, v[52:55], s[14:15]
L_qkv0_end:
    s_endpgm
.globl atta0_kernel
.p2align 8
.type atta0_kernel,@function
atta0_kernel:
    s_cmp_ge_u32 s2, 256
    s_cbranch_scc1 L_atta0_end
    s_load_dwordx2 s[4:5], s[0:1], 64
    s_load_dwordx2 s[6:7], s[0:1], 64
    s_load_dwordx2 s[16:17], s[0:1], 64
    s_load_dwordx2 s[18:19], s[0:1], 64
    s_waitcnt lgkmcnt(0)
    s_add_u32 s4, s4, 8388608
    s_addc_u32 s5, s5, 0
    s_add_u32 s6, s6, 12582912
    s_addc_u32 s7, s7, 0
    s_add_u32 s16, s16, 16777216
    s_addc_u32 s17, s17, 0
    s_add_u32 s18, s18, 20971520
    s_addc_u32 s19, s19, 0
    s_lshr_b32 s8, s2, 3
    s_and_b32 s9, s2, 7
    v_lshrrev_b32 v1, 6, v0
    v_and_b32 v2, 63, v0
    v_and_b32 v3, 31, v2
    v_lshrrev_b32 v4, 5, v2
    s_lshl_b32 s10, s8, 17
    v_lshl_add_u32 v5, v0, 4, s10
    v_add_u32 v6, 0, v5
    global_load_dwordx4 v[32:35], v6, s[6:7]
    v_add_u32 v6, 4096, v5
    global_load_dwordx4 v[36:39], v6, s[6:7]
    v_add_u32 v6, 8192, v5
    global_load_dwordx4 v[40:43], v6, s[6:7]
    v_add_u32 v6, 12288, v5
    global_load_dwordx4 v[44:47], v6, s[6:7]
    v_add_u32 v6, 16384, v5
    global_load_dwordx4 v[48:51], v6, s[6:7]
    v_add_u32 v6, 20480, v5
    global_load_dwordx4 v[52:55], v6, s[6:7]
    v_add_u32 v6, 24576, v5
    global_load_dwordx4 v[56:59], v6, s[6:7]
    v_add_u32 v6, 28672, v5
    global_load_dwordx4 v[60:63], v6, s[6:7]
    v_add_u32 v6, 32768, v5
    global_load_dwordx4 v[64:67], v6, s[6:7]
    v_add_u32 v6, 36864, v5
    global_load_dwordx4 v[68:71], v6, s[6:7]
    v_add_u32 v6, 40960, v5
    global_load_dwordx4 v[72:75], v6, s[6:7]
    v_add_u32 v6, 45056, v5
    global_load_dwordx4 v[76:79], v6, s[6:7]
    v_add_u32 v6, 49152, v5
    global_load_dwordx4 v[80:83], v6, s[6:7]
    v_add_u32 v6, 53248, v5
    global_load_dwordx4 v[84:87], v6, s[6:7]
    v_add_u32 v6, 57344, v5
    global_load_dwordx4 v[88:91], v6, s[6:7]
    v_add_u32 v6, 61440, v5
    global_load_dwordx4 v[92:95], v6, s[6:7]
    v_add_u32 v6, 65536, v5
    global_load_dwordx4 v[96:99], v6, s[6:7]
    v_add_u32 v6, 69632, v5
    global_load_dwordx4 v[100:103], v6, s[6:7]
    v_add_u32 v6, 73728, v5
    global_load_dwordx4 v[104:107], v6, s[6:7]
    v_add_u32 v6, 77824, v5
    global_load_dwordx4 v[108:111], v6, s[6:7]
    v_add_u32 v6, 81920, v5
    global_load_dwordx4 v[112:115], v6, s[6:7]
    v_add_u32 v6, 86016, v5
    global_load_dwordx4 v[116:119], v6, s[6:7]
    v_add_u32 v6, 90112, v5
    global_load_dwordx4 v[120:123], v6, s[6:7]
    v_add_u32 v6, 94208, v5
    global_load_dwordx4 v[124:127], v6, s[6:7]
    v_add_u32 v6, 98304, v5
    global_load_dwordx4 v[128:131], v6, s[6:7]
    v_add_u32 v6, 102400, v5
    global_load_dwordx4 v[132:135], v6, s[6:7]
    v_add_u32 v6, 106496, v5
    global_load_dwordx4 v[136:139], v6, s[6:7]
    v_add_u32 v6, 110592, v5
    global_load_dwordx4 v[140:143], v6, s[6:7]
    v_add_u32 v6, 114688, v5
    global_load_dwordx4 v[144:147], v6, s[6:7]
    v_add_u32 v6, 118784, v5
    global_load_dwordx4 v[148:151], v6, s[6:7]
    v_add_u32 v6, 122880, v5
    global_load_dwordx4 v[152:155], v6, s[6:7]
    v_add_u32 v6, 126976, v5
    global_load_dwordx4 v[156:159], v6, s[6:7]
    s_lshl_b32 s10, s8, 13
    v_lshl_add_u32 v5, v1, 11, s10
    v_lshl_add_u32 v5, v2, 2, v5
    global_load_dword v160, v5, s[16:17] offset:0
    global_load_dword v161, v5, s[16:17] offset:256
    global_load_dword v162, v5, s[16:17] offset:512
    global_load_dword v163, v5, s[16:17] offset:768
    global_load_dword v164, v5, s[16:17] offset:1024
    global_load_dword v165, v5, s[16:17] offset:1280
    global_load_dword v166, v5, s[16:17] offset:1536
    global_load_dword v167, v5, s[16:17] offset:1792
    s_waitcnt vmcnt(8)
    v_add_f32 v32, v32, v36
    v_add_f32 v33, v33, v37
    v_add_f32 v34, v34, v38
    v_add_f32 v35, v35, v39
    v_add_f32 v32, v32, v40
    v_add_f32 v33, v33, v41
    v_add_f32 v34, v34, v42
    v_add_f32 v35, v35, v43
    v_add_f32 v32, v32, v44
    v_add_f32 v33, v33, v45
    v_add_f32 v34, v34, v46
    v_add_f32 v35, v35, v47
    v_add_f32 v32, v32, v48
    v_add_f32 v33, v33, v49
    v_add_f32 v34, v34, v50
    v_add_f32 v35, v35, v51
    v_add_f32 v32, v32, v52
    v_add_f32 v33, v33, v53
    v_add_f32 v34, v34, v54
    v_add_f32 v35, v35, v55
    v_add_f32 v32, v32, v56
    v_add_f32 v33, v33, v57
    v_add_f32 v34, v34, v58
    v_add_f32 v35, v35, v59
    v_add_f32 v32, v32, v60
    v_add_f32 v33, v33, v61
    v_add_f32 v34, v34, v62
    v_add_f32 v35, v35, v63
    v_add_f32 v32, v32, v64
    v_add_f32 v33, v33, v65
    v_add_f32 v34, v34, v66
    v_add_f32 v35, v35, v67
    v_add_f32 v32, v32, v68
    v_add_f32 v33, v33, v69
    v_add_f32 v34, v34, v70
    v_add_f32 v35, v35, v71
    v_add_f32 v32, v32, v72
    v_add_f32 v33, v33, v73
    v_add_f32 v34, v34, v74
    v_add_f32 v35, v35, v75
    v_add_f32 v32, v32, v76
    v_add_f32 v33, v33, v77
    v_add_f32 v34, v34, v78
    v_add_f32 v35, v35, v79
    v_add_f32 v32, v32, v80
    v_add_f32 v33, v33, v81
    v_add_f32 v34, v34, v82
    v_add_f32 v35, v35, v83
    v_add_f32 v32, v32, v84
    v_add_f32 v33, v33, v85
    v_add_f32 v34, v34, v86
    v_add_f32 v35, v35, v87
    v_add_f32 v32, v32, v88
    v_add_f32 v33, v33, v89
    v_add_f32 v34, v34, v90
    v_add_f32 v35, v35, v91
    v_add_f32 v32, v32, v92
    v_add_f32 v33, v33, v93
    v_add_f32 v34, v34, v94
    v_add_f32 v35, v35, v95
    v_add_f32 v32, v32, v96
    v_add_f32 v33, v33, v97
    v_add_f32 v34, v34, v98
    v_add_f32 v35, v35, v99
    v_add_f32 v32, v32, v100
    v_add_f32 v33, v33, v101
    v_add_f32 v34, v34, v102
    v_add_f32 v35, v35, v103
    v_add_f32 v32, v32, v104
    v_add_f32 v33, v33, v105
    v_add_f32 v34, v34, v106
    v_add_f32 v35, v35, v107
    v_add_f32 v32, v32, v108
    v_add_f32 v33, v33, v109
    v_add_f32 v34, v34, v110
    v_add_f32 v35, v35, v111
    v_add_f32 v32, v32, v112
    v_add_f32 v33, v33, v113
    v_add_f32 v34, v34, v114
    v_add_f32 v35, v35, v115
    v_add_f32 v32, v32, v116
    v_add_f32 v33, v33, v117
    v_add_f32 v34, v34, v118
    v_add_f32 v35, v35, v119
    v_add_f32 v32, v32, v120
    v_add_f32 v33, v33, v121
    v_add_f32 v34, v34, v122
    v_add_f32 v35, v35, v123
    v_add_f32 v32, v32, v124
    v_add_f32 v33, v33, v125
    v_add_f32 v34, v34, v126
    v_add_f32 v35, v35, v127
    v_add_f32 v32, v32, v128
    v_add_f32 v33, v33, v129
    v_add_f32 v34, v34, v130
    v_add_f32 v35, v35, v131
    v_add_f32 v32, v32, v132
    v_add_f32 v33, v33, v133
    v_add_f32 v34, v34, v134
    v_add_f32 v35, v35, v135
    v_add_f32 v32, v32, v136
    v_add_f32 v33, v33, v137
    v_add_f32 v34, v34, v138
    v_add_f32 v35, v35, v139
    v_add_f32 v32, v32, v140
    v_add_f32 v33, v33, v141
    v_add_f32 v34, v34, v142
    v_add_f32 v35, v35, v143
    v_add_f32 v32, v32, v144
    v_add_f32 v33, v33, v145
    v_add_f32 v34, v34, v146
    v_add_f32 v35, v35, v147
    v_add_f32 v32, v32, v148
    v_add_f32 v33, v33, v149
    v_add_f32 v34, v34, v150
    v_add_f32 v35, v35, v151
    v_add_f32 v32, v32, v152
    v_add_f32 v33, v33, v153
    v_add_f32 v34, v34, v154
    v_add_f32 v35, v35, v155
    v_add_f32 v32, v32, v156
    v_add_f32 v33, v33, v157
    v_add_f32 v34, v34, v158
    v_add_f32 v35, v35, v159
    s_waitcnt vmcnt(0)
    v_add_f32 v160, v160, v161
    v_add_f32 v160, v160, v162
    v_add_f32 v160, v160, v163
    v_add_f32 v160, v160, v164
    v_add_f32 v160, v160, v165
    v_add_f32 v160, v160, v166
    v_add_f32 v160, v160, v167
    v_lshlrev_b32 v8, 8, v1
    v_lshl_add_u32 v8, v2, 2, v8
    ds_write_b32 v8, v160 offset:16384
    s_waitcnt lgkmcnt(0)
    s_barrier
    v_cvt_pk_bf16_f32 v36, v32, v33
    v_cvt_pk_bf16_f32 v37, v34, v35
    v_lshrrev_b32 v8, 2, v0
    v_and_b32 v9, 31, v8
    v_lshrrev_b32 v8, 5, v8
    v_and_b32 v10, 3, v0
    v_lshlrev_b32 v9, 6, v9
    v_lshl_add_u32 v9, v10, 4, v9
    v_lshl_add_u32 v9, v8, 3, v9
    ds_write_b64 v9, v[36:37] offset:17408
    v_lshlrev_b32 v7, 2, v0
    ds_read_b32 v40, v7 offset:16384
    ds_read_b32 v41, v7 offset:16512
    ds_read_b32 v42, v7 offset:16640
    ds_read_b32 v43, v7 offset:16768
    ds_read_b32 v44, v7 offset:16896
    ds_read_b32 v45, v7 offset:17024
    ds_read_b32 v46, v7 offset:17152
    ds_read_b32 v47, v7 offset:17280
    s_waitcnt lgkmcnt(0)
    v_add_f32 v40, v40, v41
    v_add_f32 v40, v40, v42
    v_add_f32 v40, v40, v43
    v_add_f32 v40, v40, v44
    v_add_f32 v40, v40, v45
    v_add_f32 v40, v40, v46
    v_add_f32 v40, v40, v47
    v_cmp_gt_u32 vcc, 32, v0
    s_and_saveexec_b64 s[22:23], vcc
    ds_write_b32 v7, v40 offset:19456
    s_mov_b64 exec, s[22:23]
    s_waitcnt lgkmcnt(0)
    s_barrier
    v_lshlrev_b32 v7, 6, v3
    v_lshl_add_u32 v7, v4, 4, v7
    ds_read_b128 v[32:35], v7 offset:17408
    ds_read_b128 v[36:39], v7 offset:17440
    v_lshlrev_b32 v7, 5, v4
    ds_read_b128 v[40:43], v7 offset:19456
    ds_read_b128 v[44:47], v7 offset:19472
    ds_read_b128 v[48:51], v7 offset:19520
    ds_read_b128 v[52:55], v7 offset:19536
    s_lshl_b32 s10, s8, 11
    s_lshl_b32 s11, s9, 8
    s_add_u32 s10, s10, s11
    v_lshl_add_u32 v8, v1, 6, v3
    v_add_u32 v9, s10, v8
    v_lshlrev_b32 v9, 6, v9
    v_lshl_add_u32 v9, v4, 4, v9
    v_add_u32 v10, s11, v8
    v_lshlrev_b32 v10, 11, v10
    s_lshl_b32 s12, s8, 6
    v_add_u32 v10, s12, v10
    v_lshl_add_u32 v10, v4, 3, v10
    v_lshlrev_b32 v11, 2, v2
    v_xor_b32 v11, 128, v11
    global_load_dwordx4 v[64:67], v9, s[4:5] offset:0
    global_load_dwordx4 v[68:71], v9, s[4:5] offset:32
    global_load_dwordx4 v[72:75], v9, s[4:5] offset:2048
    global_load_dwordx4 v[76:79], v9, s[4:5] offset:2080
    s_waitcnt vmcnt(0) lgkmcnt(0)
    v_mfma_f32_32x32x16_bf16 v[16:31], v[32:35], v[64:67], 0
    v_mfma_f32_32x32x16_bf16 v[16:31], v[36:39], v[68:71], v[16:31]
    v_mov_b32 v12, 0
    v_lshlrev_b32 v13, 16, v64
    v_and_b32 v14, 0xffff0000, v64
    v_fmac_f32 v12, v13, v40
    v_fmac_f32 v12, v14, v41
    v_lshlrev_b32 v13, 16, v65
    v_and_b32 v14, 0xffff0000, v65
    v_fmac_f32 v12, v13, v42
    v_fmac_f32 v12, v14, v43
    v_lshlrev_b32 v13, 16, v66
    v_and_b32 v14, 0xffff0000, v66
    v_fmac_f32 v12, v13, v44
    v_fmac_f32 v12, v14, v45
    v_lshlrev_b32 v13, 16, v67
    v_and_b32 v14, 0xffff0000, v67
    v_fmac_f32 v12, v13, v46
    v_fmac_f32 v12, v14, v47
    v_lshlrev_b32 v13, 16, v68
    v_and_b32 v14, 0xffff0000, v68
    v_fmac_f32 v12, v13, v48
    v_fmac_f32 v12, v14, v49
    v_lshlrev_b32 v13, 16, v69
    v_and_b32 v14, 0xffff0000, v69
    v_fmac_f32 v12, v13, v50
    v_fmac_f32 v12, v14, v51
    v_lshlrev_b32 v13, 16, v70
    v_and_b32 v14, 0xffff0000, v70
    v_fmac_f32 v12, v13, v52
    v_fmac_f32 v12, v14, v53
    v_lshlrev_b32 v13, 16, v71
    v_and_b32 v14, 0xffff0000, v71
    v_fmac_f32 v12, v13, v54
    v_fmac_f32 v12, v14, v55
    ds_bpermute_b32 v13, v11, v12
    s_waitcnt lgkmcnt(0)
    v_add_f32 v12, v12, v13
    v_add_f32 v12, 0x358637bd, v12
    v_rcp_f32 v12, v12
    s_nop 7
    v_mul_f32 v16, v16, v12
    v_mul_f32 v17, v17, v12
    v_mul_f32 v18, v18, v12
    v_mul_f32 v19, v19, v12
    v_mul_f32 v20, v20, v12
    v_mul_f32 v21, v21, v12
    v_mul_f32 v22, v22, v12
    v_mul_f32 v23, v23, v12
    v_mul_f32 v24, v24, v12
    v_mul_f32 v25, v25, v12
    v_mul_f32 v26, v26, v12
    v_mul_f32 v27, v27, v12
    v_mul_f32 v28, v28, v12
    v_mul_f32 v29, v29, v12
    v_mul_f32 v30, v30, v12
    v_mul_f32 v31, v31, v12
    v_cvt_pk_bf16_f32 v80, v16, v17
    v_cvt_pk_bf16_f32 v81, v18, v19
    v_cvt_pk_bf16_f32 v82, v20, v21
    v_cvt_pk_bf16_f32 v83, v22, v23
    v_cvt_pk_bf16_f32 v84, v24, v25
    v_cvt_pk_bf16_f32 v85, v26, v27
    v_cvt_pk_bf16_f32 v86, v28, v29
    v_cvt_pk_bf16_f32 v87, v30, v31
    global_store_dwordx2 v10, v[80:81], s[18:19] offset:0
    global_store_dwordx2 v10, v[82:83], s[18:19] offset:16
    global_store_dwordx2 v10, v[84:85], s[18:19] offset:32
    global_store_dwordx2 v10, v[86:87], s[18:19] offset:48
    v_add_u32 v10, 65536, v10
    s_nop 7
    v_mfma_f32_32x32x16_bf16 v[16:31], v[32:35], v[72:75], 0
    v_mfma_f32_32x32x16_bf16 v[16:31], v[36:39], v[76:79], v[16:31]
    v_mov_b32 v12, 0
    v_lshlrev_b32 v13, 16, v72
    v_and_b32 v14, 0xffff0000, v72
    v_fmac_f32 v12, v13, v40
    v_fmac_f32 v12, v14, v41
    v_lshlrev_b32 v13, 16, v73
    v_and_b32 v14, 0xffff0000, v73
    v_fmac_f32 v12, v13, v42
    v_fmac_f32 v12, v14, v43
    v_lshlrev_b32 v13, 16, v74
    v_and_b32 v14, 0xffff0000, v74
    v_fmac_f32 v12, v13, v44
    v_fmac_f32 v12, v14, v45
    v_lshlrev_b32 v13, 16, v75
    v_and_b32 v14, 0xffff0000, v75
    v_fmac_f32 v12, v13, v46
    v_fmac_f32 v12, v14, v47
    v_lshlrev_b32 v13, 16, v76
    v_and_b32 v14, 0xffff0000, v76
    v_fmac_f32 v12, v13, v48
    v_fmac_f32 v12, v14, v49
    v_lshlrev_b32 v13, 16, v77
    v_and_b32 v14, 0xffff0000, v77
    v_fmac_f32 v12, v13, v50
    v_fmac_f32 v12, v14, v51
    v_lshlrev_b32 v13, 16, v78
    v_and_b32 v14, 0xffff0000, v78
    v_fmac_f32 v12, v13, v52
    v_fmac_f32 v12, v14, v53
    v_lshlrev_b32 v13, 16, v79
    v_and_b32 v14, 0xffff0000, v79
    v_fmac_f32 v12, v13, v54
    v_fmac_f32 v12, v14, v55
    ds_bpermute_b32 v13, v11, v12
    s_waitcnt lgkmcnt(0)
    v_add_f32 v12, v12, v13
    v_add_f32 v12, 0x358637bd, v12
    v_rcp_f32 v12, v12
    s_nop 7
    v_mul_f32 v16, v16, v12
    v_mul_f32 v17, v17, v12
    v_mul_f32 v18, v18, v12
    v_mul_f32 v19, v19, v12
    v_mul_f32 v20, v20, v12
    v_mul_f32 v21, v21, v12
    v_mul_f32 v22, v22, v12
    v_mul_f32 v23, v23, v12
    v_mul_f32 v24, v24, v12
    v_mul_f32 v25, v25, v12
    v_mul_f32 v26, v26, v12
    v_mul_f32 v27, v27, v12
    v_mul_f32 v28, v28, v12
    v_mul_f32 v29, v29, v12
    v_mul_f32 v30, v30, v12
    v_mul_f32 v31, v31, v12
    v_cvt_pk_bf16_f32 v80, v16, v17
    v_cvt_pk_bf16_f32 v81, v18, v19
    v_cvt_pk_bf16_f32 v82, v20, v21
    v_cvt_pk_bf16_f32 v83, v22, v23
    v_cvt_pk_bf16_f32 v84, v24, v25
    v_cvt_pk_bf16_f32 v85, v26, v27
    v_cvt_pk_bf16_f32 v86, v28, v29
    v_cvt_pk_bf16_f32 v87, v30, v31
    global_store_dwordx2 v10, v[80:81], s[18:19] offset:0
    global_store_dwordx2 v10, v[82:83], s[18:19] offset:16
    global_store_dwordx2 v10, v[84:85], s[18:19] offset:32
    global_store_dwordx2 v10, v[86:87], s[18:19] offset:48
    s_nop 7
L_atta0_end:
    s_endpgm
.globl wo0_kernel
.p2align 8
.type wo0_kernel,@function
wo0_kernel:
    s_cmp_ge_u32 s2, 256
    s_cbranch_scc1 L_wo0_end
    s_load_dwordx2 s[4:5], s[0:1], 64
    s_load_dwordx2 s[6:7], s[0:1], 16
    s_load_dwordx2 s[14:15], s[0:1], 64
    s_waitcnt lgkmcnt(0)
    s_add_u32 s4, s4, 20971520
    s_addc_u32 s5, s5, 0
    s_add_u32 s14, s14, 4194304
    s_addc_u32 s15, s15, 0
    s_lshr_b32 s8, s2, 4
    s_and_b32 s9, s2, 15
    v_lshrrev_b32 v1, 3, v0
    v_and_b32 v2, 7, v0
    s_lshl_b32 s10, s8, 7
    v_add_u32 v3, s10, v1
    v_lshlrev_b32 v3, 11, v3
    v_lshl_add_u32 v3, v2, 4, v3
    v_add_u32 v4, 0, v3
    v_add_u32 v5, 65536, v3
    v_add_u32 v6, 131072, v3
    v_add_u32 v7, 196608, v3
    s_mov_b32 s11, 2048
    v_mul_lo_u32 v3, v1, s11
    v_lshl_add_u32 v3, v2, 4, v3
    s_lshl_b32 s12, s9, 7
    v_add_u32 v3, s12, v3
    v_add_u32 v8, 0, v3
    v_add_u32 v9, 65536, v3
    v_mul_u32_u24 v14, 144, v1
    v_lshl_add_u32 v14, v2, 4, v14
    v_mul_u32_u24 v15, 192, v1
    v_lshl_add_u32 v15, v2, 4, v15
    v_add_u32 v15, 18432, v15
    v_and_b32 v16, 63, v0
    v_lshrrev_b32 v17, 6, v0
    v_lshrrev_b32 v18, 1, v17
    v_and_b32 v19, 1, v17
    v_and_b32 v20, 31, v16
    v_lshrrev_b32 v21, 5, v16
    v_lshl_add_u32 v22, v18, 6, v20
    v_mul_u32_u24 v22, 144, v22
    v_lshl_add_u32 v22, v21, 4, v22
    v_bfe_u32 v23, v16, 2, 2
    v_lshl_add_u32 v23, v21, 3, v23
    v_mul_u32_u24 v23, 192, v23
    v_bfe_u32 v24, v16, 4, 1
    v_lshlrev_b32 v24, 5, v24
    v_lshl_add_u32 v24, v19, 6, v24
    v_and_b32 v25, 3, v16
    v_lshl_add_u32 v24, v25, 3, v24
    v_add_u32 v23, v23, v24
    v_add_u32 v23, 18432, v23
    v_add_u32 v24, 30720, v22
    v_add_u32 v25, 30720, v23
    v_mov_b32 v160, 0
    v_mov_b32 v161, 0
    v_mov_b32 v162, 0
    v_mov_b32 v163, 0
    v_mov_b32 v164, 0
    v_mov_b32 v165, 0
    v_mov_b32 v166, 0
    v_mov_b32 v167, 0
    v_mov_b32 v168, 0
    v_mov_b32 v169, 0
    v_mov_b32 v170, 0
    v_mov_b32 v171, 0
    v_mov_b32 v172, 0
    v_mov_b32 v173, 0
    v_mov_b32 v174, 0
    v_mov_b32 v175, 0
    v_mov_b32 v176, 0
    v_mov_b32 v177, 0
    v_mov_b32 v178, 0
    v_mov_b32 v179, 0
    v_mov_b32 v180, 0
    v_mov_b32 v181, 0
    v_mov_b32 v182, 0
    v_mov_b32 v183, 0
    v_mov_b32 v184, 0
    v_mov_b32 v185, 0
    v_mov_b32 v186, 0
    v_mov_b32 v187, 0
    v_mov_b32 v188, 0
    v_mov_b32 v189, 0
    v_mov_b32 v190, 0
    v_mov_b32 v191, 0
    global_load_dwordx4 v[40:43], v4, s[4:5]
    global_load_dwordx4 v[44:47], v5, s[4:5]
    global_load_dwordx4 v[48:51], v6, s[4:5]
    global_load_dwordx4 v[52:55], v7, s[4:5]
    global_load_dwordx4 v[56:59], v8, s[6:7]
    global_load_dwordx4 v[60:63], v9, s[6:7]
    s_add_u32 s4, s4, 128
    s_addc_u32 s5, s5, 0
    s_add_u32 s6, s6, 131072
    s_addc_u32 s7, s7, 0
    global_load_dwordx4 v[64:67], v4, s[4:5]
    global_load_dwordx4 v[68:71], v5, s[4:5]
    global_load_dwordx4 v[72:75], v6, s[4:5]
    global_load_dwordx4 v[76:79], v7, s[4:5]
    global_load_dwordx4 v[80:83], v8, s[6:7]
    global_load_dwordx4 v[84:87], v9, s[6:7]
    s_add_u32 s4, s4, 128
    s_addc_u32 s5, s5, 0
    s_add_u32 s6, s6, 131072
    s_addc_u32 s7, s7, 0
    global_load_dwordx4 v[88:91], v4, s[4:5]
    global_load_dwordx4 v[92:95], v5, s[4:5]
    global_load_dwordx4 v[96:99], v6, s[4:5]
    global_load_dwordx4 v[100:103], v7, s[4:5]
    global_load_dwordx4 v[104:107], v8, s[6:7]
    global_load_dwordx4 v[108:111], v9, s[6:7]
    s_add_u32 s4, s4, 128
    s_addc_u32 s5, s5, 0
    s_add_u32 s6, s6, 131072
    s_addc_u32 s7, s7, 0
    global_load_dwordx4 v[112:115], v4, s[4:5]
    global_load_dwordx4 v[116:119], v5, s[4:5]
    global_load_dwordx4 v[120:123], v6, s[4:5]
    global_load_dwordx4 v[124:127], v7, s[4:5]
    global_load_dwordx4 v[128:131], v8, s[6:7]
    global_load_dwordx4 v[132:135], v9, s[6:7]
    s_add_u32 s4, s4, 128
    s_addc_u32 s5, s5, 0
    s_add_u32 s6, s6, 131072
    s_addc_u32 s7, s7, 0
    s_waitcnt vmcnt(18)
    ds_write_b128 v14, v[40:43] offset:0
    ds_write_b128 v14, v[44:47] offset:4608
    ds_write_b128 v14, v[48:51] offset:9216
    ds_write_b128 v14, v[52:55] offset:13824
    ds_write_b128 v15, v[56:59] offset:0
    ds_write_b128 v15, v[60:63] offset:6144
    s_waitcnt lgkmcnt(0)
    s_barrier
    ds_read_b128 v[208:211], v22 offset:0
    ds_read_b128 v[212:215], v22 offset:4608
    ds_read_b64_tr_b16 v[192:193], v23 offset:0
    ds_read_b64_tr_b16 v[194:195], v23 offset:768
    ds_read_b128 v[216:219], v22 offset:32
    ds_read_b128 v[220:223], v22 offset:4640
    ds_read_b64_tr_b16 v[196:197], v23 offset:3072
    ds_read_b64_tr_b16 v[198:199], v23 offset:3840
    ds_read_b128 v[224:227], v22 offset:64
    ds_read_b128 v[228:231], v22 offset:4672
    ds_read_b64_tr_b16 v[200:201], v23 offset:6144
    ds_read_b64_tr_b16 v[202:203], v23 offset:6912
    ds_read_b128 v[232:235], v22 offset:96
    ds_read_b128 v[236:239], v22 offset:4704
    ds_read_b64_tr_b16 v[204:205], v23 offset:9216
    ds_read_b64_tr_b16 v[206:207], v23 offset:9984
    s_mov_b32 s20, 0
L_wo0_loop:
    s_waitcnt lgkmcnt(12)
    v_mfma_f32_32x32x16_bf16 v[160:175], v[192:195], v[208:211], v[160:175]
    global_load_dwordx4 v[40:43], v4, s[4:5]
    global_load_dwordx4 v[44:47], v5, s[4:5]
    global_load_dwordx4 v[48:51], v6, s[4:5]
    v_mfma_f32_32x32x16_bf16 v[176:191], v[192:195], v[212:215], v[176:191]
    global_load_dwordx4 v[52:55], v7, s[4:5]
    global_load_dwordx4 v[56:59], v8, s[6:7]
    s_waitcnt lgkmcnt(8)
    v_mfma_f32_32x32x16_bf16 v[160:175], v[196:199], v[216:219], v[160:175]
    global_load_dwordx4 v[60:63], v9, s[6:7]
    s_add_u32 s4, s4, 128
    v_mfma_f32_32x32x16_bf16 v[176:191], v[196:199], v[220:223], v[176:191]
    s_addc_u32 s5, s5, 0
    s_add_u32 s6, s6, 131072
    s_waitcnt lgkmcnt(4)
    v_mfma_f32_32x32x16_bf16 v[160:175], v[200:203], v[224:227], v[160:175]
    s_addc_u32 s7, s7, 0
    s_waitcnt vmcnt(18)
    v_mfma_f32_32x32x16_bf16 v[176:191], v[200:203], v[228:231], v[176:191]
    ds_write_b128 v14, v[64:67] offset:30720
    ds_write_b128 v14, v[68:71] offset:35328
    s_waitcnt lgkmcnt(2)
    v_mfma_f32_32x32x16_bf16 v[160:175], v[204:207], v[232:235], v[160:175]
    ds_write_b128 v14, v[72:75] offset:39936
    ds_write_b128 v14, v[76:79] offset:44544
    v_mfma_f32_32x32x16_bf16 v[176:191], v[204:207], v[236:239], v[176:191]
    ds_write_b128 v15, v[80:83] offset:30720
    ds_write_b128 v15, v[84:87] offset:36864
    s_waitcnt lgkmcnt(0)
    s_barrier
    ds_read_b128 v[208:211], v24 offset:0
    ds_read_b128 v[212:215], v24 offset:4608
    ds_read_b64_tr_b16 v[192:193], v25 offset:0
    ds_read_b64_tr_b16 v[194:195], v25 offset:768
    ds_read_b128 v[216:219], v24 offset:32
    ds_read_b128 v[220:223], v24 offset:4640
    ds_read_b64_tr_b16 v[196:197], v25 offset:3072
    ds_read_b64_tr_b16 v[198:199], v25 offset:3840
    ds_read_b128 v[224:227], v24 offset:64
    ds_read_b128 v[228:231], v24 offset:4672
    ds_read_b64_tr_b16 v[200:201], v25 offset:6144
    ds_read_b64_tr_b16 v[202:203], v25 offset:6912
    ds_read_b128 v[232:235], v24 offset:96
    ds_read_b128 v[236:239], v24 offset:4704
    ds_read_b64_tr_b16 v[204:205], v25 offset:9216
    ds_read_b64_tr_b16 v[206:207], v25 offset:9984
    s_waitcnt lgkmcnt(12)
    v_mfma_f32_32x32x16_bf16 v[160:175], v[192:195], v[208:211], v[160:175]
    global_load_dwordx4 v[64:67], v4, s[4:5]
    global_load_dwordx4 v[68:71], v5, s[4:5]
    global_load_dwordx4 v[72:75], v6, s[4:5]
    v_mfma_f32_32x32x16_bf16 v[176:191], v[192:195], v[212:215], v[176:191]
    global_load_dwordx4 v[76:79], v7, s[4:5]
    global_load_dwordx4 v[80:83], v8, s[6:7]
    s_waitcnt lgkmcnt(8)
    v_mfma_f32_32x32x16_bf16 v[160:175], v[196:199], v[216:219], v[160:175]
    global_load_dwordx4 v[84:87], v9, s[6:7]
    s_add_u32 s4, s4, 128
    v_mfma_f32_32x32x16_bf16 v[176:191], v[196:199], v[220:223], v[176:191]
    s_addc_u32 s5, s5, 0
    s_add_u32 s6, s6, 131072
    s_waitcnt lgkmcnt(4)
    v_mfma_f32_32x32x16_bf16 v[160:175], v[200:203], v[224:227], v[160:175]
    s_addc_u32 s7, s7, 0
    s_waitcnt vmcnt(18)
    v_mfma_f32_32x32x16_bf16 v[176:191], v[200:203], v[228:231], v[176:191]
    ds_write_b128 v14, v[88:91] offset:0
    ds_write_b128 v14, v[92:95] offset:4608
    s_waitcnt lgkmcnt(2)
    v_mfma_f32_32x32x16_bf16 v[160:175], v[204:207], v[232:235], v[160:175]
    ds_write_b128 v14, v[96:99] offset:9216
    ds_write_b128 v14, v[100:103] offset:13824
    v_mfma_f32_32x32x16_bf16 v[176:191], v[204:207], v[236:239], v[176:191]
    ds_write_b128 v15, v[104:107] offset:0
    ds_write_b128 v15, v[108:111] offset:6144
    s_waitcnt lgkmcnt(0)
    s_barrier
    ds_read_b128 v[208:211], v22 offset:0
    ds_read_b128 v[212:215], v22 offset:4608
    ds_read_b64_tr_b16 v[192:193], v23 offset:0
    ds_read_b64_tr_b16 v[194:195], v23 offset:768
    ds_read_b128 v[216:219], v22 offset:32
    ds_read_b128 v[220:223], v22 offset:4640
    ds_read_b64_tr_b16 v[196:197], v23 offset:3072
    ds_read_b64_tr_b16 v[198:199], v23 offset:3840
    ds_read_b128 v[224:227], v22 offset:64
    ds_read_b128 v[228:231], v22 offset:4672
    ds_read_b64_tr_b16 v[200:201], v23 offset:6144
    ds_read_b64_tr_b16 v[202:203], v23 offset:6912
    ds_read_b128 v[232:235], v22 offset:96
    ds_read_b128 v[236:239], v22 offset:4704
    ds_read_b64_tr_b16 v[204:205], v23 offset:9216
    ds_read_b64_tr_b16 v[206:207], v23 offset:9984
    s_waitcnt lgkmcnt(12)
    v_mfma_f32_32x32x16_bf16 v[160:175], v[192:195], v[208:211], v[160:175]
    global_load_dwordx4 v[88:91], v4, s[4:5]
    global_load_dwordx4 v[92:95], v5, s[4:5]
    global_load_dwordx4 v[96:99], v6, s[4:5]
    v_mfma_f32_32x32x16_bf16 v[176:191], v[192:195], v[212:215], v[176:191]
    global_load_dwordx4 v[100:103], v7, s[4:5]
    global_load_dwordx4 v[104:107], v8, s[6:7]
    s_waitcnt lgkmcnt(8)
    v_mfma_f32_32x32x16_bf16 v[160:175], v[196:199], v[216:219], v[160:175]
    global_load_dwordx4 v[108:111], v9, s[6:7]
    s_add_u32 s4, s4, 128
    v_mfma_f32_32x32x16_bf16 v[176:191], v[196:199], v[220:223], v[176:191]
    s_addc_u32 s5, s5, 0
    s_add_u32 s6, s6, 131072
    s_waitcnt lgkmcnt(4)
    v_mfma_f32_32x32x16_bf16 v[160:175], v[200:203], v[224:227], v[160:175]
    s_addc_u32 s7, s7, 0
    s_waitcnt vmcnt(18)
    v_mfma_f32_32x32x16_bf16 v[176:191], v[200:203], v[228:231], v[176:191]
    ds_write_b128 v14, v[112:115] offset:30720
    ds_write_b128 v14, v[116:119] offset:35328
    s_waitcnt lgkmcnt(2)
    v_mfma_f32_32x32x16_bf16 v[160:175], v[204:207], v[232:235], v[160:175]
    ds_write_b128 v14, v[120:123] offset:39936
    ds_write_b128 v14, v[124:127] offset:44544
    v_mfma_f32_32x32x16_bf16 v[176:191], v[204:207], v[236:239], v[176:191]
    ds_write_b128 v15, v[128:131] offset:30720
    ds_write_b128 v15, v[132:135] offset:36864
    s_waitcnt lgkmcnt(0)
    s_barrier
    ds_read_b128 v[208:211], v24 offset:0
    ds_read_b128 v[212:215], v24 offset:4608
    ds_read_b64_tr_b16 v[192:193], v25 offset:0
    ds_read_b64_tr_b16 v[194:195], v25 offset:768
    ds_read_b128 v[216:219], v24 offset:32
    ds_read_b128 v[220:223], v24 offset:4640
    ds_read_b64_tr_b16 v[196:197], v25 offset:3072
    ds_read_b64_tr_b16 v[198:199], v25 offset:3840
    ds_read_b128 v[224:227], v24 offset:64
    ds_read_b128 v[228:231], v24 offset:4672
    ds_read_b64_tr_b16 v[200:201], v25 offset:6144
    ds_read_b64_tr_b16 v[202:203], v25 offset:6912
    ds_read_b128 v[232:235], v24 offset:96
    ds_read_b128 v[236:239], v24 offset:4704
    ds_read_b64_tr_b16 v[204:205], v25 offset:9216
    ds_read_b64_tr_b16 v[206:207], v25 offset:9984
    s_waitcnt lgkmcnt(12)
    v_mfma_f32_32x32x16_bf16 v[160:175], v[192:195], v[208:211], v[160:175]
    global_load_dwordx4 v[112:115], v4, s[4:5]
    global_load_dwordx4 v[116:119], v5, s[4:5]
    global_load_dwordx4 v[120:123], v6, s[4:5]
    v_mfma_f32_32x32x16_bf16 v[176:191], v[192:195], v[212:215], v[176:191]
    global_load_dwordx4 v[124:127], v7, s[4:5]
    global_load_dwordx4 v[128:131], v8, s[6:7]
    s_waitcnt lgkmcnt(8)
    v_mfma_f32_32x32x16_bf16 v[160:175], v[196:199], v[216:219], v[160:175]
    global_load_dwordx4 v[132:135], v9, s[6:7]
    s_add_u32 s4, s4, 128
    v_mfma_f32_32x32x16_bf16 v[176:191], v[196:199], v[220:223], v[176:191]
    s_addc_u32 s5, s5, 0
    s_add_u32 s6, s6, 131072
    s_waitcnt lgkmcnt(4)
    v_mfma_f32_32x32x16_bf16 v[160:175], v[200:203], v[224:227], v[160:175]
    s_addc_u32 s7, s7, 0
    s_waitcnt vmcnt(18)
    v_mfma_f32_32x32x16_bf16 v[176:191], v[200:203], v[228:231], v[176:191]
    ds_write_b128 v14, v[40:43] offset:0
    ds_write_b128 v14, v[44:47] offset:4608
    s_waitcnt lgkmcnt(2)
    v_mfma_f32_32x32x16_bf16 v[160:175], v[204:207], v[232:235], v[160:175]
    ds_write_b128 v14, v[48:51] offset:9216
    ds_write_b128 v14, v[52:55] offset:13824
    v_mfma_f32_32x32x16_bf16 v[176:191], v[204:207], v[236:239], v[176:191]
    ds_write_b128 v15, v[56:59] offset:0
    ds_write_b128 v15, v[60:63] offset:6144
    s_waitcnt lgkmcnt(0)
    s_barrier
    ds_read_b128 v[208:211], v22 offset:0
    ds_read_b128 v[212:215], v22 offset:4608
    ds_read_b64_tr_b16 v[192:193], v23 offset:0
    ds_read_b64_tr_b16 v[194:195], v23 offset:768
    ds_read_b128 v[216:219], v22 offset:32
    ds_read_b128 v[220:223], v22 offset:4640
    ds_read_b64_tr_b16 v[196:197], v23 offset:3072
    ds_read_b64_tr_b16 v[198:199], v23 offset:3840
    ds_read_b128 v[224:227], v22 offset:64
    ds_read_b128 v[228:231], v22 offset:4672
    ds_read_b64_tr_b16 v[200:201], v23 offset:6144
    ds_read_b64_tr_b16 v[202:203], v23 offset:6912
    ds_read_b128 v[232:235], v22 offset:96
    ds_read_b128 v[236:239], v22 offset:4704
    ds_read_b64_tr_b16 v[204:205], v23 offset:9216
    ds_read_b64_tr_b16 v[206:207], v23 offset:9984
    s_add_u32 s20, s20, 4
    s_cmp_lt_u32 s20, 12
    s_cbranch_scc1 L_wo0_loop
    s_waitcnt lgkmcnt(12)
    v_mfma_f32_32x32x16_bf16 v[160:175], v[192:195], v[208:211], v[160:175]
    s_waitcnt vmcnt(12)
    v_mfma_f32_32x32x16_bf16 v[176:191], v[192:195], v[212:215], v[176:191]
    ds_write_b128 v14, v[64:67] offset:30720
    s_waitcnt lgkmcnt(9)
    v_mfma_f32_32x32x16_bf16 v[160:175], v[196:199], v[216:219], v[160:175]
    ds_write_b128 v14, v[68:71] offset:35328
    v_mfma_f32_32x32x16_bf16 v[176:191], v[196:199], v[220:223], v[176:191]
    ds_write_b128 v14, v[72:75] offset:39936
    s_waitcnt lgkmcnt(7)
    v_mfma_f32_32x32x16_bf16 v[160:175], v[200:203], v[224:227], v[160:175]
    ds_write_b128 v14, v[76:79] offset:44544
    v_mfma_f32_32x32x16_bf16 v[176:191], v[200:203], v[228:231], v[176:191]
    ds_write_b128 v15, v[80:83] offset:30720
    s_waitcnt lgkmcnt(5)
    v_mfma_f32_32x32x16_bf16 v[160:175], v[204:207], v[232:235], v[160:175]
    ds_write_b128 v15, v[84:87] offset:36864
    v_mfma_f32_32x32x16_bf16 v[176:191], v[204:207], v[236:239], v[176:191]
    s_waitcnt lgkmcnt(0)
    s_barrier
    ds_read_b128 v[208:211], v24 offset:0
    ds_read_b128 v[212:215], v24 offset:4608
    ds_read_b64_tr_b16 v[192:193], v25 offset:0
    ds_read_b64_tr_b16 v[194:195], v25 offset:768
    ds_read_b128 v[216:219], v24 offset:32
    ds_read_b128 v[220:223], v24 offset:4640
    ds_read_b64_tr_b16 v[196:197], v25 offset:3072
    ds_read_b64_tr_b16 v[198:199], v25 offset:3840
    ds_read_b128 v[224:227], v24 offset:64
    ds_read_b128 v[228:231], v24 offset:4672
    ds_read_b64_tr_b16 v[200:201], v25 offset:6144
    ds_read_b64_tr_b16 v[202:203], v25 offset:6912
    ds_read_b128 v[232:235], v24 offset:96
    ds_read_b128 v[236:239], v24 offset:4704
    ds_read_b64_tr_b16 v[204:205], v25 offset:9216
    ds_read_b64_tr_b16 v[206:207], v25 offset:9984
    s_waitcnt lgkmcnt(12)
    v_mfma_f32_32x32x16_bf16 v[160:175], v[192:195], v[208:211], v[160:175]
    s_waitcnt vmcnt(6)
    v_mfma_f32_32x32x16_bf16 v[176:191], v[192:195], v[212:215], v[176:191]
    ds_write_b128 v14, v[88:91] offset:0
    s_waitcnt lgkmcnt(9)
    v_mfma_f32_32x32x16_bf16 v[160:175], v[196:199], v[216:219], v[160:175]
    ds_write_b128 v14, v[92:95] offset:4608
    v_mfma_f32_32x32x16_bf16 v[176:191], v[196:199], v[220:223], v[176:191]
    ds_write_b128 v14, v[96:99] offset:9216
    s_waitcnt lgkmcnt(7)
    v_mfma_f32_32x32x16_bf16 v[160:175], v[200:203], v[224:227], v[160:175]
    ds_write_b128 v14, v[100:103] offset:13824
    v_mfma_f32_32x32x16_bf16 v[176:191], v[200:203], v[228:231], v[176:191]
    ds_write_b128 v15, v[104:107] offset:0
    s_waitcnt lgkmcnt(5)
    v_mfma_f32_32x32x16_bf16 v[160:175], v[204:207], v[232:235], v[160:175]
    ds_write_b128 v15, v[108:111] offset:6144
    v_mfma_f32_32x32x16_bf16 v[176:191], v[204:207], v[236:239], v[176:191]
    s_waitcnt lgkmcnt(0)
    s_barrier
    ds_read_b128 v[208:211], v22 offset:0
    ds_read_b128 v[212:215], v22 offset:4608
    ds_read_b64_tr_b16 v[192:193], v23 offset:0
    ds_read_b64_tr_b16 v[194:195], v23 offset:768
    ds_read_b128 v[216:219], v22 offset:32
    ds_read_b128 v[220:223], v22 offset:4640
    ds_read_b64_tr_b16 v[196:197], v23 offset:3072
    ds_read_b64_tr_b16 v[198:199], v23 offset:3840
    ds_read_b128 v[224:227], v22 offset:64
    ds_read_b128 v[228:231], v22 offset:4672
    ds_read_b64_tr_b16 v[200:201], v23 offset:6144
    ds_read_b64_tr_b16 v[202:203], v23 offset:6912
    ds_read_b128 v[232:235], v22 offset:96
    ds_read_b128 v[236:239], v22 offset:4704
    ds_read_b64_tr_b16 v[204:205], v23 offset:9216
    ds_read_b64_tr_b16 v[206:207], v23 offset:9984
    s_waitcnt lgkmcnt(12)
    v_mfma_f32_32x32x16_bf16 v[160:175], v[192:195], v[208:211], v[160:175]
    s_waitcnt vmcnt(0)
    v_mfma_f32_32x32x16_bf16 v[176:191], v[192:195], v[212:215], v[176:191]
    ds_write_b128 v14, v[112:115] offset:30720
    s_waitcnt lgkmcnt(9)
    v_mfma_f32_32x32x16_bf16 v[160:175], v[196:199], v[216:219], v[160:175]
    ds_write_b128 v14, v[116:119] offset:35328
    v_mfma_f32_32x32x16_bf16 v[176:191], v[196:199], v[220:223], v[176:191]
    ds_write_b128 v14, v[120:123] offset:39936
    s_waitcnt lgkmcnt(7)
    v_mfma_f32_32x32x16_bf16 v[160:175], v[200:203], v[224:227], v[160:175]
    ds_write_b128 v14, v[124:127] offset:44544
    v_mfma_f32_32x32x16_bf16 v[176:191], v[200:203], v[228:231], v[176:191]
    ds_write_b128 v15, v[128:131] offset:30720
    s_waitcnt lgkmcnt(5)
    v_mfma_f32_32x32x16_bf16 v[160:175], v[204:207], v[232:235], v[160:175]
    ds_write_b128 v15, v[132:135] offset:36864
    v_mfma_f32_32x32x16_bf16 v[176:191], v[204:207], v[236:239], v[176:191]
    s_waitcnt lgkmcnt(0)
    s_barrier
    ds_read_b128 v[208:211], v24 offset:0
    ds_read_b128 v[212:215], v24 offset:4608
    ds_read_b64_tr_b16 v[192:193], v25 offset:0
    ds_read_b64_tr_b16 v[194:195], v25 offset:768
    ds_read_b128 v[216:219], v24 offset:32
    ds_read_b128 v[220:223], v24 offset:4640
    ds_read_b64_tr_b16 v[196:197], v25 offset:3072
    ds_read_b64_tr_b16 v[198:199], v25 offset:3840
    ds_read_b128 v[224:227], v24 offset:64
    ds_read_b128 v[228:231], v24 offset:4672
    ds_read_b64_tr_b16 v[200:201], v25 offset:6144
    ds_read_b64_tr_b16 v[202:203], v25 offset:6912
    ds_read_b128 v[232:235], v24 offset:96
    ds_read_b128 v[236:239], v24 offset:4704
    ds_read_b64_tr_b16 v[204:205], v25 offset:9216
    ds_read_b64_tr_b16 v[206:207], v25 offset:9984
    s_waitcnt lgkmcnt(12)
    v_mfma_f32_32x32x16_bf16 v[160:175], v[192:195], v[208:211], v[160:175]
    v_mfma_f32_32x32x16_bf16 v[176:191], v[192:195], v[212:215], v[176:191]
    s_waitcnt lgkmcnt(8)
    v_mfma_f32_32x32x16_bf16 v[160:175], v[196:199], v[216:219], v[160:175]
    v_mfma_f32_32x32x16_bf16 v[176:191], v[196:199], v[220:223], v[176:191]
    s_waitcnt lgkmcnt(4)
    v_mfma_f32_32x32x16_bf16 v[160:175], v[200:203], v[224:227], v[160:175]
    v_mfma_f32_32x32x16_bf16 v[176:191], v[200:203], v[228:231], v[176:191]
    s_waitcnt lgkmcnt(0)
    v_mfma_f32_32x32x16_bf16 v[160:175], v[204:207], v[232:235], v[160:175]
    v_mfma_f32_32x32x16_bf16 v[176:191], v[204:207], v[236:239], v[176:191]
    s_nop 15
    s_nop 7
    s_load_dwordx2 s[14:15], s[0:1], 0
    s_load_dwordx2 s[16:17], s[0:1], 64
    s_load_dwordx2 s[18:19], s[0:1], 64
    s_waitcnt lgkmcnt(0)
    s_add_u32 s18, s18, 4194304
    s_addc_u32 s19, s19, 0
    s_barrier
    v_lshlrev_b32 v24, 13, v17
    v_lshl_add_u32 v22, v20, 7, v24
    v_lshl_add_u32 v22, v21, 4, v22
    ds_write_b128 v22, v[160:163] offset:0
    ds_write_b128 v22, v[164:167] offset:32
    ds_write_b128 v22, v[168:171] offset:64
    ds_write_b128 v22, v[172:175] offset:96
    ds_write_b128 v22, v[176:179] offset:4096
    ds_write_b128 v22, v[180:183] offset:4128
    ds_write_b128 v22, v[184:187] offset:4160
    ds_write_b128 v22, v[188:191] offset:4192
    v_lshl_add_u32 v23, v16, 5, v24
    v_lshrrev_b32 v25, 2, v16
    v_and_b32 v26, 3, v16
    v_lshl_add_u32 v27, v18, 6, s10
    v_add_u32 v27, v27, v25
    s_lshl_b32 s12, s9, 6
    v_lshl_add_u32 v28, v19, 5, s12
    v_lshl_add_u32 v28, v26, 3, v28
    v_lshlrev_b32 v29, 10, v27
    v_add_u32 v29, v29, v28
    v_lshlrev_b32 v29, 1, v29
    s_lshl_b32 s13, s9, 1
    v_lshl_add_u32 v30, v27, 5, s13
    v_add_u32 v30, v30, v19
    v_lshlrev_b32 v30, 3, v30
    global_load_dwordx4 v[40:43], v29, s[14:15] offset:0
    v_add_u32 v31, 32768, v29
    global_load_dwordx4 v[44:47], v31, s[14:15]
    v_add_u32 v31, 65536, v29
    global_load_dwordx4 v[48:51], v31, s[14:15]
    v_add_u32 v31, 98304, v29
    global_load_dwordx4 v[52:55], v31, s[14:15]
    s_waitcnt lgkmcnt(0)
    ds_read_b128 v[64:67], v23 offset:0
    ds_read_b128 v[68:71], v23 offset:16
    ds_read_b128 v[72:75], v23 offset:2048
    ds_read_b128 v[76:79], v23 offset:2064
    ds_read_b128 v[80:83], v23 offset:4096
    ds_read_b128 v[84:87], v23 offset:4112
    ds_read_b128 v[88:91], v23 offset:6144
    ds_read_b128 v[92:95], v23 offset:6160
    s_waitcnt vmcnt(0) lgkmcnt(0)
    v_mov_b32 v56, 0
    v_mov_b32 v57, 0
    v_lshlrev_b32 v58, 16, v40
    v_and_b32 v59, 0xffff0000, v40
    v_add_f32 v58, v58, v64
    v_add_f32 v59, v59, v65
    v_cvt_pk_bf16_f32 v40, v58, v59
    v_lshlrev_b32 v58, 16, v40
    v_and_b32 v59, 0xffff0000, v40
    v_add_f32 v56, v56, v58
    v_fmac_f32 v57, v58, v58
    v_add_f32 v56, v56, v59
    v_fmac_f32 v57, v59, v59
    v_lshlrev_b32 v58, 16, v41
    v_and_b32 v59, 0xffff0000, v41
    v_add_f32 v58, v58, v66
    v_add_f32 v59, v59, v67
    v_cvt_pk_bf16_f32 v41, v58, v59
    v_lshlrev_b32 v58, 16, v41
    v_and_b32 v59, 0xffff0000, v41
    v_add_f32 v56, v56, v58
    v_fmac_f32 v57, v58, v58
    v_add_f32 v56, v56, v59
    v_fmac_f32 v57, v59, v59
    v_lshlrev_b32 v58, 16, v42
    v_and_b32 v59, 0xffff0000, v42
    v_add_f32 v58, v58, v68
    v_add_f32 v59, v59, v69
    v_cvt_pk_bf16_f32 v42, v58, v59
    v_lshlrev_b32 v58, 16, v42
    v_and_b32 v59, 0xffff0000, v42
    v_add_f32 v56, v56, v58
    v_fmac_f32 v57, v58, v58
    v_add_f32 v56, v56, v59
    v_fmac_f32 v57, v59, v59
    v_lshlrev_b32 v58, 16, v43
    v_and_b32 v59, 0xffff0000, v43
    v_add_f32 v58, v58, v70
    v_add_f32 v59, v59, v71
    v_cvt_pk_bf16_f32 v43, v58, v59
    v_lshlrev_b32 v58, 16, v43
    v_and_b32 v59, 0xffff0000, v43
    v_add_f32 v56, v56, v58
    v_fmac_f32 v57, v58, v58
    v_add_f32 v56, v56, v59
    v_fmac_f32 v57, v59, v59
    v_add_u32 v31, 0, v29
    global_store_dwordx4 v31, v[40:43], s[16:17]
    s_nop 1
    v_mov_b32_dpp v58, v56 quad_perm:[1,0,3,2] row_mask:0xf bank_mask:0xf
    v_mov_b32_dpp v59, v57 quad_perm:[1,0,3,2] row_mask:0xf bank_mask:0xf
    v_add_f32 v56, v56, v58
    v_add_f32 v57, v57, v59
    s_nop 1
    v_mov_b32_dpp v58, v56 quad_perm:[2,3,0,1] row_mask:0xf bank_mask:0xf
    v_mov_b32_dpp v59, v57 quad_perm:[2,3,0,1] row_mask:0xf bank_mask:0xf
    v_add_f32 v56, v56, v58
    v_add_f32 v57, v57, v59
    v_cmp_eq_u32 vcc, 0, v26
    s_and_saveexec_b64 s[22:23], vcc
    v_add_u32 v31, 0, v30
    global_store_dwordx2 v31, v[56:57], s[18:19]
    s_mov_b64 exec, s[22:23]
    v_mov_b32 v56, 0
    v_mov_b32 v57, 0
    v_lshlrev_b32 v58, 16, v44
    v_and_b32 v59, 0xffff0000, v44
    v_add_f32 v58, v58, v72
    v_add_f32 v59, v59, v73
    v_cvt_pk_bf16_f32 v44, v58, v59
    v_lshlrev_b32 v58, 16, v44
    v_and_b32 v59, 0xffff0000, v44
    v_add_f32 v56, v56, v58
    v_fmac_f32 v57, v58, v58
    v_add_f32 v56, v56, v59
    v_fmac_f32 v57, v59, v59
    v_lshlrev_b32 v58, 16, v45
    v_and_b32 v59, 0xffff0000, v45
    v_add_f32 v58, v58, v74
    v_add_f32 v59, v59, v75
    v_cvt_pk_bf16_f32 v45, v58, v59
    v_lshlrev_b32 v58, 16, v45
    v_and_b32 v59, 0xffff0000, v45
    v_add_f32 v56, v56, v58
    v_fmac_f32 v57, v58, v58
    v_add_f32 v56, v56, v59
    v_fmac_f32 v57, v59, v59
    v_lshlrev_b32 v58, 16, v46
    v_and_b32 v59, 0xffff0000, v46
    v_add_f32 v58, v58, v76
    v_add_f32 v59, v59, v77
    v_cvt_pk_bf16_f32 v46, v58, v59
    v_lshlrev_b32 v58, 16, v46
    v_and_b32 v59, 0xffff0000, v46
    v_add_f32 v56, v56, v58
    v_fmac_f32 v57, v58, v58
    v_add_f32 v56, v56, v59
    v_fmac_f32 v57, v59, v59
    v_lshlrev_b32 v58, 16, v47
    v_and_b32 v59, 0xffff0000, v47
    v_add_f32 v58, v58, v78
    v_add_f32 v59, v59, v79
    v_cvt_pk_bf16_f32 v47, v58, v59
    v_lshlrev_b32 v58, 16, v47
    v_and_b32 v59, 0xffff0000, v47
    v_add_f32 v56, v56, v58
    v_fmac_f32 v57, v58, v58
    v_add_f32 v56, v56, v59
    v_fmac_f32 v57, v59, v59
    v_add_u32 v31, 32768, v29
    global_store_dwordx4 v31, v[44:47], s[16:17]
    s_nop 1
    v_mov_b32_dpp v58, v56 quad_perm:[1,0,3,2] row_mask:0xf bank_mask:0xf
    v_mov_b32_dpp v59, v57 quad_perm:[1,0,3,2] row_mask:0xf bank_mask:0xf
    v_add_f32 v56, v56, v58
    v_add_f32 v57, v57, v59
    s_nop 1
    v_mov_b32_dpp v58, v56 quad_perm:[2,3,0,1] row_mask:0xf bank_mask:0xf
    v_mov_b32_dpp v59, v57 quad_perm:[2,3,0,1] row_mask:0xf bank_mask:0xf
    v_add_f32 v56, v56, v58
    v_add_f32 v57, v57, v59
    v_cmp_eq_u32 vcc, 0, v26
    s_and_saveexec_b64 s[22:23], vcc
    v_add_u32 v31, 4096, v30
    global_store_dwordx2 v31, v[56:57], s[18:19]
    s_mov_b64 exec, s[22:23]
    v_mov_b32 v56, 0
    v_mov_b32 v57, 0
    v_lshlrev_b32 v58, 16, v48
    v_and_b32 v59, 0xffff0000, v48
    v_add_f32 v58, v58, v80
    v_add_f32 v59, v59, v81
    v_cvt_pk_bf16_f32 v48, v58, v59
    v_lshlrev_b32 v58, 16, v48
    v_and_b32 v59, 0xffff0000, v48
    v_add_f32 v56, v56, v58
    v_fmac_f32 v57, v58, v58
    v_add_f32 v56, v56, v59
    v_fmac_f32 v57, v59, v59
    v_lshlrev_b32 v58, 16, v49
    v_and_b32 v59, 0xffff0000, v49
    v_add_f32 v58, v58, v82
    v_add_f32 v59, v59, v83
    v_cvt_pk_bf16_f32 v49, v58, v59
    v_lshlrev_b32 v58, 16, v49
    v_and_b32 v59, 0xffff0000, v49
    v_add_f32 v56, v56, v58
    v_fmac_f32 v57, v58, v58
    v_add_f32 v56, v56, v59
    v_fmac_f32 v57, v59, v59
    v_lshlrev_b32 v58, 16, v50
    v_and_b32 v59, 0xffff0000, v50
    v_add_f32 v58, v58, v84
    v_add_f32 v59, v59, v85
    v_cvt_pk_bf16_f32 v50, v58, v59
    v_lshlrev_b32 v58, 16, v50
    v_and_b32 v59, 0xffff0000, v50
    v_add_f32 v56, v56, v58
    v_fmac_f32 v57, v58, v58
    v_add_f32 v56, v56, v59
    v_fmac_f32 v57, v59, v59
    v_lshlrev_b32 v58, 16, v51
    v_and_b32 v59, 0xffff0000, v51
    v_add_f32 v58, v58, v86
    v_add_f32 v59, v59, v87
    v_cvt_pk_bf16_f32 v51, v58, v59
    v_lshlrev_b32 v58, 16, v51
    v_and_b32 v59, 0xffff0000, v51
    v_add_f32 v56, v56, v58
    v_fmac_f32 v57, v58, v58
    v_add_f32 v56, v56, v59
    v_fmac_f32 v57, v59, v59
    v_add_u32 v31, 65536, v29
    global_store_dwordx4 v31, v[48:51], s[16:17]
    s_nop 1
    v_mov_b32_dpp v58, v56 quad_perm:[1,0,3,2] row_mask:0xf bank_mask:0xf
    v_mov_b32_dpp v59, v57 quad_perm:[1,0,3,2] row_mask:0xf bank_mask:0xf
    v_add_f32 v56, v56, v58
    v_add_f32 v57, v57, v59
    s_nop 1
    v_mov_b32_dpp v58, v56 quad_perm:[2,3,0,1] row_mask:0xf bank_mask:0xf
    v_mov_b32_dpp v59, v57 quad_perm:[2,3,0,1] row_mask:0xf bank_mask:0xf
    v_add_f32 v56, v56, v58
    v_add_f32 v57, v57, v59
    v_cmp_eq_u32 vcc, 0, v26
    s_and_saveexec_b64 s[22:23], vcc
    v_add_u32 v31, 8192, v30
    global_store_dwordx2 v31, v[56:57], s[18:19]
    s_mov_b64 exec, s[22:23]
    v_mov_b32 v56, 0
    v_mov_b32 v57, 0
    v_lshlrev_b32 v58, 16, v52
    v_and_b32 v59, 0xffff0000, v52
    v_add_f32 v58, v58, v88
    v_add_f32 v59, v59, v89
    v_cvt_pk_bf16_f32 v52, v58, v59
    v_lshlrev_b32 v58, 16, v52
    v_and_b32 v59, 0xffff0000, v52
    v_add_f32 v56, v56, v58
    v_fmac_f32 v57, v58, v58
    v_add_f32 v56, v56, v59
    v_fmac_f32 v57, v59, v59
    v_lshlrev_b32 v58, 16, v53
    v_and_b32 v59, 0xffff0000, v53
    v_add_f32 v58, v58, v90
    v_add_f32 v59, v59, v91
    v_cvt_pk_bf16_f32 v53, v58, v59
    v_lshlrev_b32 v58, 16, v53
    v_and_b32 v59, 0xffff0000, v53
    v_add_f32 v56, v56, v58
    v_fmac_f32 v57, v58, v58
    v_add_f32 v56, v56, v59
    v_fmac_f32 v57, v59, v59
    v_lshlrev_b32 v58, 16, v54
    v_and_b32 v59, 0xffff0000, v54
    v_add_f32 v58, v58, v92
    v_add_f32 v59, v59, v93
    v_cvt_pk_bf16_f32 v54, v58, v59
    v_lshlrev_b32 v58, 16, v54
    v_and_b32 v59, 0xffff0000, v54
    v_add_f32 v56, v56, v58
    v_fmac_f32 v57, v58, v58
    v_add_f32 v56, v56, v59
    v_fmac_f32 v57, v59, v59
    v_lshlrev_b32 v58, 16, v55
    v_and_b32 v59, 0xffff0000, v55
    v_add_f32 v58, v58, v94
    v_add_f32 v59, v59, v95
    v_cvt_pk_bf16_f32 v55, v58, v59
    v_lshlrev_b32 v58, 16, v55
    v_and_b32 v59, 0xffff0000, v55
    v_add_f32 v56, v56, v58
    v_fmac_f32 v57, v58, v58
    v_add_f32 v56, v56, v59
    v_fmac_f32 v57, v59, v59
    v_add_u32 v31, 98304, v29
    global_store_dwordx4 v31, v[52:55], s[16:17]
    s_nop 1
    v_mov_b32_dpp v58, v56 quad_perm:[1,0,3,2] row_mask:0xf bank_mask:0xf
    v_mov_b32_dpp v59, v57 quad_perm:[1,0,3,2] row_mask:0xf bank_mask:0xf
    v_add_f32 v56, v56, v58
    v_add_f32 v57, v57, v59
    s_nop 1
    v_mov_b32_dpp v58, v56 quad_perm:[2,3,0,1] row_mask:0xf bank_mask:0xf
    v_mov_b32_dpp v59, v57 quad_perm:[2,3,0,1] row_mask:0xf bank_mask:0xf
    v_add_f32 v56, v56, v58
    v_add_f32 v57, v57, v59
    v_cmp_eq_u32 vcc, 0, v26
    s_and_saveexec_b64 s[22:23], vcc
    v_add_u32 v31, 12288, v30
    global_store_dwordx2 v31, v[56:57], s[18:19]
    s_mov_b64 exec, s[22:23]
L_wo0_end:
    s_endpgm
.globl qkv1_kernel
.p2align 8
.type qkv1_kernel,@function
qkv1_kernel:
    s_cmp_ge_u32 s2, 256
    s_cbranch_scc1 L_qkv1_end
    s_load_dwordx2 s[4:5], s[0:1], 64
    s_load_dwordx2 s[6:7], s[0:1], 32
    s_load_dwordx2 s[14:15], s[0:1], 64
    s_waitcnt lgkmcnt(0)
    s_add_u32 s14, s14, 4194304
    s_addc_u32 s15, s15, 0
    s_lshr_b32 s8, s2, 4
    s_and_b32 s9, s2, 15
    v_lshrrev_b32 v1, 3, v0
    v_and_b32 v2, 7, v0
    s_lshl_b32 s10, s8, 7
    v_add_u32 v3, s10, v1
    v_lshlrev_b32 v3, 11, v3
    v_lshl_add_u32 v3, v2, 4, v3
    v_add_u32 v4, 0, v3
    v_add_u32 v5, 65536, v3
    v_add_u32 v6, 131072, v3
    v_add_u32 v7, 196608, v3
    s_mov_b32 s11, 6144
    v_mul_lo_u32 v3, v1, s11
    v_lshl_add_u32 v3, v2, 4, v3
    s_lshl_b32 s12, s9, 7
    v_add_u32 v3, s12, v3
    v_add_u32 v8, 0, v3
    v_add_u32 v9, 2048, v3
    v_add_u32 v10, 4096, v3
    v_add_u32 v11, 196608, v3
    v_add_u32 v12, 198656, v3
    v_add_u32 v13, 200704, v3
    v_mul_u32_u24 v14, 144, v1
    v_lshl_add_u32 v14, v2, 4, v14
    v_mul_u32_u24 v15, 448, v1
    v_lshl_add_u32 v15, v2, 4, v15
    v_add_u32 v15, 18432, v15
    v_and_b32 v16, 63, v0
    v_lshrrev_b32 v17, 6, v0
    v_lshrrev_b32 v18, 1, v17
    v_and_b32 v19, 1, v17
    v_and_b32 v20, 31, v16
    v_lshrrev_b32 v21, 5, v16
    v_lshl_add_u32 v22, v18, 6, v20
    v_mul_u32_u24 v22, 144, v22
    v_lshl_add_u32 v22, v21, 4, v22
    v_bfe_u32 v23, v16, 2, 2
    v_lshl_add_u32 v23, v21, 3, v23
    v_mul_u32_u24 v23, 448, v23
    v_bfe_u32 v24, v16, 4, 1
    v_lshlrev_b32 v24, 5, v24
    v_lshl_add_u32 v24, v19, 6, v24
    v_and_b32 v25, 3, v16
    v_lshl_add_u32 v24, v25, 3, v24
    v_add_u32 v23, v23, v24
    v_add_u32 v23, 18432, v23
    v_add_u32 v24, 47104, v22
    v_add_u32 v25, 47104, v23
    v_lshrrev_b32 v26, 1, v0
    v_and_b32 v27, 1, v0
    v_add_u32 v28, s10, v26
    v_lshlrev_b32 v28, 8, v28
    v_lshl_add_u32 v28, v27, 7, v28
    global_load_dwordx4 v[160:163], v28, s[14:15] offset:0
    global_load_dwordx4 v[164:167], v28, s[14:15] offset:16
    global_load_dwordx4 v[168:171], v28, s[14:15] offset:32
    global_load_dwordx4 v[172:175], v28, s[14:15] offset:48
    global_load_dwordx4 v[176:179], v28, s[14:15] offset:64
    global_load_dwordx4 v[180:183], v28, s[14:15] offset:80
    global_load_dwordx4 v[184:187], v28, s[14:15] offset:96
    global_load_dwordx4 v[188:191], v28, s[14:15] offset:112
    v_mov_b32 v34, 0
    v_mov_b32 v35, 0
    global_load_dwordx4 v[40:43], v4, s[4:5]
    global_load_dwordx4 v[44:47], v5, s[4:5]
    global_load_dwordx4 v[48:51], v6, s[4:5]
    global_load_dwordx4 v[52:55], v7, s[4:5]
    global_load_dwordx4 v[56:59], v8, s[6:7]
    global_load_dwordx4 v[60:63], v9, s[6:7]
    global_load_dwordx4 v[64:67], v10, s[6:7]
    global_load_dwordx4 v[68:71], v11, s[6:7]
    global_load_dwordx4 v[72:75], v12, s[6:7]
    global_load_dwordx4 v[76:79], v13, s[6:7]
    s_add_u32 s4, s4, 128
    s_addc_u32 s5, s5, 0
    s_add_u32 s6, s6, 393216
    s_addc_u32 s7, s7, 0
    global_load_dwordx4 v[80:83], v4, s[4:5]
    global_load_dwordx4 v[84:87], v5, s[4:5]
    global_load_dwordx4 v[88:91], v6, s[4:5]
    global_load_dwordx4 v[92:95], v7, s[4:5]
    global_load_dwordx4 v[96:99], v8, s[6:7]
    global_load_dwordx4 v[100:103], v9, s[6:7]
    global_load_dwordx4 v[104:107], v10, s[6:7]
    global_load_dwordx4 v[108:111], v11, s[6:7]
    global_load_dwordx4 v[112:115], v12, s[6:7]
    global_load_dwordx4 v[116:119], v13, s[6:7]
    s_add_u32 s4, s4, 128
    s_addc_u32 s5, s5, 0
    s_add_u32 s6, s6, 393216
    s_addc_u32 s7, s7, 0
    s_waitcnt vmcnt(20)
    v_add_f32 v34, v34, v160
    v_add_f32 v35, v35, v161
    v_add_f32 v34, v34, v162
    v_add_f32 v35, v35, v163
    v_add_f32 v34, v34, v164
    v_add_f32 v35, v35, v165
    v_add_f32 v34, v34, v166
    v_add_f32 v35, v35, v167
    v_add_f32 v34, v34, v168
    v_add_f32 v35, v35, v169
    v_add_f32 v34, v34, v170
    v_add_f32 v35, v35, v171
    v_add_f32 v34, v34, v172
    v_add_f32 v35, v35, v173
    v_add_f32 v34, v34, v174
    v_add_f32 v35, v35, v175
    v_add_f32 v34, v34, v176
    v_add_f32 v35, v35, v177
    v_add_f32 v34, v34, v178
    v_add_f32 v35, v35, v179
    v_add_f32 v34, v34, v180
    v_add_f32 v35, v35, v181
    v_add_f32 v34, v34, v182
    v_add_f32 v35, v35, v183
    v_add_f32 v34, v34, v184
    v_add_f32 v35, v35, v185
    v_add_f32 v34, v34, v186
    v_add_f32 v35, v35, v187
    v_add_f32 v34, v34, v188
    v_add_f32 v35, v35, v189
    v_add_f32 v34, v34, v190
    v_add_f32 v35, v35, v191
    s_nop 1
    v_mov_b32_dpp v31, v34 quad_perm:[1,0,3,2] row_mask:0xf bank_mask:0xf
    v_mov_b32_dpp v32, v35 quad_perm:[1,0,3,2] row_mask:0xf bank_mask:0xf
    v_add_f32 v34, v34, v31
    v_add_f32 v35, v35, v32
    v_mul_f32 v34, 0x3a800000, v34
    v_mul_f32 v35, 0x3a800000, v35
    v_fma_f32 v35, -v34, v34, v35
    v_max_f32 v35, 0, v35
    v_add_f32 v35, 0x3727c5ac, v35
    v_rsq_f32 v35, v35
    s_nop 0
    v_mul_f32 v34, v34, v35
    v_sub_f32 v34, 0, v34
    v_lshlrev_b32 v31, 3, v26
    v_add_u32 v31, 94208, v31
    ds_write_b64 v31, v[34:35]
    s_waitcnt lgkmcnt(0)
    s_barrier
    v_lshlrev_b32 v31, 3, v1
    v_add_u32 v31, 94208, v31
    ds_read_b64 v[26:27], v31 offset:0
    ds_read_b64 v[28:29], v31 offset:256
    ds_read_b64 v[30:31], v31 offset:512
    ds_read_b64 v[32:33], v31 offset:768
    s_waitcnt lgkmcnt(0)
    v_mov_b32 v160, 0
    v_mov_b32 v161, 0
    v_mov_b32 v162, 0
    v_mov_b32 v163, 0
    v_mov_b32 v164, 0
    v_mov_b32 v165, 0
    v_mov_b32 v166, 0
    v_mov_b32 v167, 0
    v_mov_b32 v168, 0
    v_mov_b32 v169, 0
    v_mov_b32 v170, 0
    v_mov_b32 v171, 0
    v_mov_b32 v172, 0
    v_mov_b32 v173, 0
    v_mov_b32 v174, 0
    v_mov_b32 v175, 0
    v_mov_b32 v176, 0
    v_mov_b32 v177, 0
    v_mov_b32 v178, 0
    v_mov_b32 v179, 0
    v_mov_b32 v180, 0
    v_mov_b32 v181, 0
    v_mov_b32 v182, 0
    v_mov_b32 v183, 0
    v_mov_b32 v184, 0
    v_mov_b32 v185, 0
    v_mov_b32 v186, 0
    v_mov_b32 v187, 0
    v_mov_b32 v188, 0
    v_mov_b32 v189, 0
    v_mov_b32 v190, 0
    v_mov_b32 v191, 0
    v_mov_b32 v192, 0
    v_mov_b32 v193, 0
    v_mov_b32 v194, 0
    v_mov_b32 v195, 0
    v_mov_b32 v196, 0
    v_mov_b32 v197, 0
    v_mov_b32 v198, 0
    v_mov_b32 v199, 0
    v_mov_b32 v200, 0
    v_mov_b32 v201, 0
    v_mov_b32 v202, 0
    v_mov_b32 v203, 0
    v_mov_b32 v204, 0
    v_mov_b32 v205, 0
    v_mov_b32 v206, 0
    v_mov_b32 v207, 0
    v_mov_b32 v208, 0
    v_mov_b32 v209, 0
    v_mov_b32 v210, 0
    v_mov_b32 v211, 0
    v_mov_b32 v212, 0
    v_mov_b32 v213, 0
    v_mov_b32 v214, 0
    v_mov_b32 v215, 0
    v_mov_b32 v216, 0
    v_mov_b32 v217, 0
    v_mov_b32 v218, 0
    v_mov_b32 v219, 0
    v_mov_b32 v220, 0
    v_mov_b32 v221, 0
    v_mov_b32 v222, 0
    v_mov_b32 v223, 0
    v_mov_b32 v224, 0
    v_mov_b32 v225, 0
    v_mov_b32 v226, 0
    v_mov_b32 v227, 0
    v_mov_b32 v228, 0
    v_mov_b32 v229, 0
    v_mov_b32 v230, 0
    v_mov_b32 v231, 0
    v_mov_b32 v232, 0
    v_mov_b32 v233, 0
    v_mov_b32 v234, 0
    v_mov_b32 v235, 0
    v_mov_b32 v236, 0
    v_mov_b32 v237, 0
    v_mov_b32 v238, 0
    v_mov_b32 v239, 0
    v_mov_b32 v240, 0
    v_mov_b32 v241, 0
    v_mov_b32 v242, 0
    v_mov_b32 v243, 0
    v_mov_b32 v244, 0
    v_mov_b32 v245, 0
    v_mov_b32 v246, 0
    v_mov_b32 v247, 0
    v_mov_b32 v248, 0
    v_mov_b32 v249, 0
    v_mov_b32 v250, 0
    v_mov_b32 v251, 0
    v_mov_b32 v252, 0
    v_mov_b32 v253, 0
    v_mov_b32 v254, 0
    v_mov_b32 v255, 0
    s_waitcnt vmcnt(10)
    v_lshlrev_b32 v36, 16, v40
    v_and_b32 v37, 0xffff0000, v40
    v_fma_f32 v36, v36, v27, v26
    v_fma_f32 v37, v37, v27, v26
    v_cvt_pk_bf16_f32 v40, v36, v37
    v_lshlrev_b32 v36, 16, v41
    v_and_b32 v37, 0xffff0000, v41
    v_fma_f32 v36, v36, v27, v26
    v_fma_f32 v37, v37, v27, v26
    v_cvt_pk_bf16_f32 v41, v36, v37
    v_lshlrev_b32 v36, 16, v42
    v_and_b32 v37, 0xffff0000, v42
    v_fma_f32 v36, v36, v27, v26
    v_fma_f32 v37, v37, v27, v26
    v_cvt_pk_bf16_f32 v42, v36, v37
    v_lshlrev_b32 v36, 16, v43
    v_and_b32 v37, 0xffff0000, v43
    v_fma_f32 v36, v36, v27, v26
    v_fma_f32 v37, v37, v27, v26
    v_cvt_pk_bf16_f32 v43, v36, v37
    ds_write_b128 v14, v[40:43] offset:0
    v_lshlrev_b32 v36, 16, v44
    v_and_b32 v37, 0xffff0000, v44
    v_fma_f32 v36, v36, v29, v28
    v_fma_f32 v37, v37, v29, v28
    v_cvt_pk_bf16_f32 v44, v36, v37
    v_lshlrev_b32 v36, 16, v45
    v_and_b32 v37, 0xffff0000, v45
    v_fma_f32 v36, v36, v29, v28
    v_fma_f32 v37, v37, v29, v28
    v_cvt_pk_bf16_f32 v45, v36, v37
    v_lshlrev_b32 v36, 16, v46
    v_and_b32 v37, 0xffff0000, v46
    v_fma_f32 v36, v36, v29, v28
    v_fma_f32 v37, v37, v29, v28
    v_cvt_pk_bf16_f32 v46, v36, v37
    v_lshlrev_b32 v36, 16, v47
    v_and_b32 v37, 0xffff0000, v47
    v_fma_f32 v36, v36, v29, v28
    v_fma_f32 v37, v37, v29, v28
    v_cvt_pk_bf16_f32 v47, v36, v37
    ds_write_b128 v14, v[44:47] offset:4608
    v_lshlrev_b32 v36, 16, v48
    v_and_b32 v37, 0xffff0000, v48
    v_fma_f32 v36, v36, v31, v30
    v_fma_f32 v37, v37, v31, v30
    v_cvt_pk_bf16_f32 v48, v36, v37
    v_lshlrev_b32 v36, 16, v49
    v_and_b32 v37, 0xffff0000, v49
    v_fma_f32 v36, v36, v31, v30
    v_fma_f32 v37, v37, v31, v30
    v_cvt_pk_bf16_f32 v49, v36, v37
    v_lshlrev_b32 v36, 16, v50
    v_and_b32 v37, 0xffff0000, v50
    v_fma_f32 v36, v36, v31, v30
    v_fma_f32 v37, v37, v31, v30
    v_cvt_pk_bf16_f32 v50, v36, v37
    v_lshlrev_b32 v36, 16, v51
    v_and_b32 v37, 0xffff0000, v51
    v_fma_f32 v36, v36, v31, v30
    v_fma_f32 v37, v37, v31, v30
    v_cvt_pk_bf16_f32 v51, v36, v37
    ds_write_b128 v14, v[48:51] offset:9216
    v_lshlrev_b32 v36, 16, v52
    v_and_b32 v37, 0xffff0000, v52
    v_fma_f32 v36, v36, v33, v32
    v_fma_f32 v37, v37, v33, v32
    v_cvt_pk_bf16_f32 v52, v36, v37
    v_lshlrev_b32 v36, 16, v53
    v_and_b32 v37, 0xffff0000, v53
    v_fma_f32 v36, v36, v33, v32
    v_fma_f32 v37, v37, v33, v32
    v_cvt_pk_bf16_f32 v53, v36, v37
    v_lshlrev_b32 v36, 16, v54
    v_and_b32 v37, 0xffff0000, v54
    v_fma_f32 v36, v36, v33, v32
    v_fma_f32 v37, v37, v33, v32
    v_cvt_pk_bf16_f32 v54, v36, v37
    v_lshlrev_b32 v36, 16, v55
    v_and_b32 v37, 0xffff0000, v55
    v_fma_f32 v36, v36, v33, v32
    v_fma_f32 v37, v37, v33, v32
    v_cvt_pk_bf16_f32 v55, v36, v37
    ds_write_b128 v14, v[52:55] offset:13824
    ds_write_b128 v15, v[56:59] offset:0
    ds_write_b128 v15, v[60:63] offset:128
    ds_write_b128 v15, v[64:67] offset:256
    ds_write_b128 v15, v[68:71] offset:14336
    ds_write_b128 v15, v[72:75] offset:14464
    ds_write_b128 v15, v[76:79] offset:14592
    s_waitcnt lgkmcnt(0)
    s_barrier
    ds_read_b128 v[120:123], v22 offset:0
    ds_read_b128 v[124:127], v22 offset:4608
    ds_read_b64_tr_b16 v[136:137], v23 offset:0
    ds_read_b64_tr_b16 v[138:139], v23 offset:1792
    ds_read_b64_tr_b16 v[140:141], v23 offset:128
    ds_read_b64_tr_b16 v[142:143], v23 offset:1920
    ds_read_b64_tr_b16 v[144:145], v23 offset:256
    ds_read_b64_tr_b16 v[146:147], v23 offset:2048
    s_mov_b32 s20, 0
L_qkv1_loop:
    s_waitcnt lgkmcnt(0)
    v_mfma_f32_32x32x16_bf16 v[160:175], v[136:139], v[120:123], v[160:175]
    ds_read_b128 v[128:131], v22 offset:32
    ds_read_b128 v[132:135], v22 offset:4640
    ds_read_b64_tr_b16 v[148:149], v23 offset:7168
    ds_read_b64_tr_b16 v[150:151], v23 offset:8960
    ds_read_b64_tr_b16 v[152:153], v23 offset:7296
    ds_read_b64_tr_b16 v[154:155], v23 offset:9088
    ds_read_b64_tr_b16 v[156:157], v23 offset:7424
    ds_read_b64_tr_b16 v[158:159], v23 offset:9216
    v_mfma_f32_32x32x16_bf16 v[176:191], v[140:143], v[120:123], v[176:191]
    global_load_dwordx4 v[40:43], v4, s[4:5]
    global_load_dwordx4 v[44:47], v5, s[4:5]
    global_load_dwordx4 v[48:51], v6, s[4:5]
    global_load_dwordx4 v[52:55], v7, s[4:5]
    global_load_dwordx4 v[56:59], v8, s[6:7]
    global_load_dwordx4 v[60:63], v9, s[6:7]
    global_load_dwordx4 v[64:67], v10, s[6:7]
    global_load_dwordx4 v[68:71], v11, s[6:7]
    v_mfma_f32_32x32x16_bf16 v[192:207], v[120:123], v[144:147], v[192:207]
    global_load_dwordx4 v[72:75], v12, s[6:7]
    global_load_dwordx4 v[76:79], v13, s[6:7]
    s_add_u32 s4, s4, 128
    s_addc_u32 s5, s5, 0
    s_add_u32 s6, s6, 393216
    s_addc_u32 s7, s7, 0
    s_waitcnt vmcnt(10)
    v_mfma_f32_32x32x16_bf16 v[208:223], v[136:139], v[124:127], v[208:223]
    v_lshlrev_b32 v36, 16, v80
    v_and_b32 v37, 0xffff0000, v80
    v_fma_f32 v36, v36, v27, v26
    v_fma_f32 v37, v37, v27, v26
    v_cvt_pk_bf16_f32 v80, v36, v37
    v_lshlrev_b32 v36, 16, v81
    v_and_b32 v37, 0xffff0000, v81
    v_mfma_f32_32x32x16_bf16 v[224:239], v[140:143], v[124:127], v[224:239]
    v_fma_f32 v36, v36, v27, v26
    v_fma_f32 v37, v37, v27, v26
    v_cvt_pk_bf16_f32 v81, v36, v37
    v_lshlrev_b32 v36, 16, v82
    v_and_b32 v37, 0xffff0000, v82
    v_fma_f32 v36, v36, v27, v26
    v_fma_f32 v37, v37, v27, v26
    v_mfma_f32_32x32x16_bf16 v[240:255], v[124:127], v[144:147], v[240:255]
    v_cvt_pk_bf16_f32 v82, v36, v37
    v_lshlrev_b32 v36, 16, v83
    v_and_b32 v37, 0xffff0000, v83
    v_fma_f32 v36, v36, v27, v26
    v_fma_f32 v37, v37, v27, v26
    v_cvt_pk_bf16_f32 v83, v36, v37
    ds_write_b128 v14, v[80:83] offset:47104
    s_waitcnt lgkmcnt(1)
    v_mfma_f32_32x32x16_bf16 v[160:175], v[148:151], v[128:131], v[160:175]
    ds_read_b128 v[120:123], v22 offset:64
    ds_read_b128 v[124:127], v22 offset:4672
    ds_read_b64_tr_b16 v[136:137], v23 offset:14336
    ds_read_b64_tr_b16 v[138:139], v23 offset:16128
    ds_read_b64_tr_b16 v[140:141], v23 offset:14464
    ds_read_b64_tr_b16 v[142:143], v23 offset:16256
    ds_read_b64_tr_b16 v[144:145], v23 offset:14592
    ds_read_b64_tr_b16 v[146:147], v23 offset:16384
    v_lshlrev_b32 v36, 16, v84
    v_mfma_f32_32x32x16_bf16 v[176:191], v[152:155], v[128:131], v[176:191]
    v_and_b32 v37, 0xffff0000, v84
    v_fma_f32 v36, v36, v29, v28
    v_fma_f32 v37, v37, v29, v28
    v_cvt_pk_bf16_f32 v84, v36, v37
    v_lshlrev_b32 v36, 16, v85
    v_and_b32 v37, 0xffff0000, v85
    v_fma_f32 v36, v36, v29, v28
    v_fma_f32 v37, v37, v29, v28
    v_cvt_pk_bf16_f32 v85, v36, v37
    v_mfma_f32_32x32x16_bf16 v[192:207], v[128:131], v[156:159], v[192:207]
    v_lshlrev_b32 v36, 16, v86
    v_and_b32 v37, 0xffff0000, v86
    v_fma_f32 v36, v36, v29, v28
    v_fma_f32 v37, v37, v29, v28
    v_cvt_pk_bf16_f32 v86, v36, v37
    v_lshlrev_b32 v36, 16, v87
    v_and_b32 v37, 0xffff0000, v87
    v_fma_f32 v36, v36, v29, v28
    v_mfma_f32_32x32x16_bf16 v[208:223], v[148:151], v[132:135], v[208:223]
    v_fma_f32 v37, v37, v29, v28
    v_cvt_pk_bf16_f32 v87, v36, v37
    ds_write_b128 v14, v[84:87] offset:51712
    v_lshlrev_b32 v36, 16, v88
    v_and_b32 v37, 0xffff0000, v88
    v_fma_f32 v36, v36, v31, v30
    v_fma_f32 v37, v37, v31, v30
    v_cvt_pk_bf16_f32 v88, v36, v37
    v_mfma_f32_32x32x16_bf16 v[224:239], v[152:155], v[132:135], v[224:239]
    v_lshlrev_b32 v36, 16, v89
    v_and_b32 v37, 0xffff0000, v89
    v_fma_f32 v36, v36, v31, v30
    v_fma_f32 v37, v37, v31, v30
    v_cvt_pk_bf16_f32 v89, v36, v37
    v_lshlrev_b32 v36, 16, v90
    v_and_b32 v37, 0xffff0000, v90
    v_fma_f32 v36, v36, v31, v30
    v_mfma_f32_32x32x16_bf16 v[240:255], v[132:135], v[156:159], v[240:255]
    v_fma_f32 v37, v37, v31, v30
    v_cvt_pk_bf16_f32 v90, v36, v37
    v_lshlrev_b32 v36, 16, v91
    v_and_b32 v37, 0xffff0000, v91
    v_fma_f32 v36, v36, v31, v30
    v_fma_f32 v37, v37, v31, v30
    v_cvt_pk_bf16_f32 v91, v36, v37
    ds_write_b128 v14, v[88:91] offset:56320
    s_waitcnt lgkmcnt(2)
    v_mfma_f32_32x32x16_bf16 v[160:175], v[136:139], v[120:123], v[160:175]
    ds_read_b128 v[128:131], v22 offset:96
    ds_read_b128 v[132:135], v22 offset:4704
    ds_read_b64_tr_b16 v[148:149], v23 offset:21504
    ds_read_b64_tr_b16 v[150:151], v23 offset:23296
    ds_read_b64_tr_b16 v[152:153], v23 offset:21632
    ds_read_b64_tr_b16 v[154:155], v23 offset:23424
    v_mfma_f32_32x32x16_bf16 v[176:191], v[140:143], v[120:123], v[176:191]
    ds_read_b64_tr_b16 v[156:157], v23 offset:21760
    ds_read_b64_tr_b16 v[158:159], v23 offset:23552
    v_lshlrev_b32 v36, 16, v92
    v_and_b32 v37, 0xffff0000, v92
    v_fma_f32 v36, v36, v33, v32
    v_fma_f32 v37, v37, v33, v32
    v_mfma_f32_32x32x16_bf16 v[192:207], v[120:123], v[144:147], v[192:207]
    v_cvt_pk_bf16_f32 v92, v36, v37
    v_lshlrev_b32 v36, 16, v93
    v_and_b32 v37, 0xffff0000, v93
    v_fma_f32 v36, v36, v33, v32
    v_fma_f32 v37, v37, v33, v32
    v_cvt_pk_bf16_f32 v93, v36, v37
    v_mfma_f32_32x32x16_bf16 v[208:223], v[136:139], v[124:127], v[208:223]
    v_lshlrev_b32 v36, 16, v94
    v_and_b32 v37, 0xffff0000, v94
    v_fma_f32 v36, v36, v33, v32
    v_fma_f32 v37, v37, v33, v32
    v_cvt_pk_bf16_f32 v94, v36, v37
    v_lshlrev_b32 v36, 16, v95
    v_mfma_f32_32x32x16_bf16 v[224:239], v[140:143], v[124:127], v[224:239]
    v_and_b32 v37, 0xffff0000, v95
    v_fma_f32 v36, v36, v33, v32
    v_fma_f32 v37, v37, v33, v32
    v_cvt_pk_bf16_f32 v95, v36, v37
    ds_write_b128 v14, v[92:95] offset:60928
    ds_write_b128 v15, v[96:99] offset:47104
    v_mfma_f32_32x32x16_bf16 v[240:255], v[124:127], v[144:147], v[240:255]
    ds_write_b128 v15, v[100:103] offset:47232
    ds_write_b128 v15, v[104:107] offset:47360
    ds_write_b128 v15, v[108:111] offset:61440
    ds_write_b128 v15, v[112:115] offset:61568
    ds_write_b128 v15, v[116:119] offset:61696
    s_waitcnt lgkmcnt(0)
    s_barrier
    s_waitcnt lgkmcnt(7)
    v_mfma_f32_32x32x16_bf16 v[160:175], v[148:151], v[128:131], v[160:175]
    ds_read_b128 v[120:123], v24 offset:0
    ds_read_b128 v[124:127], v24 offset:4608
    v_mfma_f32_32x32x16_bf16 v[176:191], v[152:155], v[128:131], v[176:191]
    ds_read_b64_tr_b16 v[136:137], v25 offset:0
    ds_read_b64_tr_b16 v[138:139], v25 offset:1792
    v_mfma_f32_32x32x16_bf16 v[192:207], v[128:131], v[156:159], v[192:207]
    ds_read_b64_tr_b16 v[140:141], v25 offset:128
    v_mfma_f32_32x32x16_bf16 v[208:223], v[148:151], v[132:135], v[208:223]
    ds_read_b64_tr_b16 v[142:143], v25 offset:1920
    v_mfma_f32_32x32x16_bf16 v[224:239], v[152:155], v[132:135], v[224:239]
    ds_read_b64_tr_b16 v[144:145], v25 offset:256
    v_mfma_f32_32x32x16_bf16 v[240:255], v[132:135], v[156:159], v[240:255]
    ds_read_b64_tr_b16 v[146:147], v25 offset:2048
    s_waitcnt lgkmcnt(0)
    v_mfma_f32_32x32x16_bf16 v[160:175], v[136:139], v[120:123], v[160:175]
    ds_read_b128 v[128:131], v24 offset:32
    ds_read_b128 v[132:135], v24 offset:4640
    ds_read_b64_tr_b16 v[148:149], v25 offset:7168
    ds_read_b64_tr_b16 v[150:151], v25 offset:8960
    ds_read_b64_tr_b16 v[152:153], v25 offset:7296
    ds_read_b64_tr_b16 v[154:155], v25 offset:9088
    ds_read_b64_tr_b16 v[156:157], v25 offset:7424
    ds_read_b64_tr_b16 v[158:159], v25 offset:9216
    v_mfma_f32_32x32x16_bf16 v[176:191], v[140:143], v[120:123], v[176:191]
    global_load_dwordx4 v[80:83], v4, s[4:5]
    global_load_dwordx4 v[84:87], v5, s[4:5]
    global_load_dwordx4 v[88:91], v6, s[4:5]
    global_load_dwordx4 v[92:95], v7, s[4:5]
    global_load_dwordx4 v[96:99], v8, s[6:7]
    global_load_dwordx4 v[100:103], v9, s[6:7]
    global_load_dwordx4 v[104:107], v10, s[6:7]
    global_load_dwordx4 v[108:111], v11, s[6:7]
    v_mfma_f32_32x32x16_bf16 v[192:207], v[120:123], v[144:147], v[192:207]
    global_load_dwordx4 v[112:115], v12, s[6:7]
    global_load_dwordx4 v[116:119], v13, s[6:7]
    s_add_u32 s4, s4, 128
    s_addc_u32 s5, s5, 0
    s_add_u32 s6, s6, 393216
    s_addc_u32 s7, s7, 0
    s_waitcnt vmcnt(10)
    v_mfma_f32_32x32x16_bf16 v[208:223], v[136:139], v[124:127], v[208:223]
    v_lshlrev_b32 v36, 16, v40
    v_and_b32 v37, 0xffff0000, v40
    v_fma_f32 v36, v36, v27, v26
    v_fma_f32 v37, v37, v27, v26
    v_cvt_pk_bf16_f32 v40, v36, v37
    v_lshlrev_b32 v36, 16, v41
    v_and_b32 v37, 0xffff0000, v41
    v_mfma_f32_32x32x16_bf16 v[224:239], v[140:143], v[124:127], v[224:239]
    v_fma_f32 v36, v36, v27, v26
    v_fma_f32 v37, v37, v27, v26
    v_cvt_pk_bf16_f32 v41, v36, v37
    v_lshlrev_b32 v36, 16, v42
    v_and_b32 v37, 0xffff0000, v42
    v_fma_f32 v36, v36, v27, v26
    v_fma_f32 v37, v37, v27, v26
    v_mfma_f32_32x32x16_bf16 v[240:255], v[124:127], v[144:147], v[240:255]
    v_cvt_pk_bf16_f32 v42, v36, v37
    v_lshlrev_b32 v36, 16, v43
    v_and_b32 v37, 0xffff0000, v43
    v_fma_f32 v36, v36, v27, v26
    v_fma_f32 v37, v37, v27, v26
    v_cvt_pk_bf16_f32 v43, v36, v37
    ds_write_b128 v14, v[40:43] offset:0
    s_waitcnt lgkmcnt(1)
    v_mfma_f32_32x32x16_bf16 v[160:175], v[148:151], v[128:131], v[160:175]
    ds_read_b128 v[120:123], v24 offset:64
    ds_read_b128 v[124:127], v24 offset:4672
    ds_read_b64_tr_b16 v[136:137], v25 offset:14336
    ds_read_b64_tr_b16 v[138:139], v25 offset:16128
    ds_read_b64_tr_b16 v[140:141], v25 offset:14464
    ds_read_b64_tr_b16 v[142:143], v25 offset:16256
    ds_read_b64_tr_b16 v[144:145], v25 offset:14592
    ds_read_b64_tr_b16 v[146:147], v25 offset:16384
    v_lshlrev_b32 v36, 16, v44
    v_mfma_f32_32x32x16_bf16 v[176:191], v[152:155], v[128:131], v[176:191]
    v_and_b32 v37, 0xffff0000, v44
    v_fma_f32 v36, v36, v29, v28
    v_fma_f32 v37, v37, v29, v28
    v_cvt_pk_bf16_f32 v44, v36, v37
    v_lshlrev_b32 v36, 16, v45
    v_and_b32 v37, 0xffff0000, v45
    v_fma_f32 v36, v36, v29, v28
    v_fma_f32 v37, v37, v29, v28
    v_cvt_pk_bf16_f32 v45, v36, v37
    v_mfma_f32_32x32x16_bf16 v[192:207], v[128:131], v[156:159], v[192:207]
    v_lshlrev_b32 v36, 16, v46
    v_and_b32 v37, 0xffff0000, v46
    v_fma_f32 v36, v36, v29, v28
    v_fma_f32 v37, v37, v29, v28
    v_cvt_pk_bf16_f32 v46, v36, v37
    v_lshlrev_b32 v36, 16, v47
    v_and_b32 v37, 0xffff0000, v47
    v_fma_f32 v36, v36, v29, v28
    v_mfma_f32_32x32x16_bf16 v[208:223], v[148:151], v[132:135], v[208:223]
    v_fma_f32 v37, v37, v29, v28
    v_cvt_pk_bf16_f32 v47, v36, v37
    ds_write_b128 v14, v[44:47] offset:4608
    v_lshlrev_b32 v36, 16, v48
    v_and_b32 v37, 0xffff0000, v48
    v_fma_f32 v36, v36, v31, v30
    v_fma_f32 v37, v37, v31, v30
    v_cvt_pk_bf16_f32 v48, v36, v37
    v_mfma_f32_32x32x16_bf16 v[224:239], v[152:155], v[132:135], v[224:239]
    v_lshlrev_b32 v36, 16, v49
    v_and_b32 v37, 0xffff0000, v49
    v_fma_f32 v36, v36, v31, v30
    v_fma_f32 v37, v37, v31, v30
    v_cvt_pk_bf16_f32 v49, v36, v37
    v_lshlrev_b32 v36, 16, v50
    v_and_b32 v37, 0xffff0000, v50
    v_fma_f32 v36, v36, v31, v30
    v_mfma_f32_32x32x16_bf16 v[240:255], v[132:135], v[156:159], v[240:255]
    v_fma_f32 v37, v37, v31, v30
    v_cvt_pk_bf16_f32 v50, v36, v37
    v_lshlrev_b32 v36, 16, v51
    v_and_b32 v37, 0xffff0000, v51
    v_fma_f32 v36, v36, v31, v30
    v_fma_f32 v37, v37, v31, v30
    v_cvt_pk_bf16_f32 v51, v36, v37
    ds_write_b128 v14, v[48:51] offset:9216
    s_waitcnt lgkmcnt(2)
    v_mfma_f32_32x32x16_bf16 v[160:175], v[136:139], v[120:123], v[160:175]
    ds_read_b128 v[128:131], v24 offset:96
    ds_read_b128 v[132:135], v24 offset:4704
    ds_read_b64_tr_b16 v[148:149], v25 offset:21504
    ds_read_b64_tr_b16 v[150:151], v25 offset:23296
    ds_read_b64_tr_b16 v[152:153], v25 offset:21632
    ds_read_b64_tr_b16 v[154:155], v25 offset:23424
    v_mfma_f32_32x32x16_bf16 v[176:191], v[140:143], v[120:123], v[176:191]
    ds_read_b64_tr_b16 v[156:157], v25 offset:21760
    ds_read_b64_tr_b16 v[158:159], v25 offset:23552
    v_lshlrev_b32 v36, 16, v52
    v_and_b32 v37, 0xffff0000, v52
    v_fma_f32 v36, v36, v33, v32
    v_fma_f32 v37, v37, v33, v32
    v_mfma_f32_32x32x16_bf16 v[192:207], v[120:123], v[144:147], v[192:207]
    v_cvt_pk_bf16_f32 v52, v36, v37
    v_lshlrev_b32 v36, 16, v53
    v_and_b32 v37, 0xffff0000, v53
    v_fma_f32 v36, v36, v33, v32
    v_fma_f32 v37, v37, v33, v32
    v_cvt_pk_bf16_f32 v53, v36, v37
    v_mfma_f32_32x32x16_bf16 v[208:223], v[136:139], v[124:127], v[208:223]
    v_lshlrev_b32 v36, 16, v54
    v_and_b32 v37, 0xffff0000, v54
    v_fma_f32 v36, v36, v33, v32
    v_fma_f32 v37, v37, v33, v32
    v_cvt_pk_bf16_f32 v54, v36, v37
    v_lshlrev_b32 v36, 16, v55
    v_mfma_f32_32x32x16_bf16 v[224:239], v[140:143], v[124:127], v[224:239]
    v_and_b32 v37, 0xffff0000, v55
    v_fma_f32 v36, v36, v33, v32
    v_fma_f32 v37, v37, v33, v32
    v_cvt_pk_bf16_f32 v55, v36, v37
    ds_write_b128 v14, v[52:55] offset:13824
    ds_write_b128 v15, v[56:59] offset:0
    v_mfma_f32_32x32x16_bf16 v[240:255], v[124:127], v[144:147], v[240:255]
    ds_write_b128 v15, v[60:63] offset:128
    ds_write_b128 v15, v[64:67] offset:256
    ds_write_b128 v15, v[68:71] offset:14336
    ds_write_b128 v15, v[72:75] offset:14464
    ds_write_b128 v15, v[76:79] offset:14592
    s_waitcnt lgkmcnt(0)
    s_barrier
    s_waitcnt lgkmcnt(7)
    v_mfma_f32_32x32x16_bf16 v[160:175], v[148:151], v[128:131], v[160:175]
    ds_read_b128 v[120:123], v22 offset:0
    ds_read_b128 v[124:127], v22 offset:4608
    v_mfma_f32_32x32x16_bf16 v[176:191], v[152:155], v[128:131], v[176:191]
    ds_read_b64_tr_b16 v[136:137], v23 offset:0
    ds_read_b64_tr_b16 v[138:139], v23 offset:1792
    v_mfma_f32_32x32x16_bf16 v[192:207], v[128:131], v[156:159], v[192:207]
    ds_read_b64_tr_b16 v[140:141], v23 offset:128
    v_mfma_f32_32x32x16_bf16 v[208:223], v[148:151], v[132:135], v[208:223]
    ds_read_b64_tr_b16 v[142:143], v23 offset:1920
    v_mfma_f32_32x32x16_bf16 v[224:239], v[152:155], v[132:135], v[224:239]
    ds_read_b64_tr_b16 v[144:145], v23 offset:256
    v_mfma_f32_32x32x16_bf16 v[240:255], v[132:135], v[156:159], v[240:255]
    ds_read_b64_tr_b16 v[146:147], v23 offset:2048
    s_add_u32 s20, s20, 2
    s_cmp_lt_u32 s20, 14
    s_cbranch_scc1 L_qkv1_loop
    s_waitcnt lgkmcnt(0)
    v_mfma_f32_32x32x16_bf16 v[160:175], v[136:139], v[120:123], v[160:175]
    ds_read_b128 v[128:131], v22 offset:32
    ds_read_b128 v[132:135], v22 offset:4640
    ds_read_b64_tr_b16 v[148:149], v23 offset:7168
    ds_read_b64_tr_b16 v[150:151], v23 offset:8960
    ds_read_b64_tr_b16 v[152:153], v23 offset:7296
    v_mfma_f32_32x32x16_bf16 v[176:191], v[140:143], v[120:123], v[176:191]
    ds_read_b64_tr_b16 v[154:155], v23 offset:9088
    ds_read_b64_tr_b16 v[156:157], v23 offset:7424
    ds_read_b64_tr_b16 v[158:159], v23 offset:9216
    s_waitcnt vmcnt(0)
    v_lshlrev_b32 v36, 16, v80
    v_mfma_f32_32x32x16_bf16 v[192:207], v[120:123], v[144:147], v[192:207]
    v_and_b32 v37, 0xffff0000, v80
    v_fma_f32 v36, v36, v27, v26
    v_fma_f32 v37, v37, v27, v26
    v_cvt_pk_bf16_f32 v80, v36, v37
    v_lshlrev_b32 v36, 16, v81
    v_mfma_f32_32x32x16_bf16 v[208:223], v[136:139], v[124:127], v[208:223]
    v_and_b32 v37, 0xffff0000, v81
    v_fma_f32 v36, v36, v27, v26
    v_fma_f32 v37, v37, v27, v26
    v_cvt_pk_bf16_f32 v81, v36, v37
    v_lshlrev_b32 v36, 16, v82
    v_mfma_f32_32x32x16_bf16 v[224:239], v[140:143], v[124:127], v[224:239]
    v_and_b32 v37, 0xffff0000, v82
    v_fma_f32 v36, v36, v27, v26
    v_fma_f32 v37, v37, v27, v26
    v_cvt_pk_bf16_f32 v82, v36, v37
    v_lshlrev_b32 v36, 16, v83
    v_mfma_f32_32x32x16_bf16 v[240:255], v[124:127], v[144:147], v[240:255]
    v_and_b32 v37, 0xffff0000, v83
    v_fma_f32 v36, v36, v27, v26
    v_fma_f32 v37, v37, v27, v26
    v_cvt_pk_bf16_f32 v83, v36, v37
    ds_write_b128 v14, v[80:83] offset:47104
    s_waitcnt lgkmcnt(1)
    v_mfma_f32_32x32x16_bf16 v[160:175], v[148:151], v[128:131], v[160:175]
    ds_read_b128 v[120:123], v22 offset:64
    ds_read_b128 v[124:127], v22 offset:4672
    ds_read_b64_tr_b16 v[136:137], v23 offset:14336
    ds_read_b64_tr_b16 v[138:139], v23 offset:16128
    ds_read_b64_tr_b16 v[140:141], v23 offset:14464
    ds_read_b64_tr_b16 v[142:143], v23 offset:16256
    ds_read_b64_tr_b16 v[144:145], v23 offset:14592
    ds_read_b64_tr_b16 v[146:147], v23 offset:16384
    v_lshlrev_b32 v36, 16, v84
    v_mfma_f32_32x32x16_bf16 v[176:191], v[152:155], v[128:131], v[176:191]
    v_and_b32 v37, 0xffff0000, v84
    v_fma_f32 v36, v36, v29, v28
    v_fma_f32 v37, v37, v29, v28
    v_cvt_pk_bf16_f32 v84, v36, v37
    v_lshlrev_b32 v36, 16, v85
    v_and_b32 v37, 0xffff0000, v85
    v_fma_f32 v36, v36, v29, v28
    v_fma_f32 v37, v37, v29, v28
    v_cvt_pk_bf16_f32 v85, v36, v37
    v_mfma_f32_32x32x16_bf16 v[192:207], v[128:131], v[156:159], v[192:207]
    v_lshlrev_b32 v36, 16, v86
    v_and_b32 v37, 0xffff0000, v86
    v_fma_f32 v36, v36, v29, v28
    v_fma_f32 v37, v37, v29, v28
    v_cvt_pk_bf16_f32 v86, v36, v37
    v_lshlrev_b32 v36, 16, v87
    v_and_b32 v37, 0xffff0000, v87
    v_fma_f32 v36, v36, v29, v28
    v_mfma_f32_32x32x16_bf16 v[208:223], v[148:151], v[132:135], v[208:223]
    v_fma_f32 v37, v37, v29, v28
    v_cvt_pk_bf16_f32 v87, v36, v37
    ds_write_b128 v14, v[84:87] offset:51712
    v_lshlrev_b32 v36, 16, v88
    v_and_b32 v37, 0xffff0000, v88
    v_fma_f32 v36, v36, v31, v30
    v_fma_f32 v37, v37, v31, v30
    v_cvt_pk_bf16_f32 v88, v36, v37
    v_mfma_f32_32x32x16_bf16 v[224:239], v[152:155], v[132:135], v[224:239]
    v_lshlrev_b32 v36, 16, v89
    v_and_b32 v37, 0xffff0000, v89
    v_fma_f32 v36, v36, v31, v30
    v_fma_f32 v37, v37, v31, v30
    v_cvt_pk_bf16_f32 v89, v36, v37
    v_lshlrev_b32 v36, 16, v90
    v_and_b32 v37, 0xffff0000, v90
    v_fma_f32 v36, v36, v31, v30
    v_mfma_f32_32x32x16_bf16 v[240:255], v[132:135], v[156:159], v[240:255]
    v_fma_f32 v37, v37, v31, v30
    v_cvt_pk_bf16_f32 v90, v36, v37
    v_lshlrev_b32 v36, 16, v91
    v_and_b32 v37, 0xffff0000, v91
    v_fma_f32 v36, v36, v31, v30
    v_fma_f32 v37, v37, v31, v30
    v_cvt_pk_bf16_f32 v91, v36, v37
    ds_write_b128 v14, v[88:91] offset:56320
    s_waitcnt lgkmcnt(2)
    v_mfma_f32_32x32x16_bf16 v[160:175], v[136:139], v[120:123], v[160:175]
    ds_read_b128 v[128:131], v22 offset:96
    ds_read_b128 v[132:135], v22 offset:4704
    ds_read_b64_tr_b16 v[148:149], v23 offset:21504
    ds_read_b64_tr_b16 v[150:151], v23 offset:23296
    ds_read_b64_tr_b16 v[152:153], v23 offset:21632
    ds_read_b64_tr_b16 v[154:155], v23 offset:23424
    v_mfma_f32_32x32x16_bf16 v[176:191], v[140:143], v[120:123], v[176:191]
    ds_read_b64_tr_b16 v[156:157], v23 offset:21760
    ds_read_b64_tr_b16 v[158:159], v23 offset:23552
    v_lshlrev_b32 v36, 16, v92
    v_and_b32 v37, 0xffff0000, v92
    v_fma_f32 v36, v36, v33, v32
    v_fma_f32 v37, v37, v33, v32
    v_mfma_f32_32x32x16_bf16 v[192:207], v[120:123], v[144:147], v[192:207]
    v_cvt_pk_bf16_f32 v92, v36, v37
    v_lshlrev_b32 v36, 16, v93
    v_and_b32 v37, 0xffff0000, v93
    v_fma_f32 v36, v36, v33, v32
    v_fma_f32 v37, v37, v33, v32
    v_cvt_pk_bf16_f32 v93, v36, v37
    v_mfma_f32_32x32x16_bf16 v[208:223], v[136:139], v[124:127], v[208:223]
    v_lshlrev_b32 v36, 16, v94
    v_and_b32 v37, 0xffff0000, v94
    v_fma_f32 v36, v36, v33, v32
    v_fma_f32 v37, v37, v33, v32
    v_cvt_pk_bf16_f32 v94, v36, v37
    v_lshlrev_b32 v36, 16, v95
    v_mfma_f32_32x32x16_bf16 v[224:239], v[140:143], v[124:127], v[224:239]
    v_and_b32 v37, 0xffff0000, v95
    v_fma_f32 v36, v36, v33, v32
    v_fma_f32 v37, v37, v33, v32
    v_cvt_pk_bf16_f32 v95, v36, v37
    ds_write_b128 v14, v[92:95] offset:60928
    ds_write_b128 v15, v[96:99] offset:47104
    v_mfma_f32_32x32x16_bf16 v[240:255], v[124:127], v[144:147], v[240:255]
    ds_write_b128 v15, v[100:103] offset:47232
    ds_write_b128 v15, v[104:107] offset:47360
    ds_write_b128 v15, v[108:111] offset:61440
    ds_write_b128 v15, v[112:115] offset:61568
    ds_write_b128 v15, v[116:119] offset:61696
    s_waitcnt lgkmcnt(0)
    s_barrier
    s_waitcnt lgkmcnt(7)
    v_mfma_f32_32x32x16_bf16 v[160:175], v[148:151], v[128:131], v[160:175]
    ds_read_b128 v[120:123], v24 offset:0
    ds_read_b128 v[124:127], v24 offset:4608
    v_mfma_f32_32x32x16_bf16 v[176:191], v[152:155], v[128:131], v[176:191]
    ds_read_b64_tr_b16 v[136:137], v25 offset:0
    ds_read_b64_tr_b16 v[138:139], v25 offset:1792
    v_mfma_f32_32x32x16_bf16 v[192:207], v[128:131], v[156:159], v[192:207]
    ds_read_b64_tr_b16 v[140:141], v25 offset:128
    v_mfma_f32_32x32x16_bf16 v[208:223], v[148:151], v[132:135], v[208:223]
    ds_read_b64_tr_b16 v[142:143], v25 offset:1920
    v_mfma_f32_32x32x16_bf16 v[224:239], v[152:155], v[132:135], v[224:239]
    ds_read_b64_tr_b16 v[144:145], v25 offset:256
    v_mfma_f32_32x32x16_bf16 v[240:255], v[132:135], v[156:159], v[240:255]
    ds_read_b64_tr_b16 v[146:147], v25 offset:2048
    s_waitcnt lgkmcnt(0)
    v_mfma_f32_32x32x16_bf16 v[160:175], v[136:139], v[120:123], v[160:175]
    ds_read_b128 v[128:131], v24 offset:32
    ds_read_b128 v[132:135], v24 offset:4640
    v_mfma_f32_32x32x16_bf16 v[176:191], v[140:143], v[120:123], v[176:191]
    ds_read_b64_tr_b16 v[148:149], v25 offset:7168
    ds_read_b64_tr_b16 v[150:151], v25 offset:8960
    v_mfma_f32_32x32x16_bf16 v[192:207], v[120:123], v[144:147], v[192:207]
    ds_read_b64_tr_b16 v[152:153], v25 offset:7296
    v_mfma_f32_32x32x16_bf16 v[208:223], v[136:139], v[124:127], v[208:223]
    ds_read_b64_tr_b16 v[154:155], v25 offset:9088
    v_mfma_f32_32x32x16_bf16 v[224:239], v[140:143], v[124:127], v[224:239]
    ds_read_b64_tr_b16 v[156:157], v25 offset:7424
    v_mfma_f32_32x32x16_bf16 v[240:255], v[124:127], v[144:147], v[240:255]
    ds_read_b64_tr_b16 v[158:159], v25 offset:9216
    s_waitcnt lgkmcnt(0)
    v_mfma_f32_32x32x16_bf16 v[160:175], v[148:151], v[128:131], v[160:175]
    ds_read_b128 v[120:123], v24 offset:64
    ds_read_b128 v[124:127], v24 offset:4672
    v_mfma_f32_32x32x16_bf16 v[176:191], v[152:155], v[128:131], v[176:191]
    ds_read_b64_tr_b16 v[136:137], v25 offset:14336
    ds_read_b64_tr_b16 v[138:139], v25 offset:16128
    v_mfma_f32_32x32x16_bf16 v[192:207], v[128:131], v[156:159], v[192:207]
    ds_read_b64_tr_b16 v[140:141], v25 offset:14464
    v_mfma_f32_32x32x16_bf16 v[208:223], v[148:151], v[132:135], v[208:223]
    ds_read_b64_tr_b16 v[142:143], v25 offset:16256
    v_mfma_f32_32x32x16_bf16 v[224:239], v[152:155], v[132:135], v[224:239]
    ds_read_b64_tr_b16 v[144:145], v25 offset:14592
    v_mfma_f32_32x32x16_bf16 v[240:255], v[132:135], v[156:159], v[240:255]
    ds_read_b64_tr_b16 v[146:147], v25 offset:16384
    s_waitcnt lgkmcnt(0)
    v_mfma_f32_32x32x16_bf16 v[160:175], v[136:139], v[120:123], v[160:175]
    ds_read_b128 v[128:131], v24 offset:96
    ds_read_b128 v[132:135], v24 offset:4704
    v_mfma_f32_32x32x16_bf16 v[176:191], v[140:143], v[120:123], v[176:191]
    ds_read_b64_tr_b16 v[148:149], v25 offset:21504
    ds_read_b64_tr_b16 v[150:151], v25 offset:23296
    v_mfma_f32_32x32x16_bf16 v[192:207], v[120:123], v[144:147], v[192:207]
    ds_read_b64_tr_b16 v[152:153], v25 offset:21632
    v_mfma_f32_32x32x16_bf16 v[208:223], v[136:139], v[124:127], v[208:223]
    ds_read_b64_tr_b16 v[154:155], v25 offset:23424
    v_mfma_f32_32x32x16_bf16 v[224:239], v[140:143], v[124:127], v[224:239]
    ds_read_b64_tr_b16 v[156:157], v25 offset:21760
    v_mfma_f32_32x32x16_bf16 v[240:255], v[124:127], v[144:147], v[240:255]
    ds_read_b64_tr_b16 v[158:159], v25 offset:23552
    s_waitcnt lgkmcnt(0)
    v_mfma_f32_32x32x16_bf16 v[160:175], v[148:151], v[128:131], v[160:175]
    v_mfma_f32_32x32x16_bf16 v[176:191], v[152:155], v[128:131], v[176:191]
    v_mfma_f32_32x32x16_bf16 v[192:207], v[128:131], v[156:159], v[192:207]
    v_mfma_f32_32x32x16_bf16 v[208:223], v[148:151], v[132:135], v[208:223]
    v_mfma_f32_32x32x16_bf16 v[224:239], v[152:155], v[132:135], v[224:239]
    v_mfma_f32_32x32x16_bf16 v[240:255], v[132:135], v[156:159], v[240:255]
    s_nop 15
    s_nop 7
    s_load_dwordx2 s[14:15], s[0:1], 64
    s_waitcnt lgkmcnt(0)
    s_add_u32 s14, s14, 0
    s_addc_u32 s15, s15, 0
    s_barrier
    s_lshl_b32 s12, s9, 1
    v_add_u32 v26, s12, v19
    v_lshl_add_u32 v27, v18, 6, s10
    v_mul_u32_u24 v24, 15360, v17
    v_mul_u32_u24 v22, 80, v20
    v_add_u32 v22, v22, v24
    v_lshl_add_u32 v22, v21, 3, v22
    v_mul_u32_u24 v23, 144, v20
    v_add_u32 v23, v23, v24
    v_lshl_add_u32 v23, v21, 4, v23
    v_lshrrev_b32 v25, 2, v16
    v_mul_u32_u24 v25, 80, v25
    v_and_b32 v30, 3, v16
    v_lshl_add_u32 v25, v30, 4, v25
    v_add_u32 v25, v25, v24
    v_lshrrev_b32 v31, 3, v16
    v_mul_u32_u24 v31, 144, v31
    v_and_b32 v30, 7, v16
    v_lshl_add_u32 v31, v30, 4, v31
    v_add_u32 v31, v31, v24
    v_mov_b32 v15, v31
    v_lshlrev_b32 v28, 11, v26
    v_add_u32 v28, v28, v27
    v_lshlrev_b32 v28, 6, v28
    v_lshl_add_u32 v28, v16, 4, v28
    v_lshrrev_b32 v29, 5, v27
    v_lshl_add_u32 v29, v26, 6, v29
    v_bfe_u32 v30, v16, 2, 1
    v_add_u32 v29, v29, v30
    v_lshrrev_b32 v30, 3, v16
    v_lshl_add_u32 v29, v29, 5, v30
    v_lshlrev_b32 v29, 6, v29
    v_and_b32 v30, 3, v16
    v_lshl_add_u32 v29, v30, 4, v29
    v_cvt_pk_bf16_f32 v32, v160, v161
    v_cvt_pk_bf16_f32 v33, v162, v163
    v_cvt_pk_bf16_f32 v34, v164, v165
    v_cvt_pk_bf16_f32 v35, v166, v167
    v_cvt_pk_bf16_f32 v36, v168, v169
    v_cvt_pk_bf16_f32 v37, v170, v171
    v_cvt_pk_bf16_f32 v38, v172, v173
    v_cvt_pk_bf16_f32 v39, v174, v175
    ds_write_b64 v22, v[32:33] offset:0
    ds_write_b64 v22, v[34:35] offset:16
    ds_write_b64 v22, v[36:37] offset:32
    ds_write_b64 v22, v[38:39] offset:48
    v_cvt_pk_bf16_f32 v32, v208, v209
    v_cvt_pk_bf16_f32 v33, v210, v211
    v_cvt_pk_bf16_f32 v34, v212, v213
    v_cvt_pk_bf16_f32 v35, v214, v215
    v_cvt_pk_bf16_f32 v36, v216, v217
    v_cvt_pk_bf16_f32 v37, v218, v219
    v_cvt_pk_bf16_f32 v38, v220, v221
    v_cvt_pk_bf16_f32 v39, v222, v223
    ds_write_b64 v22, v[32:33] offset:2560
    ds_write_b64 v22, v[34:35] offset:2576
    ds_write_b64 v22, v[36:37] offset:2592
    ds_write_b64 v22, v[38:39] offset:2608
    v_cvt_pk_bf16_f32 v32, v176, v177
    v_cvt_pk_bf16_f32 v33, v178, v179
    v_cvt_pk_bf16_f32 v34, v180, v181
    v_cvt_pk_bf16_f32 v35, v182, v183
    v_cvt_pk_bf16_f32 v36, v184, v185
    v_cvt_pk_bf16_f32 v37, v186, v187
    v_cvt_pk_bf16_f32 v38, v188, v189
    v_cvt_pk_bf16_f32 v39, v190, v191
    ds_write_b64 v22, v[32:33] offset:5120
    ds_write_b64 v22, v[34:35] offset:5136
    ds_write_b64 v22, v[36:37] offset:5152
    ds_write_b64 v22, v[38:39] offset:5168
    v_cvt_pk_bf16_f32 v32, v224, v225
    v_cvt_pk_bf16_f32 v33, v226, v227
    v_cvt_pk_bf16_f32 v34, v228, v229
    v_cvt_pk_bf16_f32 v35, v230, v231
    v_cvt_pk_bf16_f32 v36, v232, v233
    v_cvt_pk_bf16_f32 v37, v234, v235
    v_cvt_pk_bf16_f32 v38, v236, v237
    v_cvt_pk_bf16_f32 v39, v238, v239
    ds_write_b64 v22, v[32:33] offset:7680
    ds_write_b64 v22, v[34:35] offset:7696
    ds_write_b64 v22, v[36:37] offset:7712
    ds_write_b64 v22, v[38:39] offset:7728
    v_cvt_pk_bf16_f32 v32, v192, v193
    v_cvt_pk_bf16_f32 v33, v194, v195
    v_cvt_pk_bf16_f32 v34, v196, v197
    v_cvt_pk_bf16_f32 v35, v198, v199
    v_cvt_pk_bf16_f32 v36, v200, v201
    v_cvt_pk_bf16_f32 v37, v202, v203
    v_cvt_pk_bf16_f32 v38, v204, v205
    v_cvt_pk_bf16_f32 v39, v206, v207
    ds_write_b64 v23, v[32:33] offset:10240
    ds_write_b64 v23, v[34:35] offset:10248
    ds_write_b64 v23, v[36:37] offset:10272
    ds_write_b64 v23, v[38:39] offset:10280
    v_cvt_pk_bf16_f32 v32, v240, v241
    v_cvt_pk_bf16_f32 v33, v242, v243
    v_cvt_pk_bf16_f32 v34, v244, v245
    v_cvt_pk_bf16_f32 v35, v246, v247
    v_cvt_pk_bf16_f32 v36, v248, v249
    v_cvt_pk_bf16_f32 v37, v250, v251
    v_cvt_pk_bf16_f32 v38, v252, v253
    v_cvt_pk_bf16_f32 v39, v254, v255
    ds_write_b64 v23, v[32:33] offset:10304
    ds_write_b64 v23, v[34:35] offset:10312
    ds_write_b64 v23, v[36:37] offset:10336
    ds_write_b64 v23, v[38:39] offset:10344
    s_waitcnt lgkmcnt(0)
    ds_read_b128 v[40:43], v25 offset:0
    ds_read_b128 v[44:47], v25 offset:1280
    ds_read_b128 v[48:51], v25 offset:2560
    ds_read_b128 v[52:55], v25 offset:3840
    ds_read_b128 v[56:59], v25 offset:5120
    ds_read_b128 v[60:63], v25 offset:6400
    ds_read_b128 v[64:67], v25 offset:7680
    ds_read_b128 v[68:71], v25 offset:8960
    ds_read_b128 v[72:75], v15 offset:10240
    ds_read_b128 v[76:79], v15 offset:11392
    ds_read_b128 v[80:83], v15 offset:12544
    ds_read_b128 v[84:87], v15 offset:13696
    s_waitcnt lgkmcnt(8)
    v_add_u32 v30, 8388608, v28
    global_store_dwordx4 v30, v[40:43], s[14:15]
    v_add_u32 v30, 8389632, v28
    global_store_dwordx4 v30, v[44:47], s[14:15]
    v_add_u32 v30, 8390656, v28
    global_store_dwordx4 v30, v[48:51], s[14:15]
    v_add_u32 v30, 8391680, v28
    global_store_dwordx4 v30, v[52:55], s[14:15]
    s_waitcnt lgkmcnt(4)
    v_add_u32 v30, 12582912, v28
    global_store_dwordx4 v30, v[56:59], s[14:15]
    v_add_u32 v30, 12583936, v28
    global_store_dwordx4 v30, v[60:63], s[14:15]
    v_add_u32 v30, 12584960, v28
    global_store_dwordx4 v30, v[64:67], s[14:15]
    v_add_u32 v30, 12585984, v28
    global_store_dwordx4 v30, v[68:71], s[14:15]
    s_waitcnt lgkmcnt(0)
    v_add_u32 v30, 16777216, v29
    global_store_dwordx4 v30, v[72:75], s[14:15]
    v_add_u32 v30, 16777728, v29
    global_store_dwordx4 v30, v[76:79], s[14:15]
    v_add_u32 v30, 16778240, v29
    global_store_dwordx4 v30, v[80:83], s[14:15]
    v_add_u32 v30, 16778752, v29
    global_store_dwordx4 v30, v[84:87], s[14:15]
L_qkv1_end:
    s_endpgm
.globl attb1_kernel
.p2align 8
.type attb1_kernel,@function
attb1_kernel:
    s_cmp_ge_u32 s2, 512
    s_cbranch_scc1 L_attb1_end
    s_load_dwordx2 s[4:5], s[0:1], 64
    s_load_dwordx2 s[6:7], s[0:1], 64
    s_load_dwordx2 s[16:17], s[0:1], 64
    s_load_dwordx2 s[18:19], s[0:1], 64
    s_waitcnt lgkmcnt(0)
    s_add_u32 s4, s4, 8388608
    s_addc_u32 s5, s5, 0
    s_add_u32 s6, s6, 12582912
    s_addc_u32 s7, s7, 0
    s_add_u32 s16, s16, 16777216
    s_addc_u32 s17, s17, 0
    s_add_u32 s18, s18, 20971520
    s_addc_u32 s19, s19, 0
    s_lshr_b32 s8, s2, 4
    s_and_b32 s9, s2, 15
    v_lshrrev_b32 v1, 6, v0
    s_nop 0
    v_readfirstlane_b32 s10, v1
    s_lshl_b32 s11, s9, 2
    s_add_u32 s11, s11, s10
    s_lshl_b32 s12, s11, 5
    v_and_b32 v2, 63, v0
    v_and_b32 v3, 31, v2
    v_lshrrev_b32 v4, 5, v2
    s_lshl_b32 s13, s8, 11
    v_add_u32 v5, s13, v3
    v_lshlrev_b32 v5, 6, v5
    v_lshl_add_u32 v5, v4, 4, v5
    s_lshl_b32 s14, s12, 6
    v_add_u32 v6, s14, v5
    global_load_dwordx4 v[8:11], v6, s[4:5]
    global_load_dwordx4 v[12:15], v6, s[4:5] offset:32
    s_lshl_b32 s15, s8, 5
    v_add_u32 v7, s15, v3
    v_lshlrev_b32 v7, 12, v7
    v_lshl_add_u32 v7, v4, 4, v7
    s_add_u32 s20, s11, 0
    s_cmp_lt_u32 s20, 8
    s_cbranch_scc1 L_attb1_kskip0
    s_add_u32 s21, s14, -16384
    v_add_u32 v1, s21, v5
    global_load_dwordx4 v[176:179], v1, s[6:7]
    global_load_dwordx4 v[180:183], v1, s[6:7] offset:32
L_attb1_kskip0:
    s_add_u32 s20, s11, 1
    s_cmp_lt_u32 s20, 8
    s_cbranch_scc1 L_attb1_kskip1
    s_add_u32 s21, s14, -14336
    v_add_u32 v1, s21, v5
    global_load_dwordx4 v[184:187], v1, s[6:7]
    global_load_dwordx4 v[188:191], v1, s[6:7] offset:32
L_attb1_kskip1:
    s_add_u32 s20, s11, 2
    s_cmp_lt_u32 s20, 8
    s_cbranch_scc1 L_attb1_kskip2
    s_add_u32 s21, s14, -12288
    v_add_u32 v1, s21, v5
    global_load_dwordx4 v[192:195], v1, s[6:7]
    global_load_dwordx4 v[196:199], v1, s[6:7] offset:32
L_attb1_kskip2:
    s_add_u32 s20, s11, 3
    s_cmp_lt_u32 s20, 8
    s_cbranch_scc1 L_attb1_kskip3
    s_add_u32 s21, s14, -10240
    v_add_u32 v1, s21, v5
    global_load_dwordx4 v[200:203], v1, s[6:7]
    global_load_dwordx4 v[204:207], v1, s[6:7] offset:32
L_attb1_kskip3:
    s_add_u32 s20, s11, 4
    s_cmp_lt_u32 s20, 8
    s_cbranch_scc1 L_attb1_kskip4
    s_add_u32 s21, s14, -8192
    v_add_u32 v1, s21, v5
    global_load_dwordx4 v[208:211], v1, s[6:7]
    global_load_dwordx4 v[212:215], v1, s[6:7] offset:32
L_attb1_kskip4:
    s_add_u32 s20, s11, 5
    s_cmp_lt_u32 s20, 8
    s_cbranch_scc1 L_attb1_kskip5
    s_add_u32 s21, s14, -6144
    v_add_u32 v1, s21, v5
    global_load_dwordx4 v[216:219], v1, s[6:7]
    global_load_dwordx4 v[220:223], v1, s[6:7] offset:32
L_attb1_kskip5:
    s_add_u32 s20, s11, 6
    s_cmp_lt_u32 s20, 8
    s_cbranch_scc1 L_attb1_kskip6
    s_add_u32 s21, s14, -4096
    v_add_u32 v1, s21, v5
    global_load_dwordx4 v[224:227], v1, s[6:7]
    global_load_dwordx4 v[228:231], v1, s[6:7] offset:32
L_attb1_kskip6:
    s_add_u32 s20, s11, 7
    s_cmp_lt_u32 s20, 8
    s_cbranch_scc1 L_attb1_kskip7
    s_add_u32 s21, s14, -2048
    v_add_u32 v1, s21, v5
    global_load_dwordx4 v[232:235], v1, s[6:7]
    global_load_dwordx4 v[236:239], v1, s[6:7] offset:32
L_attb1_kskip7:
    s_add_u32 s20, s11, 8
    s_cmp_lt_u32 s20, 8
    s_cbranch_scc1 L_attb1_kskip8
    s_add_u32 s21, s14, 0
    v_add_u32 v1, s21, v5
    global_load_dwordx4 v[240:243], v1, s[6:7]
    global_load_dwordx4 v[244:247], v1, s[6:7] offset:32
L_attb1_kskip8:
    s_waitcnt vmcnt(0)
    s_add_u32 s20, s11, 0
    s_cmp_lt_u32 s20, 8
    s_cbranch_scc1 L_attb1_sinv0
    v_mfma_f32_32x32x16_bf16 v[32:47], v[176:179], v[8:11], 0
    v_mfma_f32_32x32x16_bf16 v[32:47], v[180:183], v[12:15], v[32:47]
    s_branch L_attb1_sdone0
L_attb1_sinv0:
    v_mov_b32 v32, 4048155338
    v_mov_b32 v33, 4048155338
    v_mov_b32 v34, 4048155338
    v_mov_b32 v35, 4048155338
    v_mov_b32 v36, 4048155338
    v_mov_b32 v37, 4048155338
    v_mov_b32 v38, 4048155338
    v_mov_b32 v39, 4048155338
    v_mov_b32 v40, 4048155338
    v_mov_b32 v41, 4048155338
    v_mov_b32 v42, 4048155338
    v_mov_b32 v43, 4048155338
    v_mov_b32 v44, 4048155338
    v_mov_b32 v45, 4048155338
    v_mov_b32 v46, 4048155338
    v_mov_b32 v47, 4048155338
L_attb1_sdone0:
    s_add_u32 s20, s11, 1
    s_cmp_lt_u32 s20, 8
    s_cbranch_scc1 L_attb1_sinv1
    v_mfma_f32_32x32x16_bf16 v[48:63], v[184:187], v[8:11], 0
    v_mfma_f32_32x32x16_bf16 v[48:63], v[188:191], v[12:15], v[48:63]
    s_branch L_attb1_sdone1
L_attb1_sinv1:
    v_mov_b32 v48, 4048155338
    v_mov_b32 v49, 4048155338
    v_mov_b32 v50, 4048155338
    v_mov_b32 v51, 4048155338
    v_mov_b32 v52, 4048155338
    v_mov_b32 v53, 4048155338
    v_mov_b32 v54, 4048155338
    v_mov_b32 v55, 4048155338
    v_mov_b32 v56, 4048155338
    v_mov_b32 v57, 4048155338
    v_mov_b32 v58, 4048155338
    v_mov_b32 v59, 4048155338
    v_mov_b32 v60, 4048155338
    v_mov_b32 v61, 4048155338
    v_mov_b32 v62, 4048155338
    v_mov_b32 v63, 4048155338
L_attb1_sdone1:
    s_add_u32 s20, s11, 2
    s_cmp_lt_u32 s20, 8
    s_cbranch_scc1 L_attb1_sinv2
    v_mfma_f32_32x32x16_bf16 v[64:79], v[192:195], v[8:11], 0
    v_mfma_f32_32x32x16_bf16 v[64:79], v[196:199], v[12:15], v[64:79]
    s_branch L_attb1_sdone2
L_attb1_sinv2:
    v_mov_b32 v64, 4048155338
    v_mov_b32 v65, 4048155338
    v_mov_b32 v66, 4048155338
    v_mov_b32 v67, 4048155338
    v_mov_b32 v68, 4048155338
    v_mov_b32 v69, 4048155338
    v_mov_b32 v70, 4048155338
    v_mov_b32 v71, 4048155338
    v_mov_b32 v72, 4048155338
    v_mov_b32 v73, 4048155338
    v_mov_b32 v74, 4048155338
    v_mov_b32 v75, 4048155338
    v_mov_b32 v76, 4048155338
    v_mov_b32 v77, 4048155338
    v_mov_b32 v78, 4048155338
    v_mov_b32 v79, 4048155338
L_attb1_sdone2:
    s_add_u32 s20, s11, 3
    s_cmp_lt_u32 s20, 8
    s_cbranch_scc1 L_attb1_sinv3
    v_mfma_f32_32x32x16_bf16 v[80:95], v[200:203], v[8:11], 0
    v_mfma_f32_32x32x16_bf16 v[80:95], v[204:207], v[12:15], v[80:95]
    s_branch L_attb1_sdone3
L_attb1_sinv3:
    v_mov_b32 v80, 4048155338
    v_mov_b32 v81, 4048155338
    v_mov_b32 v82, 4048155338
    v_mov_b32 v83, 4048155338
    v_mov_b32 v84, 4048155338
    v_mov_b32 v85, 4048155338
    v_mov_b32 v86, 4048155338
    v_mov_b32 v87, 4048155338
    v_mov_b32 v88, 4048155338
    v_mov_b32 v89, 4048155338
    v_mov_b32 v90, 4048155338
    v_mov_b32 v91, 4048155338
    v_mov_b32 v92, 4048155338
    v_mov_b32 v93, 4048155338
    v_mov_b32 v94, 4048155338
    v_mov_b32 v95, 4048155338
L_attb1_sdone3:
    s_add_u32 s20, s11, 4
    s_cmp_lt_u32 s20, 8
    s_cbranch_scc1 L_attb1_sinv4
    v_mfma_f32_32x32x16_bf16 v[96:111], v[208:211], v[8:11], 0
    v_mfma_f32_32x32x16_bf16 v[96:111], v[212:215], v[12:15], v[96:111]
    s_branch L_attb1_sdone4
L_attb1_sinv4:
    v_mov_b32 v96, 4048155338
    v_mov_b32 v97, 4048155338
    v_mov_b32 v98, 4048155338
    v_mov_b32 v99, 4048155338
    v_mov_b32 v100, 4048155338
    v_mov_b32 v101, 4048155338
    v_mov_b32 v102, 4048155338
    v_mov_b32 v103, 4048155338
    v_mov_b32 v104, 4048155338
    v_mov_b32 v105, 4048155338
    v_mov_b32 v106, 4048155338
    v_mov_b32 v107, 4048155338
    v_mov_b32 v108, 4048155338
    v_mov_b32 v109, 4048155338
    v_mov_b32 v110, 4048155338
    v_mov_b32 v111, 4048155338
L_attb1_sdone4:
    s_add_u32 s20, s11, 5
    s_cmp_lt_u32 s20, 8
    s_cbranch_scc1 L_attb1_sinv5
    v_mfma_f32_32x32x16_bf16 v[112:127], v[216:219], v[8:11], 0
    v_mfma_f32_32x32x16_bf16 v[112:127], v[220:223], v[12:15], v[112:127]
    s_branch L_attb1_sdone5
L_attb1_sinv5:
    v_mov_b32 v112, 4048155338
    v_mov_b32 v113, 4048155338
    v_mov_b32 v114, 4048155338
    v_mov_b32 v115, 4048155338
    v_mov_b32 v116, 4048155338
    v_mov_b32 v117, 4048155338
    v_mov_b32 v118, 4048155338
    v_mov_b32 v119, 4048155338
    v_mov_b32 v120, 4048155338
    v_mov_b32 v121, 4048155338
    v_mov_b32 v122, 4048155338
    v_mov_b32 v123, 4048155338
    v_mov_b32 v124, 4048155338
    v_mov_b32 v125, 4048155338
    v_mov_b32 v126, 4048155338
    v_mov_b32 v127, 4048155338
L_attb1_sdone5:
    s_add_u32 s20, s11, 6
    s_cmp_lt_u32 s20, 8
    s_cbranch_scc1 L_attb1_sinv6
    v_mfma_f32_32x32x16_bf16 v[128:143], v[224:227], v[8:11], 0
    v_mfma_f32_32x32x16_bf16 v[128:143], v[228:231], v[12:15], v[128:143]
    s_branch L_attb1_sdone6
L_attb1_sinv6:
    v_mov_b32 v128, 4048155338
    v_mov_b32 v129, 4048155338
    v_mov_b32 v130, 4048155338
    v_mov_b32 v131, 4048155338
    v_mov_b32 v132, 4048155338
    v_mov_b32 v133, 4048155338
    v_mov_b32 v134, 4048155338
    v_mov_b32 v135, 4048155338
    v_mov_b32 v136, 4048155338
    v_mov_b32 v137, 4048155338
    v_mov_b32 v138, 4048155338
    v_mov_b32 v139, 4048155338
    v_mov_b32 v140, 4048155338
    v_mov_b32 v141, 4048155338
    v_mov_b32 v142, 4048155338
    v_mov_b32 v143, 4048155338
L_attb1_sdone6:
    s_add_u32 s20, s11, 7
    s_cmp_lt_u32 s20, 8
    s_cbranch_scc1 L_attb1_sinv7
    v_mfma_f32_32x32x16_bf16 v[144:159], v[232:235], v[8:11], 0
    v_mfma_f32_32x32x16_bf16 v[144:159], v[236:239], v[12:15], v[144:159]
    s_branch L_attb1_sdone7
L_attb1_sinv7:
    v_mov_b32 v144, 4048155338
    v_mov_b32 v145, 4048155338
    v_mov_b32 v146, 4048155338
    v_mov_b32 v147, 4048155338
    v_mov_b32 v148, 4048155338
    v_mov_b32 v149, 4048155338
    v_mov_b32 v150, 4048155338
    v_mov_b32 v151, 4048155338
    v_mov_b32 v152, 4048155338
    v_mov_b32 v153, 4048155338
    v_mov_b32 v154, 4048155338
    v_mov_b32 v155, 4048155338
    v_mov_b32 v156, 4048155338
    v_mov_b32 v157, 4048155338
    v_mov_b32 v158, 4048155338
    v_mov_b32 v159, 4048155338
L_attb1_sdone7:
    s_add_u32 s20, s11, 8
    s_cmp_lt_u32 s20, 8
    s_cbranch_scc1 L_attb1_sinv8
    v_mfma_f32_32x32x16_bf16 v[160:175], v[240:243], v[8:11], 0
    v_mfma_f32_32x32x16_bf16 v[160:175], v[244:247], v[12:15], v[160:175]
    s_branch L_attb1_sdone8
L_attb1_sinv8:
    v_mov_b32 v160, 4048155338
    v_mov_b32 v161, 4048155338
    v_mov_b32 v162, 4048155338
    v_mov_b32 v163, 4048155338
    v_mov_b32 v164, 4048155338
    v_mov_b32 v165, 4048155338
    v_mov_b32 v166, 4048155338
    v_mov_b32 v167, 4048155338
    v_mov_b32 v168, 4048155338
    v_mov_b32 v169, 4048155338
    v_mov_b32 v170, 4048155338
    v_mov_b32 v171, 4048155338
    v_mov_b32 v172, 4048155338
    v_mov_b32 v173, 4048155338
    v_mov_b32 v174, 4048155338
    v_mov_b32 v175, 4048155338
L_attb1_sdone8:
    s_nop 15
    s_nop 3
    v_lshlrev_b32 v1, 2, v4
    v_mov_b32 v16, 4048155338
    v_add_u32 v17, 0, v1
    v_cmp_gt_u32 vcc, v17, v3
    s_nop 1
    v_cndmask_b32 v32, v16, v32, vcc
    v_cmp_le_u32 vcc, v17, v3
    s_nop 1
    v_cndmask_b32 v160, v16, v160, vcc
    v_add_u32 v17, 1, v1
    v_cmp_gt_u32 vcc, v17, v3
    s_nop 1
    v_cndmask_b32 v33, v16, v33, vcc
    v_cmp_le_u32 vcc, v17, v3
    s_nop 1
    v_cndmask_b32 v161, v16, v161, vcc
    v_add_u32 v17, 2, v1
    v_cmp_gt_u32 vcc, v17, v3
    s_nop 1
    v_cndmask_b32 v34, v16, v34, vcc
    v_cmp_le_u32 vcc, v17, v3
    s_nop 1
    v_cndmask_b32 v162, v16, v162, vcc
    v_add_u32 v17, 3, v1
    v_cmp_gt_u32 vcc, v17, v3
    s_nop 1
    v_cndmask_b32 v35, v16, v35, vcc
    v_cmp_le_u32 vcc, v17, v3
    s_nop 1
    v_cndmask_b32 v163, v16, v163, vcc
    v_add_u32 v17, 8, v1
    v_cmp_gt_u32 vcc, v17, v3
    s_nop 1
    v_cndmask_b32 v36, v16, v36, vcc
    v_cmp_le_u32 vcc, v17, v3
    s_nop 1
    v_cndmask_b32 v164, v16, v164, vcc
    v_add_u32 v17, 9, v1
    v_cmp_gt_u32 vcc, v17, v3
    s_nop 1
    v_cndmask_b32 v37, v16, v37, vcc
    v_cmp_le_u32 vcc, v17, v3
    s_nop 1
    v_cndmask_b32 v165, v16, v165, vcc
    v_add_u32 v17, 10, v1
    v_cmp_gt_u32 vcc, v17, v3
    s_nop 1
    v_cndmask_b32 v38, v16, v38, vcc
    v_cmp_le_u32 vcc, v17, v3
    s_nop 1
    v_cndmask_b32 v166, v16, v166, vcc
    v_add_u32 v17, 11, v1
    v_cmp_gt_u32 vcc, v17, v3
    s_nop 1
    v_cndmask_b32 v39, v16, v39, vcc
    v_cmp_le_u32 vcc, v17, v3
    s_nop 1
    v_cndmask_b32 v167, v16, v167, vcc
    v_add_u32 v17, 16, v1
    v_cmp_gt_u32 vcc, v17, v3
    s_nop 1
    v_cndmask_b32 v40, v16, v40, vcc
    v_cmp_le_u32 vcc, v17, v3
    s_nop 1
    v_cndmask_b32 v168, v16, v168, vcc
    v_add_u32 v17, 17, v1
    v_cmp_gt_u32 vcc, v17, v3
    s_nop 1
    v_cndmask_b32 v41, v16, v41, vcc
    v_cmp_le_u32 vcc, v17, v3
    s_nop 1
    v_cndmask_b32 v169, v16, v169, vcc
    v_add_u32 v17, 18, v1
    v_cmp_gt_u32 vcc, v17, v3
    s_nop 1
    v_cndmask_b32 v42, v16, v42, vcc
    v_cmp_le_u32 vcc, v17, v3
    s_nop 1
    v_cndmask_b32 v170, v16, v170, vcc
    v_add_u32 v17, 19, v1
    v_cmp_gt_u32 vcc, v17, v3
    s_nop 1
    v_cndmask_b32 v43, v16, v43, vcc
    v_cmp_le_u32 vcc, v17, v3
    s_nop 1
    v_cndmask_b32 v171, v16, v171, vcc
    v_add_u32 v17, 24, v1
    v_cmp_gt_u32 vcc, v17, v3
    s_nop 1
    v_cndmask_b32 v44, v16, v44, vcc
    v_cmp_le_u32 vcc, v17, v3
    s_nop 1
    v_cndmask_b32 v172, v16, v172, vcc
    v_add_u32 v17, 25, v1
    v_cmp_gt_u32 vcc, v17, v3
    s_nop 1
    v_cndmask_b32 v45, v16, v45, vcc
    v_cmp_le_u32 vcc, v17, v3
    s_nop 1
    v_cndmask_b32 v173, v16, v173, vcc
    v_add_u32 v17, 26, v1
    v_cmp_gt_u32 vcc, v17, v3
    s_nop 1
    v_cndmask_b32 v46, v16, v46, vcc
    v_cmp_le_u32 vcc, v17, v3
    s_nop 1
    v_cndmask_b32 v174, v16, v174, vcc
    v_add_u32 v17, 27, v1
    v_cmp_gt_u32 vcc, v17, v3
    s_nop 1
    v_cndmask_b32 v47, v16, v47, vcc
    v_cmp_le_u32 vcc, v17, v3
    s_nop 1
    v_cndmask_b32 v175, v16, v175, vcc
    v_max3_f32 v16, v32, v33, v34
    v_max3_f32 v16, v16, v35, v36
    v_max3_f32 v16, v16, v37, v38
    v_max3_f32 v16, v16, v39, v40
    v_max3_f32 v16, v16, v41, v42
    v_max3_f32 v16, v16, v43, v44
    v_max3_f32 v16, v16, v45, v46
    v_max3_f32 v16, v16, v47, v48
    v_max3_f32 v16, v16, v49, v50
    v_max3_f32 v16, v16, v51, v52
    v_max3_f32 v16, v16, v53, v54
    v_max3_f32 v16, v16, v55, v56
    v_max3_f32 v16, v16, v57, v58
    v_max3_f32 v16, v16, v59, v60
    v_max3_f32 v16, v16, v61, v62
    v_max3_f32 v16, v16, v63, v64
    v_max3_f32 v16, v16, v65, v66
    v_max3_f32 v16, v16, v67, v68
    v_max3_f32 v16, v16, v69, v70
    v_max3_f32 v16, v16, v71, v72
    v_max3_f32 v16, v16, v73, v74
    v_max3_f32 v16, v16, v75, v76
    v_max3_f32 v16, v16, v77, v78
    v_max3_f32 v16, v16, v79, v80
    v_max3_f32 v16, v16, v81, v82
    v_max3_f32 v16, v16, v83, v84
    v_max3_f32 v16, v16, v85, v86
    v_max3_f32 v16, v16, v87, v88
    v_max3_f32 v16, v16, v89, v90
    v_max3_f32 v16, v16, v91, v92
    v_max3_f32 v16, v16, v93, v94
    v_max3_f32 v16, v16, v95, v96
    v_max3_f32 v16, v16, v97, v98
    v_max3_f32 v16, v16, v99, v100
    v_max3_f32 v16, v16, v101, v102
    v_max3_f32 v16, v16, v103, v104
    v_max3_f32 v16, v16, v105, v106
    v_max3_f32 v16, v16, v107, v108
    v_max3_f32 v16, v16, v109, v110
    v_max3_f32 v16, v16, v111, v112
    v_max3_f32 v16, v16, v113, v114
    v_max3_f32 v16, v16, v115, v116
    v_max3_f32 v16, v16, v117, v118
    v_max3_f32 v16, v16, v119, v120
    v_max3_f32 v16, v16, v121, v122
    v_max3_f32 v16, v16, v123, v124
    v_max3_f32 v16, v16, v125, v126
    v_max3_f32 v16, v16, v127, v128
    v_max3_f32 v16, v16, v129, v130
    v_max3_f32 v16, v16, v131, v132
    v_max3_f32 v16, v16, v133, v134
    v_max3_f32 v16, v16, v135, v136
    v_max3_f32 v16, v16, v137, v138
    v_max3_f32 v16, v16, v139, v140
    v_max3_f32 v16, v16, v141, v142
    v_max3_f32 v16, v16, v143, v144
    v_max3_f32 v16, v16, v145, v146
    v_max3_f32 v16, v16, v147, v148
    v_max3_f32 v16, v16, v149, v150
    v_max3_f32 v16, v16, v151, v152
    v_max3_f32 v16, v16, v153, v154
    v_max3_f32 v16, v16, v155, v156
    v_max3_f32 v16, v16, v157, v158
    v_max3_f32 v16, v16, v159, v160
    v_max3_f32 v16, v16, v161, v162
    v_max3_f32 v16, v16, v163, v164
    v_max3_f32 v16, v16, v165, v166
    v_max3_f32 v16, v16, v167, v168
    v_max3_f32 v16, v16, v169, v170
    v_max3_f32 v16, v16, v171, v172
    v_max3_f32 v16, v16, v173, v174
    v_max_f32 v16, v16, v175
    v_lshlrev_b32 v1, 2, v2
    v_xor_b32 v1, 128, v1
    ds_bpermute_b32 v17, v1, v16
    s_waitcnt lgkmcnt(0)
    v_max_f32 v16, v16, v17
    s_mov_b32 s22, 0x3e829448
    v_mul_f32 v16, s22, v16
    v_sub_f32 v16, 0, v16
    v_mov_b32 v17, 0
    v_fma_f32 v32, v32, s22, v16
    v_exp_f32 v32, v32
    v_fma_f32 v33, v33, s22, v16
    v_exp_f32 v33, v33
    v_fma_f32 v34, v34, s22, v16
    v_exp_f32 v34, v34
    v_fma_f32 v35, v35, s22, v16
    v_exp_f32 v35, v35
    v_fma_f32 v36, v36, s22, v16
    v_exp_f32 v36, v36
    v_fma_f32 v37, v37, s22, v16
    v_exp_f32 v37, v37
    v_fma_f32 v38, v38, s22, v16
    v_exp_f32 v38, v38
    v_fma_f32 v39, v39, s22, v16
    v_exp_f32 v39, v39
    v_fma_f32 v40, v40, s22, v16
    v_exp_f32 v40, v40
    v_fma_f32 v41, v41, s22, v16
    v_exp_f32 v41, v41
    v_fma_f32 v42, v42, s22, v16
    v_exp_f32 v42, v42
    v_fma_f32 v43, v43, s22, v16
    v_exp_f32 v43, v43
    v_fma_f32 v44, v44, s22, v16
    v_exp_f32 v44, v44
    v_fma_f32 v45, v45, s22, v16
    v_exp_f32 v45, v45
    v_fma_f32 v46, v46, s22, v16
    v_exp_f32 v46, v46
    v_fma_f32 v47, v47, s22, v16
    v_exp_f32 v47, v47
    v_fma_f32 v48, v48, s22, v16
    v_exp_f32 v48, v48
    v_fma_f32 v49, v49, s22, v16
    v_exp_f32 v49, v49
    v_fma_f32 v50, v50, s22, v16
    v_exp_f32 v50, v50
    v_fma_f32 v51, v51, s22, v16
    v_exp_f32 v51, v51
    v_fma_f32 v52, v52, s22, v16
    v_exp_f32 v52, v52
    v_fma_f32 v53, v53, s22, v16
    v_exp_f32 v53, v53
    v_fma_f32 v54, v54, s22, v16
    v_exp_f32 v54, v54
    v_fma_f32 v55, v55, s22, v16
    v_exp_f32 v55, v55
    v_fma_f32 v56, v56, s22, v16
    v_exp_f32 v56, v56
    v_fma_f32 v57, v57, s22, v16
    v_exp_f32 v57, v57
    v_fma_f32 v58, v58, s22, v16
    v_exp_f32 v58, v58
    v_fma_f32 v59, v59, s22, v16
    v_exp_f32 v59, v59
    v_fma_f32 v60, v60, s22, v16
    v_exp_f32 v60, v60
    v_fma_f32 v61, v61, s22, v16
    v_exp_f32 v61, v61
    v_fma_f32 v62, v62, s22, v16
    v_exp_f32 v62, v62
    v_fma_f32 v63, v63, s22, v16
    v_exp_f32 v63, v63
    v_fma_f32 v64, v64, s22, v16
    v_exp_f32 v64, v64
    v_fma_f32 v65, v65, s22, v16
    v_exp_f32 v65, v65
    v_fma_f32 v66, v66, s22, v16
    v_exp_f32 v66, v66
    v_fma_f32 v67, v67, s22, v16
    v_exp_f32 v67, v67
    v_fma_f32 v68, v68, s22, v16
    v_exp_f32 v68, v68
    v_fma_f32 v69, v69, s22, v16
    v_exp_f32 v69, v69
    v_fma_f32 v70, v70, s22, v16
    v_exp_f32 v70, v70
    v_fma_f32 v71, v71, s22, v16
    v_exp_f32 v71, v71
    v_fma_f32 v72, v72, s22, v16
    v_exp_f32 v72, v72
    v_fma_f32 v73, v73, s22, v16
    v_exp_f32 v73, v73
    v_fma_f32 v74, v74, s22, v16
    v_exp_f32 v74, v74
    v_fma_f32 v75, v75, s22, v16
    v_exp_f32 v75, v75
    v_fma_f32 v76, v76, s22, v16
    v_exp_f32 v76, v76
    v_fma_f32 v77, v77, s22, v16
    v_exp_f32 v77, v77
    v_fma_f32 v78, v78, s22, v16
    v_exp_f32 v78, v78
    v_fma_f32 v79, v79, s22, v16
    v_exp_f32 v79, v79
    v_fma_f32 v80, v80, s22, v16
    v_exp_f32 v80, v80
    v_fma_f32 v81, v81, s22, v16
    v_exp_f32 v81, v81
    v_fma_f32 v82, v82, s22, v16
    v_exp_f32 v82, v82
    v_fma_f32 v83, v83, s22, v16
    v_exp_f32 v83, v83
    v_fma_f32 v84, v84, s22, v16
    v_exp_f32 v84, v84
    v_fma_f32 v85, v85, s22, v16
    v_exp_f32 v85, v85
    v_fma_f32 v86, v86, s22, v16
    v_exp_f32 v86, v86
    v_fma_f32 v87, v87, s22, v16
    v_exp_f32 v87, v87
    v_fma_f32 v88, v88, s22, v16
    v_exp_f32 v88, v88
    v_fma_f32 v89, v89, s22, v16
    v_exp_f32 v89, v89
    v_fma_f32 v90, v90, s22, v16
    v_exp_f32 v90, v90
    v_fma_f32 v91, v91, s22, v16
    v_exp_f32 v91, v91
    v_fma_f32 v92, v92, s22, v16
    v_exp_f32 v92, v92
    v_fma_f32 v93, v93, s22, v16
    v_exp_f32 v93, v93
    v_fma_f32 v94, v94, s22, v16
    v_exp_f32 v94, v94
    v_fma_f32 v95, v95, s22, v16
    v_exp_f32 v95, v95
    v_fma_f32 v96, v96, s22, v16
    v_exp_f32 v96, v96
    v_fma_f32 v97, v97, s22, v16
    v_exp_f32 v97, v97
    v_fma_f32 v98, v98, s22, v16
    v_exp_f32 v98, v98
    v_fma_f32 v99, v99, s22, v16
    v_exp_f32 v99, v99
    v_fma_f32 v100, v100, s22, v16
    v_exp_f32 v100, v100
    v_fma_f32 v101, v101, s22, v16
    v_exp_f32 v101, v101
    v_fma_f32 v102, v102, s22, v16
    v_exp_f32 v102, v102
    v_fma_f32 v103, v103, s22, v16
    v_exp_f32 v103, v103
    v_fma_f32 v104, v104, s22, v16
    v_exp_f32 v104, v104
    v_fma_f32 v105, v105, s22, v16
    v_exp_f32 v105, v105
    v_fma_f32 v106, v106, s22, v16
    v_exp_f32 v106, v106
    v_fma_f32 v107, v107, s22, v16
    v_exp_f32 v107, v107
    v_fma_f32 v108, v108, s22, v16
    v_exp_f32 v108, v108
    v_fma_f32 v109, v109, s22, v16
    v_exp_f32 v109, v109
    v_fma_f32 v110, v110, s22, v16
    v_exp_f32 v110, v110
    v_fma_f32 v111, v111, s22, v16
    v_exp_f32 v111, v111
    v_fma_f32 v112, v112, s22, v16
    v_exp_f32 v112, v112
    v_fma_f32 v113, v113, s22, v16
    v_exp_f32 v113, v113
    v_fma_f32 v114, v114, s22, v16
    v_exp_f32 v114, v114
    v_fma_f32 v115, v115, s22, v16
    v_exp_f32 v115, v115
    v_fma_f32 v116, v116, s22, v16
    v_exp_f32 v116, v116
    v_fma_f32 v117, v117, s22, v16
    v_exp_f32 v117, v117
    v_fma_f32 v118, v118, s22, v16
    v_exp_f32 v118, v118
    v_fma_f32 v119, v119, s22, v16
    v_exp_f32 v119, v119
    v_fma_f32 v120, v120, s22, v16
    v_exp_f32 v120, v120
    v_fma_f32 v121, v121, s22, v16
    v_exp_f32 v121, v121
    v_fma_f32 v122, v122, s22, v16
    v_exp_f32 v122, v122
    v_fma_f32 v123, v123, s22, v16
    v_exp_f32 v123, v123
    v_fma_f32 v124, v124, s22, v16
    v_exp_f32 v124, v124
    v_fma_f32 v125, v125, s22, v16
    v_exp_f32 v125, v125
    v_fma_f32 v126, v126, s22, v16
    v_exp_f32 v126, v126
    v_fma_f32 v127, v127, s22, v16
    v_exp_f32 v127, v127
    v_fma_f32 v128, v128, s22, v16
    v_exp_f32 v128, v128
    v_fma_f32 v129, v129, s22, v16
    v_exp_f32 v129, v129
    v_fma_f32 v130, v130, s22, v16
    v_exp_f32 v130, v130
    v_fma_f32 v131, v131, s22, v16
    v_exp_f32 v131, v131
    v_fma_f32 v132, v132, s22, v16
    v_exp_f32 v132, v132
    v_fma_f32 v133, v133, s22, v16
    v_exp_f32 v133, v133
    v_fma_f32 v134, v134, s22, v16
    v_exp_f32 v134, v134
    v_fma_f32 v135, v135, s22, v16
    v_exp_f32 v135, v135
    v_fma_f32 v136, v136, s22, v16
    v_exp_f32 v136, v136
    v_fma_f32 v137, v137, s22, v16
    v_exp_f32 v137, v137
    v_fma_f32 v138, v138, s22, v16
    v_exp_f32 v138, v138
    v_fma_f32 v139, v139, s22, v16
    v_exp_f32 v139, v139
    v_fma_f32 v140, v140, s22, v16
    v_exp_f32 v140, v140
    v_fma_f32 v141, v141, s22, v16
    v_exp_f32 v141, v141
    v_fma_f32 v142, v142, s22, v16
    v_exp_f32 v142, v142
    v_fma_f32 v143, v143, s22, v16
    v_exp_f32 v143, v143
    v_fma_f32 v144, v144, s22, v16
    v_exp_f32 v144, v144
    v_fma_f32 v145, v145, s22, v16
    v_exp_f32 v145, v145
    v_fma_f32 v146, v146, s22, v16
    v_exp_f32 v146, v146
    v_fma_f32 v147, v147, s22, v16
    v_exp_f32 v147, v147
    v_fma_f32 v148, v148, s22, v16
    v_exp_f32 v148, v148
    v_fma_f32 v149, v149, s22, v16
    v_exp_f32 v149, v149
    v_fma_f32 v150, v150, s22, v16
    v_exp_f32 v150, v150
    v_fma_f32 v151, v151, s22, v16
    v_exp_f32 v151, v151
    v_fma_f32 v152, v152, s22, v16
    v_exp_f32 v152, v152
    v_fma_f32 v153, v153, s22, v16
    v_exp_f32 v153, v153
    v_fma_f32 v154, v154, s22, v16
    v_exp_f32 v154, v154
    v_fma_f32 v155, v155, s22, v16
    v_exp_f32 v155, v155
    v_fma_f32 v156, v156, s22, v16
    v_exp_f32 v156, v156
    v_fma_f32 v157, v157, s22, v16
    v_exp_f32 v157, v157
    v_fma_f32 v158, v158, s22, v16
    v_exp_f32 v158, v158
    v_fma_f32 v159, v159, s22, v16
    v_exp_f32 v159, v159
    v_fma_f32 v160, v160, s22, v16
    v_exp_f32 v160, v160
    v_fma_f32 v161, v161, s22, v16
    v_exp_f32 v161, v161
    v_fma_f32 v162, v162, s22, v16
    v_exp_f32 v162, v162
    v_fma_f32 v163, v163, s22, v16
    v_exp_f32 v163, v163
    v_fma_f32 v164, v164, s22, v16
    v_exp_f32 v164, v164
    v_fma_f32 v165, v165, s22, v16
    v_exp_f32 v165, v165
    v_fma_f32 v166, v166, s22, v16
    v_exp_f32 v166, v166
    v_fma_f32 v167, v167, s22, v16
    v_exp_f32 v167, v167
    v_fma_f32 v168, v168, s22, v16
    v_exp_f32 v168, v168
    v_fma_f32 v169, v169, s22, v16
    v_exp_f32 v169, v169
    v_fma_f32 v170, v170, s22, v16
    v_exp_f32 v170, v170
    v_fma_f32 v171, v171, s22, v16
    v_exp_f32 v171, v171
    v_fma_f32 v172, v172, s22, v16
    v_exp_f32 v172, v172
    v_fma_f32 v173, v173, s22, v16
    v_exp_f32 v173, v173
    v_fma_f32 v174, v174, s22, v16
    v_exp_f32 v174, v174
    v_fma_f32 v175, v175, s22, v16
    v_exp_f32 v175, v175
    s_nop 0
    v_add_f32 v17, v17, v32
    v_add_f32 v17, v17, v33
    v_add_f32 v17, v17, v34
    v_add_f32 v17, v17, v35
    v_add_f32 v17, v17, v36
    v_add_f32 v17, v17, v37
    v_add_f32 v17, v17, v38
    v_add_f32 v17, v17, v39
    v_add_f32 v17, v17, v40
    v_add_f32 v17, v17, v41
    v_add_f32 v17, v17, v42
    v_add_f32 v17, v17, v43
    v_add_f32 v17, v17, v44
    v_add_f32 v17, v17, v45
    v_add_f32 v17, v17, v46
    v_add_f32 v17, v17, v47
    v_add_f32 v17, v17, v48
    v_add_f32 v17, v17, v49
    v_add_f32 v17, v17, v50
    v_add_f32 v17, v17, v51
    v_add_f32 v17, v17, v52
    v_add_f32 v17, v17, v53
    v_add_f32 v17, v17, v54
    v_add_f32 v17, v17, v55
    v_add_f32 v17, v17, v56
    v_add_f32 v17, v17, v57
    v_add_f32 v17, v17, v58
    v_add_f32 v17, v17, v59
    v_add_f32 v17, v17, v60
    v_add_f32 v17, v17, v61
    v_add_f32 v17, v17, v62
    v_add_f32 v17, v17, v63
    v_add_f32 v17, v17, v64
    v_add_f32 v17, v17, v65
    v_add_f32 v17, v17, v66
    v_add_f32 v17, v17, v67
    v_add_f32 v17, v17, v68
    v_add_f32 v17, v17, v69
    v_add_f32 v17, v17, v70
    v_add_f32 v17, v17, v71
    v_add_f32 v17, v17, v72
    v_add_f32 v17, v17, v73
    v_add_f32 v17, v17, v74
    v_add_f32 v17, v17, v75
    v_add_f32 v17, v17, v76
    v_add_f32 v17, v17, v77
    v_add_f32 v17, v17, v78
    v_add_f32 v17, v17, v79
    v_add_f32 v17, v17, v80
    v_add_f32 v17, v17, v81
    v_add_f32 v17, v17, v82
    v_add_f32 v17, v17, v83
    v_add_f32 v17, v17, v84
    v_add_f32 v17, v17, v85
    v_add_f32 v17, v17, v86
    v_add_f32 v17, v17, v87
    v_add_f32 v17, v17, v88
    v_add_f32 v17, v17, v89
    v_add_f32 v17, v17, v90
    v_add_f32 v17, v17, v91
    v_add_f32 v17, v17, v92
    v_add_f32 v17, v17, v93
    v_add_f32 v17, v17, v94
    v_add_f32 v17, v17, v95
    v_add_f32 v17, v17, v96
    v_add_f32 v17, v17, v97
    v_add_f32 v17, v17, v98
    v_add_f32 v17, v17, v99
    v_add_f32 v17, v17, v100
    v_add_f32 v17, v17, v101
    v_add_f32 v17, v17, v102
    v_add_f32 v17, v17, v103
    v_add_f32 v17, v17, v104
    v_add_f32 v17, v17, v105
    v_add_f32 v17, v17, v106
    v_add_f32 v17, v17, v107
    v_add_f32 v17, v17, v108
    v_add_f32 v17, v17, v109
    v_add_f32 v17, v17, v110
    v_add_f32 v17, v17, v111
    v_add_f32 v17, v17, v112
    v_add_f32 v17, v17, v113
    v_add_f32 v17, v17, v114
    v_add_f32 v17, v17, v115
    v_add_f32 v17, v17, v116
    v_add_f32 v17, v17, v117
    v_add_f32 v17, v17, v118
    v_add_f32 v17, v17, v119
    v_add_f32 v17, v17, v120
    v_add_f32 v17, v17, v121
    v_add_f32 v17, v17, v122
    v_add_f32 v17, v17, v123
    v_add_f32 v17, v17, v124
    v_add_f32 v17, v17, v125
    v_add_f32 v17, v17, v126
    v_add_f32 v17, v17, v127
    v_add_f32 v17, v17, v128
    v_add_f32 v17, v17, v129
    v_add_f32 v17, v17, v130
    v_add_f32 v17, v17, v131
    v_add_f32 v17, v17, v132
    v_add_f32 v17, v17, v133
    v_add_f32 v17, v17, v134
    v_add_f32 v17, v17, v135
    v_add_f32 v17, v17, v136
    v_add_f32 v17, v17, v137
    v_add_f32 v17, v17, v138
    v_add_f32 v17, v17, v139
    v_add_f32 v17, v17, v140
    v_add_f32 v17, v17, v141
    v_add_f32 v17, v17, v142
    v_add_f32 v17, v17, v143
    v_add_f32 v17, v17, v144
    v_add_f32 v17, v17, v145
    v_add_f32 v17, v17, v146
    v_add_f32 v17, v17, v147
    v_add_f32 v17, v17, v148
    v_add_f32 v17, v17, v149
    v_add_f32 v17, v17, v150
    v_add_f32 v17, v17, v151
    v_add_f32 v17, v17, v152
    v_add_f32 v17, v17, v153
    v_add_f32 v17, v17, v154
    v_add_f32 v17, v17, v155
    v_add_f32 v17, v17, v156
    v_add_f32 v17, v17, v157
    v_add_f32 v17, v17, v158
    v_add_f32 v17, v17, v159
    v_add_f32 v17, v17, v160
    v_add_f32 v17, v17, v161
    v_add_f32 v17, v17, v162
    v_add_f32 v17, v17, v163
    v_add_f32 v17, v17, v164
    v_add_f32 v17, v17, v165
    v_add_f32 v17, v17, v166
    v_add_f32 v17, v17, v167
    v_add_f32 v17, v17, v168
    v_add_f32 v17, v17, v169
    v_add_f32 v17, v17, v170
    v_add_f32 v17, v17, v171
    v_add_f32 v17, v17, v172
    v_add_f32 v17, v17, v173
    v_add_f32 v17, v17, v174
    v_add_f32 v17, v17, v175
    ds_bpermute_b32 v18, v1, v17
    v_cvt_pk_bf16_f32 v32, v32, v33
    v_cvt_pk_bf16_f32 v33, v34, v35
    v_cvt_pk_bf16_f32 v34, v36, v37
    v_cvt_pk_bf16_f32 v35, v38, v39
    v_cvt_pk_bf16_f32 v36, v40, v41
    v_cvt_pk_bf16_f32 v37, v42, v43
    v_cvt_pk_bf16_f32 v38, v44, v45
    v_cvt_pk_bf16_f32 v39, v46, v47
    v_cvt_pk_bf16_f32 v48, v48, v49
    v_cvt_pk_bf16_f32 v49, v50, v51
    v_cvt_pk_bf16_f32 v50, v52, v53
    v_cvt_pk_bf16_f32 v51, v54, v55
    v_cvt_pk_bf16_f32 v52, v56, v57
    v_cvt_pk_bf16_f32 v53, v58, v59
    v_cvt_pk_bf16_f32 v54, v60, v61
    v_cvt_pk_bf16_f32 v55, v62, v63
    v_cvt_pk_bf16_f32 v64, v64, v65
    v_cvt_pk_bf16_f32 v65, v66, v67
    v_cvt_pk_bf16_f32 v66, v68, v69
    v_cvt_pk_bf16_f32 v67, v70, v71
    v_cvt_pk_bf16_f32 v68, v72, v73
    v_cvt_pk_bf16_f32 v69, v74, v75
    v_cvt_pk_bf16_f32 v70, v76, v77
    v_cvt_pk_bf16_f32 v71, v78, v79
    v_cvt_pk_bf16_f32 v80, v80, v81
    v_cvt_pk_bf16_f32 v81, v82, v83
    v_cvt_pk_bf16_f32 v82, v84, v85
    v_cvt_pk_bf16_f32 v83, v86, v87
    v_cvt_pk_bf16_f32 v84, v88, v89
    v_cvt_pk_bf16_f32 v85, v90, v91
    v_cvt_pk_bf16_f32 v86, v92, v93
    v_cvt_pk_bf16_f32 v87, v94, v95
    v_cvt_pk_bf16_f32 v96, v96, v97
    v_cvt_pk_bf16_f32 v97, v98, v99
    v_cvt_pk_bf16_f32 v98, v100, v101
    v_cvt_pk_bf16_f32 v99, v102, v103
    v_cvt_pk_bf16_f32 v100, v104, v105
    v_cvt_pk_bf16_f32 v101, v106, v107
    v_cvt_pk_bf16_f32 v102, v108, v109
    v_cvt_pk_bf16_f32 v103, v110, v111
    v_cvt_pk_bf16_f32 v112, v112, v113
    v_cvt_pk_bf16_f32 v113, v114, v115
    v_cvt_pk_bf16_f32 v114, v116, v117
    v_cvt_pk_bf16_f32 v115, v118, v119
    v_cvt_pk_bf16_f32 v116, v120, v121
    v_cvt_pk_bf16_f32 v117, v122, v123
    v_cvt_pk_bf16_f32 v118, v124, v125
    v_cvt_pk_bf16_f32 v119, v126, v127
    v_cvt_pk_bf16_f32 v128, v128, v129
    v_cvt_pk_bf16_f32 v129, v130, v131
    v_cvt_pk_bf16_f32 v130, v132, v133
    v_cvt_pk_bf16_f32 v131, v134, v135
    v_cvt_pk_bf16_f32 v132, v136, v137
    v_cvt_pk_bf16_f32 v133, v138, v139
    v_cvt_pk_bf16_f32 v134, v140, v141
    v_cvt_pk_bf16_f32 v135, v142, v143
    v_cvt_pk_bf16_f32 v144, v144, v145
    v_cvt_pk_bf16_f32 v145, v146, v147
    v_cvt_pk_bf16_f32 v146, v148, v149
    v_cvt_pk_bf16_f32 v147, v150, v151
    v_cvt_pk_bf16_f32 v148, v152, v153
    v_cvt_pk_bf16_f32 v149, v154, v155
    v_cvt_pk_bf16_f32 v150, v156, v157
    v_cvt_pk_bf16_f32 v151, v158, v159
    v_cvt_pk_bf16_f32 v160, v160, v161
    v_cvt_pk_bf16_f32 v161, v162, v163
    v_cvt_pk_bf16_f32 v162, v164, v165
    v_cvt_pk_bf16_f32 v163, v166, v167
    v_cvt_pk_bf16_f32 v164, v168, v169
    v_cvt_pk_bf16_f32 v165, v170, v171
    v_cvt_pk_bf16_f32 v166, v172, v173
    v_cvt_pk_bf16_f32 v167, v174, v175
    s_waitcnt lgkmcnt(0)
    v_add_f32 v17, v17, v18
    v_rcp_f32 v17, v17
    s_add_u32 s20, s11, 0
    s_cmp_lt_u32 s20, 8
    s_cbranch_scc1 L_attb1_vskip0
    s_add_u32 s21, s14, -16384
    v_add_u32 v1, s21, v5
    global_load_dwordx4 v[176:179], v1, s[16:17] offset:0
    global_load_dwordx4 v[180:183], v1, s[16:17] offset:32
L_attb1_vskip0:
    s_add_u32 s20, s11, 1
    s_cmp_lt_u32 s20, 8
    s_cbranch_scc1 L_attb1_vskip1
    s_add_u32 s21, s14, -14336
    v_add_u32 v1, s21, v5
    global_load_dwordx4 v[184:187], v1, s[16:17] offset:0
    global_load_dwordx4 v[188:191], v1, s[16:17] offset:32
L_attb1_vskip1:
    s_add_u32 s20, s11, 2
    s_cmp_lt_u32 s20, 8
    s_cbranch_scc1 L_attb1_vskip2
    s_add_u32 s21, s14, -12288
    v_add_u32 v1, s21, v5
    global_load_dwordx4 v[192:195], v1, s[16:17] offset:0
    global_load_dwordx4 v[196:199], v1, s[16:17] offset:32
L_attb1_vskip2:
    s_add_u32 s20, s11, 3
    s_cmp_lt_u32 s20, 8
    s_cbranch_scc1 L_attb1_vskip3
    s_add_u32 s21, s14, -10240
    v_add_u32 v1, s21, v5
    global_load_dwordx4 v[200:203], v1, s[16:17] offset:0
    global_load_dwordx4 v[204:207], v1, s[16:17] offset:32
L_attb1_vskip3:
    s_add_u32 s20, s11, 4
    s_cmp_lt_u32 s20, 8
    s_cbranch_scc1 L_attb1_vskip4
    s_add_u32 s21, s14, -8192
    v_add_u32 v1, s21, v5
    global_load_dwordx4 v[208:211], v1, s[16:17] offset:0
    global_load_dwordx4 v[212:215], v1, s[16:17] offset:32
L_attb1_vskip4:
    s_add_u32 s20, s11, 5
    s_cmp_lt_u32 s20, 8
    s_cbranch_scc1 L_attb1_vskip5
    s_add_u32 s21, s14, -6144
    v_add_u32 v1, s21, v5
    global_load_dwordx4 v[216:219], v1, s[16:17] offset:0
    global_load_dwordx4 v[220:223], v1, s[16:17] offset:32
L_attb1_vskip5:
    s_add_u32 s20, s11, 6
    s_cmp_lt_u32 s20, 8
    s_cbranch_scc1 L_attb1_vskip6
    s_add_u32 s21, s14, -4096
    v_add_u32 v1, s21, v5
    global_load_dwordx4 v[224:227], v1, s[16:17] offset:0
    global_load_dwordx4 v[228:231], v1, s[16:17] offset:32
L_attb1_vskip6:
    s_add_u32 s20, s11, 7
    s_cmp_lt_u32 s20, 8
    s_cbranch_scc1 L_attb1_vskip7
    s_add_u32 s21, s14, -2048
    v_add_u32 v1, s21, v5
    global_load_dwordx4 v[232:235], v1, s[16:17] offset:0
    global_load_dwordx4 v[236:239], v1, s[16:17] offset:32
L_attb1_vskip7:
    s_add_u32 s20, s11, 8
    s_cmp_lt_u32 s20, 8
    s_cbranch_scc1 L_attb1_vskip8
    s_add_u32 s21, s14, 0
    v_add_u32 v1, s21, v5
    global_load_dwordx4 v[240:243], v1, s[16:17] offset:0
    global_load_dwordx4 v[244:247], v1, s[16:17] offset:32
L_attb1_vskip8:
    v_mov_b32 v6, v17
    v_mov_b32 v16, 0
    v_mov_b32 v17, 0
    v_mov_b32 v18, 0
    v_mov_b32 v19, 0
    v_mov_b32 v20, 0
    v_mov_b32 v21, 0
    v_mov_b32 v22, 0
    v_mov_b32 v23, 0
    v_mov_b32 v24, 0
    v_mov_b32 v25, 0
    v_mov_b32 v26, 0
    v_mov_b32 v27, 0
    v_mov_b32 v28, 0
    v_mov_b32 v29, 0
    v_mov_b32 v30, 0
    v_mov_b32 v31, 0
    s_waitcnt vmcnt(0)
    s_add_u32 s20, s11, 0
    s_cmp_lt_u32 s20, 8
    s_cbranch_scc1 L_attb1_pskip0
    v_mfma_f32_32x32x16_bf16 v[16:31], v[176:179], v[32:35], v[16:31]
    v_mfma_f32_32x32x16_bf16 v[16:31], v[180:183], v[36:39], v[16:31]
L_attb1_pskip0:
    s_add_u32 s20, s11, 1
    s_cmp_lt_u32 s20, 8
    s_cbranch_scc1 L_attb1_pskip1
    v_mfma_f32_32x32x16_bf16 v[16:31], v[184:187], v[48:51], v[16:31]
    v_mfma_f32_32x32x16_bf16 v[16:31], v[188:191], v[52:55], v[16:31]
L_attb1_pskip1:
    s_add_u32 s20, s11, 2
    s_cmp_lt_u32 s20, 8
    s_cbranch_scc1 L_attb1_pskip2
    v_mfma_f32_32x32x16_bf16 v[16:31], v[192:195], v[64:67], v[16:31]
    v_mfma_f32_32x32x16_bf16 v[16:31], v[196:199], v[68:71], v[16:31]
L_attb1_pskip2:
    s_add_u32 s20, s11, 3
    s_cmp_lt_u32 s20, 8
    s_cbranch_scc1 L_attb1_pskip3
    v_mfma_f32_32x32x16_bf16 v[16:31], v[200:203], v[80:83], v[16:31]
    v_mfma_f32_32x32x16_bf16 v[16:31], v[204:207], v[84:87], v[16:31]
L_attb1_pskip3:
    s_add_u32 s20, s11, 4
    s_cmp_lt_u32 s20, 8
    s_cbranch_scc1 L_attb1_pskip4
    v_mfma_f32_32x32x16_bf16 v[16:31], v[208:211], v[96:99], v[16:31]
    v_mfma_f32_32x32x16_bf16 v[16:31], v[212:215], v[100:103], v[16:31]
L_attb1_pskip4:
    s_add_u32 s20, s11, 5
    s_cmp_lt_u32 s20, 8
    s_cbranch_scc1 L_attb1_pskip5
    v_mfma_f32_32x32x16_bf16 v[16:31], v[216:219], v[112:115], v[16:31]
    v_mfma_f32_32x32x16_bf16 v[16:31], v[220:223], v[116:119], v[16:31]
L_attb1_pskip5:
    s_add_u32 s20, s11, 6
    s_cmp_lt_u32 s20, 8
    s_cbranch_scc1 L_attb1_pskip6
    v_mfma_f32_32x32x16_bf16 v[16:31], v[224:227], v[128:131], v[16:31]
    v_mfma_f32_32x32x16_bf16 v[16:31], v[228:231], v[132:135], v[16:31]
L_attb1_pskip6:
    s_add_u32 s20, s11, 7
    s_cmp_lt_u32 s20, 8
    s_cbranch_scc1 L_attb1_pskip7
    v_mfma_f32_32x32x16_bf16 v[16:31], v[232:235], v[144:147], v[16:31]
    v_mfma_f32_32x32x16_bf16 v[16:31], v[236:239], v[148:151], v[16:31]
L_attb1_pskip7:
    s_add_u32 s20, s11, 8
    s_cmp_lt_u32 s20, 8
    s_cbranch_scc1 L_attb1_pskip8
    v_mfma_f32_32x32x16_bf16 v[16:31], v[240:243], v[160:163], v[16:31]
    v_mfma_f32_32x32x16_bf16 v[16:31], v[244:247], v[164:167], v[16:31]
L_attb1_pskip8:
    s_nop 15
    s_nop 3
    v_mul_f32 v16, v16, v6
    v_mul_f32 v17, v17, v6
    v_mul_f32 v18, v18, v6
    v_mul_f32 v19, v19, v6
    v_mul_f32 v20, v20, v6
    v_mul_f32 v21, v21, v6
    v_mul_f32 v22, v22, v6
    v_mul_f32 v23, v23, v6
    v_mul_f32 v24, v24, v6
    v_mul_f32 v25, v25, v6
    v_mul_f32 v26, v26, v6
    v_mul_f32 v27, v27, v6
    v_mul_f32 v28, v28, v6
    v_mul_f32 v29, v29, v6
    v_mul_f32 v30, v30, v6
    v_mul_f32 v31, v31, v6
    v_cvt_pk_bf16_f32 v32, v16, v17
    v_cvt_pk_bf16_f32 v33, v18, v19
    v_cvt_pk_bf16_f32 v34, v20, v21
    v_cvt_pk_bf16_f32 v35, v22, v23
    v_cvt_pk_bf16_f32 v36, v24, v25
    v_cvt_pk_bf16_f32 v37, v26, v27
    v_cvt_pk_bf16_f32 v38, v28, v29
    v_cvt_pk_bf16_f32 v39, v30, v31
    v_add_u32 v1, s12, v3
    v_lshlrev_b32 v1, 11, v1
    s_lshl_b32 s21, s8, 6
    v_add_u32 v1, s21, v1
    v_lshl_add_u32 v1, v4, 3, v1
    global_store_dwordx2 v1, v[32:33], s[18:19] offset:0
    global_store_dwordx2 v1, v[34:35], s[18:19] offset:16
    global_store_dwordx2 v1, v[36:37], s[18:19] offset:32
    global_store_dwordx2 v1, v[38:39], s[18:19] offset:48
L_attb1_end:
    s_endpgm
.globl wo1_kernel
.p2align 8
.type wo1_kernel,@function
wo1_kernel:
    s_cmp_ge_u32 s2, 256
    s_cbranch_scc1 L_wo1_end
    s_load_dwordx2 s[4:5], s[0:1], 64
    s_load_dwordx2 s[6:7], s[0:1], 40
    s_load_dwordx2 s[14:15], s[0:1], 64
    s_waitcnt lgkmcnt(0)
    s_add_u32 s4, s4, 20971520
    s_addc_u32 s5, s5, 0
    s_add_u32 s14, s14, 4194304
    s_addc_u32 s15, s15, 0
    s_lshr_b32 s8, s2, 4
    s_and_b32 s9, s2, 15
    v_lshrrev_b32 v1, 3, v0
    v_and_b32 v2, 7, v0
    s_lshl_b32 s10, s8, 7
    v_add_u32 v3, s10, v1
    v_lshlrev_b32 v3, 11, v3
    v_lshl_add_u32 v3, v2, 4, v3
    v_add_u32 v4, 0, v3
    v_add_u32 v5, 65536, v3
    v_add_u32 v6, 131072, v3
    v_add_u32 v7, 196608, v3
    s_mov_b32 s11, 2048
    v_mul_lo_u32 v3, v1, s11
    v_lshl_add_u32 v3, v2, 4, v3
    s_lshl_b32 s12, s9, 7
    v_add_u32 v3, s12, v3
    v_add_u32 v8, 0, v3
    v_add_u32 v9, 65536, v3
    v_mul_u32_u24 v14, 144, v1
    v_lshl_add_u32 v14, v2, 4, v14
    v_mul_u32_u24 v15, 192, v1
    v_lshl_add_u32 v15, v2, 4, v15
    v_add_u32 v15, 18432, v15
    v_and_b32 v16, 63, v0
    v_lshrrev_b32 v17, 6, v0
    v_lshrrev_b32 v18, 1, v17
    v_and_b32 v19, 1, v17
    v_and_b32 v20, 31, v16
    v_lshrrev_b32 v21, 5, v16
    v_lshl_add_u32 v22, v18, 6, v20
    v_mul_u32_u24 v22, 144, v22
    v_lshl_add_u32 v22, v21, 4, v22
    v_bfe_u32 v23, v16, 2, 2
    v_lshl_add_u32 v23, v21, 3, v23
    v_mul_u32_u24 v23, 192, v23
    v_bfe_u32 v24, v16, 4, 1
    v_lshlrev_b32 v24, 5, v24
    v_lshl_add_u32 v24, v19, 6, v24
    v_and_b32 v25, 3, v16
    v_lshl_add_u32 v24, v25, 3, v24
    v_add_u32 v23, v23, v24
    v_add_u32 v23, 18432, v23
    v_add_u32 v24, 30720, v22
    v_add_u32 v25, 30720, v23
    v_mov_b32 v160, 0
    v_mov_b32 v161, 0
    v_mov_b32 v162, 0
    v_mov_b32 v163, 0
    v_mov_b32 v164, 0
    v_mov_b32 v165, 0
    v_mov_b32 v166, 0
    v_mov_b32 v167, 0
    v_mov_b32 v168, 0
    v_mov_b32 v169, 0
    v_mov_b32 v170, 0
    v_mov_b32 v171, 0
    v_mov_b32 v172, 0
    v_mov_b32 v173, 0
    v_mov_b32 v174, 0
    v_mov_b32 v175, 0
    v_mov_b32 v176, 0
    v_mov_b32 v177, 0
    v_mov_b32 v178, 0
    v_mov_b32 v179, 0
    v_mov_b32 v180, 0
    v_mov_b32 v181, 0
    v_mov_b32 v182, 0
    v_mov_b32 v183, 0
    v_mov_b32 v184, 0
    v_mov_b32 v185, 0
    v_mov_b32 v186, 0
    v_mov_b32 v187, 0
    v_mov_b32 v188, 0
    v_mov_b32 v189, 0
    v_mov_b32 v190, 0
    v_mov_b32 v191, 0
    global_load_dwordx4 v[40:43], v4, s[4:5]
    global_load_dwordx4 v[44:47], v5, s[4:5]
    global_load_dwordx4 v[48:51], v6, s[4:5]
    global_load_dwordx4 v[52:55], v7, s[4:5]
    global_load_dwordx4 v[56:59], v8, s[6:7]
    global_load_dwordx4 v[60:63], v9, s[6:7]
    s_add_u32 s4, s4, 128
    s_addc_u32 s5, s5, 0
    s_add_u32 s6, s6, 131072
    s_addc_u32 s7, s7, 0
    global_load_dwordx4 v[64:67], v4, s[4:5]
    global_load_dwordx4 v[68:71], v5, s[4:5]
    global_load_dwordx4 v[72:75], v6, s[4:5]
    global_load_dwordx4 v[76:79], v7, s[4:5]
    global_load_dwordx4 v[80:83], v8, s[6:7]
    global_load_dwordx4 v[84:87], v9, s[6:7]
    s_add_u32 s4, s4, 128
    s_addc_u32 s5, s5, 0
    s_add_u32 s6, s6, 131072
    s_addc_u32 s7, s7, 0
    global_load_dwordx4 v[88:91], v4, s[4:5]
    global_load_dwordx4 v[92:95], v5, s[4:5]
    global_load_dwordx4 v[96:99], v6, s[4:5]
    global_load_dwordx4 v[100:103], v7, s[4:5]
    global_load_dwordx4 v[104:107], v8, s[6:7]
    global_load_dwordx4 v[108:111], v9, s[6:7]
    s_add_u32 s4, s4, 128
    s_addc_u32 s5, s5, 0
    s_add_u32 s6, s6, 131072
    s_addc_u32 s7, s7, 0
    global_load_dwordx4 v[112:115], v4, s[4:5]
    global_load_dwordx4 v[116:119], v5, s[4:5]
    global_load_dwordx4 v[120:123], v6, s[4:5]
    global_load_dwordx4 v[124:127], v7, s[4:5]
    global_load_dwordx4 v[128:131], v8, s[6:7]
    global_load_dwordx4 v[132:135], v9, s[6:7]
    s_add_u32 s4, s4, 128
    s_addc_u32 s5, s5, 0
    s_add_u32 s6, s6, 131072
    s_addc_u32 s7, s7, 0
    s_waitcnt vmcnt(18)
    ds_write_b128 v14, v[40:43] offset:0
    ds_write_b128 v14, v[44:47] offset:4608
    ds_write_b128 v14, v[48:51] offset:9216
    ds_write_b128 v14, v[52:55] offset:13824
    ds_write_b128 v15, v[56:59] offset:0
    ds_write_b128 v15, v[60:63] offset:6144
    s_waitcnt lgkmcnt(0)
    s_barrier
    ds_read_b128 v[208:211], v22 offset:0
    ds_read_b128 v[212:215], v22 offset:4608
    ds_read_b64_tr_b16 v[192:193], v23 offset:0
    ds_read_b64_tr_b16 v[194:195], v23 offset:768
    ds_read_b128 v[216:219], v22 offset:32
    ds_read_b128 v[220:223], v22 offset:4640
    ds_read_b64_tr_b16 v[196:197], v23 offset:3072
    ds_read_b64_tr_b16 v[198:199], v23 offset:3840
    ds_read_b128 v[224:227], v22 offset:64
    ds_read_b128 v[228:231], v22 offset:4672
    ds_read_b64_tr_b16 v[200:201], v23 offset:6144
    ds_read_b64_tr_b16 v[202:203], v23 offset:6912
    ds_read_b128 v[232:235], v22 offset:96
    ds_read_b128 v[236:239], v22 offset:4704
    ds_read_b64_tr_b16 v[204:205], v23 offset:9216
    ds_read_b64_tr_b16 v[206:207], v23 offset:9984
    s_mov_b32 s20, 0
L_wo1_loop:
    s_waitcnt lgkmcnt(12)
    v_mfma_f32_32x32x16_bf16 v[160:175], v[192:195], v[208:211], v[160:175]
    global_load_dwordx4 v[40:43], v4, s[4:5]
    global_load_dwordx4 v[44:47], v5, s[4:5]
    global_load_dwordx4 v[48:51], v6, s[4:5]
    v_mfma_f32_32x32x16_bf16 v[176:191], v[192:195], v[212:215], v[176:191]
    global_load_dwordx4 v[52:55], v7, s[4:5]
    global_load_dwordx4 v[56:59], v8, s[6:7]
    s_waitcnt lgkmcnt(8)
    v_mfma_f32_32x32x16_bf16 v[160:175], v[196:199], v[216:219], v[160:175]
    global_load_dwordx4 v[60:63], v9, s[6:7]
    s_add_u32 s4, s4, 128
    v_mfma_f32_32x32x16_bf16 v[176:191], v[196:199], v[220:223], v[176:191]
    s_addc_u32 s5, s5, 0
    s_add_u32 s6, s6, 131072
    s_waitcnt lgkmcnt(4)
    v_mfma_f32_32x32x16_bf16 v[160:175], v[200:203], v[224:227], v[160:175]
    s_addc_u32 s7, s7, 0
    s_waitcnt vmcnt(18)
    v_mfma_f32_32x32x16_bf16 v[176:191], v[200:203], v[228:231], v[176:191]
    ds_write_b128 v14, v[64:67] offset:30720
    ds_write_b128 v14, v[68:71] offset:35328
    s_waitcnt lgkmcnt(2)
    v_mfma_f32_32x32x16_bf16 v[160:175], v[204:207], v[232:235], v[160:175]
    ds_write_b128 v14, v[72:75] offset:39936
    ds_write_b128 v14, v[76:79] offset:44544
    v_mfma_f32_32x32x16_bf16 v[176:191], v[204:207], v[236:239], v[176:191]
    ds_write_b128 v15, v[80:83] offset:30720
    ds_write_b128 v15, v[84:87] offset:36864
    s_waitcnt lgkmcnt(0)
    s_barrier
    ds_read_b128 v[208:211], v24 offset:0
    ds_read_b128 v[212:215], v24 offset:4608
    ds_read_b64_tr_b16 v[192:193], v25 offset:0
    ds_read_b64_tr_b16 v[194:195], v25 offset:768
    ds_read_b128 v[216:219], v24 offset:32
    ds_read_b128 v[220:223], v24 offset:4640
    ds_read_b64_tr_b16 v[196:197], v25 offset:3072
    ds_read_b64_tr_b16 v[198:199], v25 offset:3840
    ds_read_b128 v[224:227], v24 offset:64
    ds_read_b128 v[228:231], v24 offset:4672
    ds_read_b64_tr_b16 v[200:201], v25 offset:6144
    ds_read_b64_tr_b16 v[202:203], v25 offset:6912
    ds_read_b128 v[232:235], v24 offset:96
    ds_read_b128 v[236:239], v24 offset:4704
    ds_read_b64_tr_b16 v[204:205], v25 offset:9216
    ds_read_b64_tr_b16 v[206:207], v25 offset:9984
    s_waitcnt lgkmcnt(12)
    v_mfma_f32_32x32x16_bf16 v[160:175], v[192:195], v[208:211], v[160:175]
    global_load_dwordx4 v[64:67], v4, s[4:5]
    global_load_dwordx4 v[68:71], v5, s[4:5]
    global_load_dwordx4 v[72:75], v6, s[4:5]
    v_mfma_f32_32x32x16_bf16 v[176:191], v[192:195], v[212:215], v[176:191]
    global_load_dwordx4 v[76:79], v7, s[4:5]
    global_load_dwordx4 v[80:83], v8, s[6:7]
    s_waitcnt lgkmcnt(8)
    v_mfma_f32_32x32x16_bf16 v[160:175], v[196:199], v[216:219], v[160:175]
    global_load_dwordx4 v[84:87], v9, s[6:7]
    s_add_u32 s4, s4, 128
    v_mfma_f32_32x32x16_bf16 v[176:191], v[196:199], v[220:223], v[176:191]
    s_addc_u32 s5, s5, 0
    s_add_u32 s6, s6, 131072
    s_waitcnt lgkmcnt(4)
    v_mfma_f32_32x32x16_bf16 v[160:175], v[200:203], v[224:227], v[160:175]
    s_addc_u32 s7, s7, 0
    s_waitcnt vmcnt(18)
    v_mfma_f32_32x32x16_bf16 v[176:191], v[200:203], v[228:231], v[176:191]
    ds_write_b128 v14, v[88:91] offset:0
    ds_write_b128 v14, v[92:95] offset:4608
    s_waitcnt lgkmcnt(2)
    v_mfma_f32_32x32x16_bf16 v[160:175], v[204:207], v[232:235], v[160:175]
    ds_write_b128 v14, v[96:99] offset:9216
    ds_write_b128 v14, v[100:103] offset:13824
    v_mfma_f32_32x32x16_bf16 v[176:191], v[204:207], v[236:239], v[176:191]
    ds_write_b128 v15, v[104:107] offset:0
    ds_write_b128 v15, v[108:111] offset:6144
    s_waitcnt lgkmcnt(0)
    s_barrier
    ds_read_b128 v[208:211], v22 offset:0
    ds_read_b128 v[212:215], v22 offset:4608
    ds_read_b64_tr_b16 v[192:193], v23 offset:0
    ds_read_b64_tr_b16 v[194:195], v23 offset:768
    ds_read_b128 v[216:219], v22 offset:32
    ds_read_b128 v[220:223], v22 offset:4640
    ds_read_b64_tr_b16 v[196:197], v23 offset:3072
    ds_read_b64_tr_b16 v[198:199], v23 offset:3840
    ds_read_b128 v[224:227], v22 offset:64
    ds_read_b128 v[228:231], v22 offset:4672
    ds_read_b64_tr_b16 v[200:201], v23 offset:6144
    ds_read_b64_tr_b16 v[202:203], v23 offset:6912
    ds_read_b128 v[232:235], v22 offset:96
    ds_read_b128 v[236:239], v22 offset:4704
    ds_read_b64_tr_b16 v[204:205], v23 offset:9216
    ds_read_b64_tr_b16 v[206:207], v23 offset:9984
    s_waitcnt lgkmcnt(12)
    v_mfma_f32_32x32x16_bf16 v[160:175], v[192:195], v[208:211], v[160:175]
    global_load_dwordx4 v[88:91], v4, s[4:5]
    global_load_dwordx4 v[92:95], v5, s[4:5]
    global_load_dwordx4 v[96:99], v6, s[4:5]
    v_mfma_f32_32x32x16_bf16 v[176:191], v[192:195], v[212:215], v[176:191]
    global_load_dwordx4 v[100:103], v7, s[4:5]
    global_load_dwordx4 v[104:107], v8, s[6:7]
    s_waitcnt lgkmcnt(8)
    v_mfma_f32_32x32x16_bf16 v[160:175], v[196:199], v[216:219], v[160:175]
    global_load_dwordx4 v[108:111], v9, s[6:7]
    s_add_u32 s4, s4, 128
    v_mfma_f32_32x32x16_bf16 v[176:191], v[196:199], v[220:223], v[176:191]
    s_addc_u32 s5, s5, 0
    s_add_u32 s6, s6, 131072
    s_waitcnt lgkmcnt(4)
    v_mfma_f32_32x32x16_bf16 v[160:175], v[200:203], v[224:227], v[160:175]
    s_addc_u32 s7, s7, 0
    s_waitcnt vmcnt(18)
    v_mfma_f32_32x32x16_bf16 v[176:191], v[200:203], v[228:231], v[176:191]
    ds_write_b128 v14, v[112:115] offset:30720
    ds_write_b128 v14, v[116:119] offset:35328
    s_waitcnt lgkmcnt(2)
    v_mfma_f32_32x32x16_bf16 v[160:175], v[204:207], v[232:235], v[160:175]
    ds_write_b128 v14, v[120:123] offset:39936
    ds_write_b128 v14, v[124:127] offset:44544
    v_mfma_f32_32x32x16_bf16 v[176:191], v[204:207], v[236:239], v[176:191]
    ds_write_b128 v15, v[128:131] offset:30720
    ds_write_b128 v15, v[132:135] offset:36864
    s_waitcnt lgkmcnt(0)
    s_barrier
    ds_read_b128 v[208:211], v24 offset:0
    ds_read_b128 v[212:215], v24 offset:4608
    ds_read_b64_tr_b16 v[192:193], v25 offset:0
    ds_read_b64_tr_b16 v[194:195], v25 offset:768
    ds_read_b128 v[216:219], v24 offset:32
    ds_read_b128 v[220:223], v24 offset:4640
    ds_read_b64_tr_b16 v[196:197], v25 offset:3072
    ds_read_b64_tr_b16 v[198:199], v25 offset:3840
    ds_read_b128 v[224:227], v24 offset:64
    ds_read_b128 v[228:231], v24 offset:4672
    ds_read_b64_tr_b16 v[200:201], v25 offset:6144
    ds_read_b64_tr_b16 v[202:203], v25 offset:6912
    ds_read_b128 v[232:235], v24 offset:96
    ds_read_b128 v[236:239], v24 offset:4704
    ds_read_b64_tr_b16 v[204:205], v25 offset:9216
    ds_read_b64_tr_b16 v[206:207], v25 offset:9984
    s_waitcnt lgkmcnt(12)
    v_mfma_f32_32x32x16_bf16 v[160:175], v[192:195], v[208:211], v[160:175]
    global_load_dwordx4 v[112:115], v4, s[4:5]
    global_load_dwordx4 v[116:119], v5, s[4:5]
    global_load_dwordx4 v[120:123], v6, s[4:5]
    v_mfma_f32_32x32x16_bf16 v[176:191], v[192:195], v[212:215], v[176:191]
    global_load_dwordx4 v[124:127], v7, s[4:5]
    global_load_dwordx4 v[128:131], v8, s[6:7]
    s_waitcnt lgkmcnt(8)
    v_mfma_f32_32x32x16_bf16 v[160:175], v[196:199], v[216:219], v[160:175]
    global_load_dwordx4 v[132:135], v9, s[6:7]
    s_add_u32 s4, s4, 128
    v_mfma_f32_32x32x16_bf16 v[176:191], v[196:199], v[220:223], v[176:191]
    s_addc_u32 s5, s5, 0
    s_add_u32 s6, s6, 131072
    s_waitcnt lgkmcnt(4)
    v_mfma_f32_32x32x16_bf16 v[160:175], v[200:203], v[224:227], v[160:175]
    s_addc_u32 s7, s7, 0
    s_waitcnt vmcnt(18)
    v_mfma_f32_32x32x16_bf16 v[176:191], v[200:203], v[228:231], v[176:191]
    ds_write_b128 v14, v[40:43] offset:0
    ds_write_b128 v14, v[44:47] offset:4608
    s_waitcnt lgkmcnt(2)
    v_mfma_f32_32x32x16_bf16 v[160:175], v[204:207], v[232:235], v[160:175]
    ds_write_b128 v14, v[48:51] offset:9216
    ds_write_b128 v14, v[52:55] offset:13824
    v_mfma_f32_32x32x16_bf16 v[176:191], v[204:207], v[236:239], v[176:191]
    ds_write_b128 v15, v[56:59] offset:0
    ds_write_b128 v15, v[60:63] offset:6144
    s_waitcnt lgkmcnt(0)
    s_barrier
    ds_read_b128 v[208:211], v22 offset:0
    ds_read_b128 v[212:215], v22 offset:4608
    ds_read_b64_tr_b16 v[192:193], v23 offset:0
    ds_read_b64_tr_b16 v[194:195], v23 offset:768
    ds_read_b128 v[216:219], v22 offset:32
    ds_read_b128 v[220:223], v22 offset:4640
    ds_read_b64_tr_b16 v[196:197], v23 offset:3072
    ds_read_b64_tr_b16 v[198:199], v23 offset:3840
    ds_read_b128 v[224:227], v22 offset:64
    ds_read_b128 v[228:231], v22 offset:4672
    ds_read_b64_tr_b16 v[200:201], v23 offset:6144
    ds_read_b64_tr_b16 v[202:203], v23 offset:6912
    ds_read_b128 v[232:235], v22 offset:96
    ds_read_b128 v[236:239], v22 offset:4704
    ds_read_b64_tr_b16 v[204:205], v23 offset:9216
    ds_read_b64_tr_b16 v[206:207], v23 offset:9984
    s_add_u32 s20, s20, 4
    s_cmp_lt_u32 s20, 12
    s_cbranch_scc1 L_wo1_loop
    s_waitcnt lgkmcnt(12)
    v_mfma_f32_32x32x16_bf16 v[160:175], v[192:195], v[208:211], v[160:175]
    s_waitcnt vmcnt(12)
    v_mfma_f32_32x32x16_bf16 v[176:191], v[192:195], v[212:215], v[176:191]
    ds_write_b128 v14, v[64:67] offset:30720
    s_waitcnt lgkmcnt(9)
    v_mfma_f32_32x32x16_bf16 v[160:175], v[196:199], v[216:219], v[160:175]
    ds_write_b128 v14, v[68:71] offset:35328
    v_mfma_f32_32x32x16_bf16 v[176:191], v[196:199], v[220:223], v[176:191]
    ds_write_b128 v14, v[72:75] offset:39936
    s_waitcnt lgkmcnt(7)
    v_mfma_f32_32x32x16_bf16 v[160:175], v[200:203], v[224:227], v[160:175]
    ds_write_b128 v14, v[76:79] offset:44544
    v_mfma_f32_32x32x16_bf16 v[176:191], v[200:203], v[228:231], v[176:191]
    ds_write_b128 v15, v[80:83] offset:30720
    s_waitcnt lgkmcnt(5)
    v_mfma_f32_32x32x16_bf16 v[160:175], v[204:207], v[232:235], v[160:175]
    ds_write_b128 v15, v[84:87] offset:36864
    v_mfma_f32_32x32x16_bf16 v[176:191], v[204:207], v[236:239], v[176:191]
    s_waitcnt lgkmcnt(0)
    s_barrier
    ds_read_b128 v[208:211], v24 offset:0
    ds_read_b128 v[212:215], v24 offset:4608
    ds_read_b64_tr_b16 v[192:193], v25 offset:0
    ds_read_b64_tr_b16 v[194:195], v25 offset:768
    ds_read_b128 v[216:219], v24 offset:32
    ds_read_b128 v[220:223], v24 offset:4640
    ds_read_b64_tr_b16 v[196:197], v25 offset:3072
    ds_read_b64_tr_b16 v[198:199], v25 offset:3840
    ds_read_b128 v[224:227], v24 offset:64
    ds_read_b128 v[228:231], v24 offset:4672
    ds_read_b64_tr_b16 v[200:201], v25 offset:6144
    ds_read_b64_tr_b16 v[202:203], v25 offset:6912
    ds_read_b128 v[232:235], v24 offset:96
    ds_read_b128 v[236:239], v24 offset:4704
    ds_read_b64_tr_b16 v[204:205], v25 offset:9216
    ds_read_b64_tr_b16 v[206:207], v25 offset:9984
    s_waitcnt lgkmcnt(12)
    v_mfma_f32_32x32x16_bf16 v[160:175], v[192:195], v[208:211], v[160:175]
    s_waitcnt vmcnt(6)
    v_mfma_f32_32x32x16_bf16 v[176:191], v[192:195], v[212:215], v[176:191]
    ds_write_b128 v14, v[88:91] offset:0
    s_waitcnt lgkmcnt(9)
    v_mfma_f32_32x32x16_bf16 v[160:175], v[196:199], v[216:219], v[160:175]
    ds_write_b128 v14, v[92:95] offset:4608
    v_mfma_f32_32x32x16_bf16 v[176:191], v[196:199], v[220:223], v[176:191]
    ds_write_b128 v14, v[96:99] offset:9216
    s_waitcnt lgkmcnt(7)
    v_mfma_f32_32x32x16_bf16 v[160:175], v[200:203], v[224:227], v[160:175]
    ds_write_b128 v14, v[100:103] offset:13824
    v_mfma_f32_32x32x16_bf16 v[176:191], v[200:203], v[228:231], v[176:191]
    ds_write_b128 v15, v[104:107] offset:0
    s_waitcnt lgkmcnt(5)
    v_mfma_f32_32x32x16_bf16 v[160:175], v[204:207], v[232:235], v[160:175]
    ds_write_b128 v15, v[108:111] offset:6144
    v_mfma_f32_32x32x16_bf16 v[176:191], v[204:207], v[236:239], v[176:191]
    s_waitcnt lgkmcnt(0)
    s_barrier
    ds_read_b128 v[208:211], v22 offset:0
    ds_read_b128 v[212:215], v22 offset:4608
    ds_read_b64_tr_b16 v[192:193], v23 offset:0
    ds_read_b64_tr_b16 v[194:195], v23 offset:768
    ds_read_b128 v[216:219], v22 offset:32
    ds_read_b128 v[220:223], v22 offset:4640
    ds_read_b64_tr_b16 v[196:197], v23 offset:3072
    ds_read_b64_tr_b16 v[198:199], v23 offset:3840
    ds_read_b128 v[224:227], v22 offset:64
    ds_read_b128 v[228:231], v22 offset:4672
    ds_read_b64_tr_b16 v[200:201], v23 offset:6144
    ds_read_b64_tr_b16 v[202:203], v23 offset:6912
    ds_read_b128 v[232:235], v22 offset:96
    ds_read_b128 v[236:239], v22 offset:4704
    ds_read_b64_tr_b16 v[204:205], v23 offset:9216
    ds_read_b64_tr_b16 v[206:207], v23 offset:9984
    s_waitcnt lgkmcnt(12)
    v_mfma_f32_32x32x16_bf16 v[160:175], v[192:195], v[208:211], v[160:175]
    s_waitcnt vmcnt(0)
    v_mfma_f32_32x32x16_bf16 v[176:191], v[192:195], v[212:215], v[176:191]
    ds_write_b128 v14, v[112:115] offset:30720
    s_waitcnt lgkmcnt(9)
    v_mfma_f32_32x32x16_bf16 v[160:175], v[196:199], v[216:219], v[160:175]
    ds_write_b128 v14, v[116:119] offset:35328
    v_mfma_f32_32x32x16_bf16 v[176:191], v[196:199], v[220:223], v[176:191]
    ds_write_b128 v14, v[120:123] offset:39936
    s_waitcnt lgkmcnt(7)
    v_mfma_f32_32x32x16_bf16 v[160:175], v[200:203], v[224:227], v[160:175]
    ds_write_b128 v14, v[124:127] offset:44544
    v_mfma_f32_32x32x16_bf16 v[176:191], v[200:203], v[228:231], v[176:191]
    ds_write_b128 v15, v[128:131] offset:30720
    s_waitcnt lgkmcnt(5)
    v_mfma_f32_32x32x16_bf16 v[160:175], v[204:207], v[232:235], v[160:175]
    ds_write_b128 v15, v[132:135] offset:36864
    v_mfma_f32_32x32x16_bf16 v[176:191], v[204:207], v[236:239], v[176:191]
    s_waitcnt lgkmcnt(0)
    s_barrier
    ds_read_b128 v[208:211], v24 offset:0
    ds_read_b128 v[212:215], v24 offset:4608
    ds_read_b64_tr_b16 v[192:193], v25 offset:0
    ds_read_b64_tr_b16 v[194:195], v25 offset:768
    ds_read_b128 v[216:219], v24 offset:32
    ds_read_b128 v[220:223], v24 offset:4640
    ds_read_b64_tr_b16 v[196:197], v25 offset:3072
    ds_read_b64_tr_b16 v[198:199], v25 offset:3840
    ds_read_b128 v[224:227], v24 offset:64
    ds_read_b128 v[228:231], v24 offset:4672
    ds_read_b64_tr_b16 v[200:201], v25 offset:6144
    ds_read_b64_tr_b16 v[202:203], v25 offset:6912
    ds_read_b128 v[232:235], v24 offset:96
    ds_read_b128 v[236:239], v24 offset:4704
    ds_read_b64_tr_b16 v[204:205], v25 offset:9216
    ds_read_b64_tr_b16 v[206:207], v25 offset:9984
    s_waitcnt lgkmcnt(12)
    v_mfma_f32_32x32x16_bf16 v[160:175], v[192:195], v[208:211], v[160:175]
    v_mfma_f32_32x32x16_bf16 v[176:191], v[192:195], v[212:215], v[176:191]
    s_waitcnt lgkmcnt(8)
    v_mfma_f32_32x32x16_bf16 v[160:175], v[196:199], v[216:219], v[160:175]
    v_mfma_f32_32x32x16_bf16 v[176:191], v[196:199], v[220:223], v[176:191]
    s_waitcnt lgkmcnt(4)
    v_mfma_f32_32x32x16_bf16 v[160:175], v[200:203], v[224:227], v[160:175]
    v_mfma_f32_32x32x16_bf16 v[176:191], v[200:203], v[228:231], v[176:191]
    s_waitcnt lgkmcnt(0)
    v_mfma_f32_32x32x16_bf16 v[160:175], v[204:207], v[232:235], v[160:175]
    v_mfma_f32_32x32x16_bf16 v[176:191], v[204:207], v[236:239], v[176:191]
    s_nop 15
    s_nop 7
    s_load_dwordx2 s[14:15], s[0:1], 64
    s_load_dwordx2 s[16:17], s[0:1], 64
    s_load_dwordx2 s[18:19], s[0:1], 64
    s_waitcnt lgkmcnt(0)
    s_add_u32 s18, s18, 4194304
    s_addc_u32 s19, s19, 0
    s_barrier
    v_lshlrev_b32 v24, 13, v17
    v_lshl_add_u32 v22, v20, 7, v24
    v_lshl_add_u32 v22, v21, 4, v22
    ds_write_b128 v22, v[160:163] offset:0
    ds_write_b128 v22, v[164:167] offset:32
    ds_write_b128 v22, v[168:171] offset:64
    ds_write_b128 v22, v[172:175] offset:96
    ds_write_b128 v22, v[176:179] offset:4096
    ds_write_b128 v22, v[180:183] offset:4128
    ds_write_b128 v22, v[184:187] offset:4160
    ds_write_b128 v22, v[188:191] offset:4192
    v_lshl_add_u32 v23, v16, 5, v24
    v_lshrrev_b32 v25, 2, v16
    v_and_b32 v26, 3, v16
    v_lshl_add_u32 v27, v18, 6, s10
    v_add_u32 v27, v27, v25
    s_lshl_b32 s12, s9, 6
    v_lshl_add_u32 v28, v19, 5, s12
    v_lshl_add_u32 v28, v26, 3, v28
    v_lshlrev_b32 v29, 10, v27
    v_add_u32 v29, v29, v28
    v_lshlrev_b32 v29, 1, v29
    s_lshl_b32 s13, s9, 1
    v_lshl_add_u32 v30, v27, 5, s13
    v_add_u32 v30, v30, v19
    v_lshlrev_b32 v30, 3, v30
    global_load_dwordx4 v[40:43], v29, s[14:15] offset:0
    v_add_u32 v31, 32768, v29
    global_load_dwordx4 v[44:47], v31, s[14:15]
    v_add_u32 v31, 65536, v29
    global_load_dwordx4 v[48:51], v31, s[14:15]
    v_add_u32 v31, 98304, v29
    global_load_dwordx4 v[52:55], v31, s[14:15]
    s_waitcnt lgkmcnt(0)
    ds_read_b128 v[64:67], v23 offset:0
    ds_read_b128 v[68:71], v23 offset:16
    ds_read_b128 v[72:75], v23 offset:2048
    ds_read_b128 v[76:79], v23 offset:2064
    ds_read_b128 v[80:83], v23 offset:4096
    ds_read_b128 v[84:87], v23 offset:4112
    ds_read_b128 v[88:91], v23 offset:6144
    ds_read_b128 v[92:95], v23 offset:6160
    s_waitcnt vmcnt(0) lgkmcnt(0)
    v_mov_b32 v56, 0
    v_mov_b32 v57, 0
    v_lshlrev_b32 v58, 16, v40
    v_and_b32 v59, 0xffff0000, v40
    v_add_f32 v58, v58, v64
    v_add_f32 v59, v59, v65
    v_cvt_pk_bf16_f32 v40, v58, v59
    v_lshlrev_b32 v58, 16, v40
    v_and_b32 v59, 0xffff0000, v40
    v_add_f32 v56, v56, v58
    v_fmac_f32 v57, v58, v58
    v_add_f32 v56, v56, v59
    v_fmac_f32 v57, v59, v59
    v_lshlrev_b32 v58, 16, v41
    v_and_b32 v59, 0xffff0000, v41
    v_add_f32 v58, v58, v66
    v_add_f32 v59, v59, v67
    v_cvt_pk_bf16_f32 v41, v58, v59
    v_lshlrev_b32 v58, 16, v41
    v_and_b32 v59, 0xffff0000, v41
    v_add_f32 v56, v56, v58
    v_fmac_f32 v57, v58, v58
    v_add_f32 v56, v56, v59
    v_fmac_f32 v57, v59, v59
    v_lshlrev_b32 v58, 16, v42
    v_and_b32 v59, 0xffff0000, v42
    v_add_f32 v58, v58, v68
    v_add_f32 v59, v59, v69
    v_cvt_pk_bf16_f32 v42, v58, v59
    v_lshlrev_b32 v58, 16, v42
    v_and_b32 v59, 0xffff0000, v42
    v_add_f32 v56, v56, v58
    v_fmac_f32 v57, v58, v58
    v_add_f32 v56, v56, v59
    v_fmac_f32 v57, v59, v59
    v_lshlrev_b32 v58, 16, v43
    v_and_b32 v59, 0xffff0000, v43
    v_add_f32 v58, v58, v70
    v_add_f32 v59, v59, v71
    v_cvt_pk_bf16_f32 v43, v58, v59
    v_lshlrev_b32 v58, 16, v43
    v_and_b32 v59, 0xffff0000, v43
    v_add_f32 v56, v56, v58
    v_fmac_f32 v57, v58, v58
    v_add_f32 v56, v56, v59
    v_fmac_f32 v57, v59, v59
    v_add_u32 v31, 0, v29
    global_store_dwordx4 v31, v[40:43], s[16:17]
    s_nop 1
    v_mov_b32_dpp v58, v56 quad_perm:[1,0,3,2] row_mask:0xf bank_mask:0xf
    v_mov_b32_dpp v59, v57 quad_perm:[1,0,3,2] row_mask:0xf bank_mask:0xf
    v_add_f32 v56, v56, v58
    v_add_f32 v57, v57, v59
    s_nop 1
    v_mov_b32_dpp v58, v56 quad_perm:[2,3,0,1] row_mask:0xf bank_mask:0xf
    v_mov_b32_dpp v59, v57 quad_perm:[2,3,0,1] row_mask:0xf bank_mask:0xf
    v_add_f32 v56, v56, v58
    v_add_f32 v57, v57, v59
    v_cmp_eq_u32 vcc, 0, v26
    s_and_saveexec_b64 s[22:23], vcc
    v_add_u32 v31, 0, v30
    global_store_dwordx2 v31, v[56:57], s[18:19]
    s_mov_b64 exec, s[22:23]
    v_mov_b32 v56, 0
    v_mov_b32 v57, 0
    v_lshlrev_b32 v58, 16, v44
    v_and_b32 v59, 0xffff0000, v44
    v_add_f32 v58, v58, v72
    v_add_f32 v59, v59, v73
    v_cvt_pk_bf16_f32 v44, v58, v59
    v_lshlrev_b32 v58, 16, v44
    v_and_b32 v59, 0xffff0000, v44
    v_add_f32 v56, v56, v58
    v_fmac_f32 v57, v58, v58
    v_add_f32 v56, v56, v59
    v_fmac_f32 v57, v59, v59
    v_lshlrev_b32 v58, 16, v45
    v_and_b32 v59, 0xffff0000, v45
    v_add_f32 v58, v58, v74
    v_add_f32 v59, v59, v75
    v_cvt_pk_bf16_f32 v45, v58, v59
    v_lshlrev_b32 v58, 16, v45
    v_and_b32 v59, 0xffff0000, v45
    v_add_f32 v56, v56, v58
    v_fmac_f32 v57, v58, v58
    v_add_f32 v56, v56, v59
    v_fmac_f32 v57, v59, v59
    v_lshlrev_b32 v58, 16, v46
    v_and_b32 v59, 0xffff0000, v46
    v_add_f32 v58, v58, v76
    v_add_f32 v59, v59, v77
    v_cvt_pk_bf16_f32 v46, v58, v59
    v_lshlrev_b32 v58, 16, v46
    v_and_b32 v59, 0xffff0000, v46
    v_add_f32 v56, v56, v58
    v_fmac_f32 v57, v58, v58
    v_add_f32 v56, v56, v59
    v_fmac_f32 v57, v59, v59
    v_lshlrev_b32 v58, 16, v47
    v_and_b32 v59, 0xffff0000, v47
    v_add_f32 v58, v58, v78
    v_add_f32 v59, v59, v79
    v_cvt_pk_bf16_f32 v47, v58, v59
    v_lshlrev_b32 v58, 16, v47
    v_and_b32 v59, 0xffff0000, v47
    v_add_f32 v56, v56, v58
    v_fmac_f32 v57, v58, v58
    v_add_f32 v56, v56, v59
    v_fmac_f32 v57, v59, v59
    v_add_u32 v31, 32768, v29
    global_store_dwordx4 v31, v[44:47], s[16:17]
    s_nop 1
    v_mov_b32_dpp v58, v56 quad_perm:[1,0,3,2] row_mask:0xf bank_mask:0xf
    v_mov_b32_dpp v59, v57 quad_perm:[1,0,3,2] row_mask:0xf bank_mask:0xf
    v_add_f32 v56, v56, v58
    v_add_f32 v57, v57, v59
    s_nop 1
    v_mov_b32_dpp v58, v56 quad_perm:[2,3,0,1] row_mask:0xf bank_mask:0xf
    v_mov_b32_dpp v59, v57 quad_perm:[2,3,0,1] row_mask:0xf bank_mask:0xf
    v_add_f32 v56, v56, v58
    v_add_f32 v57, v57, v59
    v_cmp_eq_u32 vcc, 0, v26
    s_and_saveexec_b64 s[22:23], vcc
    v_add_u32 v31, 4096, v30
    global_store_dwordx2 v31, v[56:57], s[18:19]
    s_mov_b64 exec, s[22:23]
    v_mov_b32 v56, 0
    v_mov_b32 v57, 0
    v_lshlrev_b32 v58, 16, v48
    v_and_b32 v59, 0xffff0000, v48
    v_add_f32 v58, v58, v80
    v_add_f32 v59, v59, v81
    v_cvt_pk_bf16_f32 v48, v58, v59
    v_lshlrev_b32 v58, 16, v48
    v_and_b32 v59, 0xffff0000, v48
    v_add_f32 v56, v56, v58
    v_fmac_f32 v57, v58, v58
    v_add_f32 v56, v56, v59
    v_fmac_f32 v57, v59, v59
    v_lshlrev_b32 v58, 16, v49
    v_and_b32 v59, 0xffff0000, v49
    v_add_f32 v58, v58, v82
    v_add_f32 v59, v59, v83
    v_cvt_pk_bf16_f32 v49, v58, v59
    v_lshlrev_b32 v58, 16, v49
    v_and_b32 v59, 0xffff0000, v49
    v_add_f32 v56, v56, v58
    v_fmac_f32 v57, v58, v58
    v_add_f32 v56, v56, v59
    v_fmac_f32 v57, v59, v59
    v_lshlrev_b32 v58, 16, v50
    v_and_b32 v59, 0xffff0000, v50
    v_add_f32 v58, v58, v84
    v_add_f32 v59, v59, v85
    v_cvt_pk_bf16_f32 v50, v58, v59
    v_lshlrev_b32 v58, 16, v50
    v_and_b32 v59, 0xffff0000, v50
    v_add_f32 v56, v56, v58
    v_fmac_f32 v57, v58, v58
    v_add_f32 v56, v56, v59
    v_fmac_f32 v57, v59, v59
    v_lshlrev_b32 v58, 16, v51
    v_and_b32 v59, 0xffff0000, v51
    v_add_f32 v58, v58, v86
    v_add_f32 v59, v59, v87
    v_cvt_pk_bf16_f32 v51, v58, v59
    v_lshlrev_b32 v58, 16, v51
    v_and_b32 v59, 0xffff0000, v51
    v_add_f32 v56, v56, v58
    v_fmac_f32 v57, v58, v58
    v_add_f32 v56, v56, v59
    v_fmac_f32 v57, v59, v59
    v_add_u32 v31, 65536, v29
    global_store_dwordx4 v31, v[48:51], s[16:17]
    s_nop 1
    v_mov_b32_dpp v58, v56 quad_perm:[1,0,3,2] row_mask:0xf bank_mask:0xf
    v_mov_b32_dpp v59, v57 quad_perm:[1,0,3,2] row_mask:0xf bank_mask:0xf
    v_add_f32 v56, v56, v58
    v_add_f32 v57, v57, v59
    s_nop 1
    v_mov_b32_dpp v58, v56 quad_perm:[2,3,0,1] row_mask:0xf bank_mask:0xf
    v_mov_b32_dpp v59, v57 quad_perm:[2,3,0,1] row_mask:0xf bank_mask:0xf
    v_add_f32 v56, v56, v58
    v_add_f32 v57, v57, v59
    v_cmp_eq_u32 vcc, 0, v26
    s_and_saveexec_b64 s[22:23], vcc
    v_add_u32 v31, 8192, v30
    global_store_dwordx2 v31, v[56:57], s[18:19]
    s_mov_b64 exec, s[22:23]
    v_mov_b32 v56, 0
    v_mov_b32 v57, 0
    v_lshlrev_b32 v58, 16, v52
    v_and_b32 v59, 0xffff0000, v52
    v_add_f32 v58, v58, v88
    v_add_f32 v59, v59, v89
    v_cvt_pk_bf16_f32 v52, v58, v59
    v_lshlrev_b32 v58, 16, v52
    v_and_b32 v59, 0xffff0000, v52
    v_add_f32 v56, v56, v58
    v_fmac_f32 v57, v58, v58
    v_add_f32 v56, v56, v59
    v_fmac_f32 v57, v59, v59
    v_lshlrev_b32 v58, 16, v53
    v_and_b32 v59, 0xffff0000, v53
    v_add_f32 v58, v58, v90
    v_add_f32 v59, v59, v91
    v_cvt_pk_bf16_f32 v53, v58, v59
    v_lshlrev_b32 v58, 16, v53
    v_and_b32 v59, 0xffff0000, v53
    v_add_f32 v56, v56, v58
    v_fmac_f32 v57, v58, v58
    v_add_f32 v56, v56, v59
    v_fmac_f32 v57, v59, v59
    v_lshlrev_b32 v58, 16, v54
    v_and_b32 v59, 0xffff0000, v54
    v_add_f32 v58, v58, v92
    v_add_f32 v59, v59, v93
    v_cvt_pk_bf16_f32 v54, v58, v59
    v_lshlrev_b32 v58, 16, v54
    v_and_b32 v59, 0xffff0000, v54
    v_add_f32 v56, v56, v58
    v_fmac_f32 v57, v58, v58
    v_add_f32 v56, v56, v59
    v_fmac_f32 v57, v59, v59
    v_lshlrev_b32 v58, 16, v55
    v_and_b32 v59, 0xffff0000, v55
    v_add_f32 v58, v58, v94
    v_add_f32 v59, v59, v95
    v_cvt_pk_bf16_f32 v55, v58, v59
    v_lshlrev_b32 v58, 16, v55
    v_and_b32 v59, 0xffff0000, v55
    v_add_f32 v56, v56, v58
    v_fmac_f32 v57, v58, v58
    v_add_f32 v56, v56, v59
    v_fmac_f32 v57, v59, v59
    v_add_u32 v31, 98304, v29
    global_store_dwordx4 v31, v[52:55], s[16:17]
    s_nop 1
    v_mov_b32_dpp v58, v56 quad_perm:[1,0,3,2] row_mask:0xf bank_mask:0xf
    v_mov_b32_dpp v59, v57 quad_perm:[1,0,3,2] row_mask:0xf bank_mask:0xf
    v_add_f32 v56, v56, v58
    v_add_f32 v57, v57, v59
    s_nop 1
    v_mov_b32_dpp v58, v56 quad_perm:[2,3,0,1] row_mask:0xf bank_mask:0xf
    v_mov_b32_dpp v59, v57 quad_perm:[2,3,0,1] row_mask:0xf bank_mask:0xf
    v_add_f32 v56, v56, v58
    v_add_f32 v57, v57, v59
    v_cmp_eq_u32 vcc, 0, v26
    s_and_saveexec_b64 s[22:23], vcc
    v_add_u32 v31, 12288, v30
    global_store_dwordx2 v31, v[56:57], s[18:19]
    s_mov_b64 exec, s[22:23]
L_wo1_end:
    s_endpgm
.globl qkv2_kernel
.p2align 8
.type qkv2_kernel,@function
qkv2_kernel:
    s_cmp_ge_u32 s2, 256
    s_cbranch_scc1 L_qkv2_end
    s_load_dwordx2 s[4:5], s[0:1], 64
    s_load_dwordx2 s[6:7], s[0:1], 8
    s_load_dwordx2 s[14:15], s[0:1], 64
    s_waitcnt lgkmcnt(0)
    s_add_u32 s14, s14, 4194304
    s_addc_u32 s15, s15, 0
    s_lshr_b32 s8, s2, 4
    s_and_b32 s9, s2, 15
    v_lshrrev_b32 v1, 3, v0
    v_and_b32 v2, 7, v0
    s_lshl_b32 s10, s8, 7
    v_add_u32 v3, s10, v1
    v_lshlrev_b32 v3, 11, v3
    v_lshl_add_u32 v3, v2, 4, v3
    v_add_u32 v4, 0, v3
    v_add_u32 v5, 65536, v3
    v_add_u32 v6, 131072, v3
    v_add_u32 v7, 196608, v3
    s_mov_b32 s11, 6144
    v_mul_lo_u32 v3, v1, s11
    v_lshl_add_u32 v3, v2, 4, v3
    s_lshl_b32 s12, s9, 7
    v_add_u32 v3, s12, v3
    v_add_u32 v8, 0, v3
    v_add_u32 v9, 2048, v3
    v_add_u32 v10, 4096, v3
    v_add_u32 v11, 196608, v3
    v_add_u32 v12, 198656, v3
    v_add_u32 v13, 200704, v3
    v_mul_u32_u24 v14, 144, v1
    v_lshl_add_u32 v14, v2, 4, v14
    v_mul_u32_u24 v15, 448, v1
    v_lshl_add_u32 v15, v2, 4, v15
    v_add_u32 v15, 18432, v15
    v_and_b32 v16, 63, v0
    v_lshrrev_b32 v17, 6, v0
    v_lshrrev_b32 v18, 1, v17
    v_and_b32 v19, 1, v17
    v_and_b32 v20, 31, v16
    v_lshrrev_b32 v21, 5, v16
    v_lshl_add_u32 v22, v18, 6, v20
    v_mul_u32_u24 v22, 144, v22
    v_lshl_add_u32 v22, v21, 4, v22
    v_bfe_u32 v23, v16, 2, 2
    v_lshl_add_u32 v23, v21, 3, v23
    v_mul_u32_u24 v23, 448, v23
    v_bfe_u32 v24, v16, 4, 1
    v_lshlrev_b32 v24, 5, v24
    v_lshl_add_u32 v24, v19, 6, v24
    v_and_b32 v25, 3, v16
    v_lshl_add_u32 v24, v25, 3, v24
    v_add_u32 v23, v23, v24
    v_add_u32 v23, 18432, v23
    v_add_u32 v24, 47104, v22
    v_add_u32 v25, 47104, v23
    v_lshrrev_b32 v26, 1, v0
    v_and_b32 v27, 1, v0
    v_add_u32 v28, s10, v26
    v_lshlrev_b32 v28, 8, v28
    v_lshl_add_u32 v28, v27, 7, v28
    global_load_dwordx4 v[160:163], v28, s[14:15] offset:0
    global_load_dwordx4 v[164:167], v28, s[14:15] offset:16
    global_load_dwordx4 v[168:171], v28, s[14:15] offset:32
    global_load_dwordx4 v[172:175], v28, s[14:15] offset:48
    global_load_dwordx4 v[176:179], v28, s[14:15] offset:64
    global_load_dwordx4 v[180:183], v28, s[14:15] offset:80
    global_load_dwordx4 v[184:187], v28, s[14:15] offset:96
    global_load_dwordx4 v[188:191], v28, s[14:15] offset:112
    v_mov_b32 v34, 0
    v_mov_b32 v35, 0
    global_load_dwordx4 v[40:43], v4, s[4:5]
    global_load_dwordx4 v[44:47], v5, s[4:5]
    global_load_dwordx4 v[48:51], v6, s[4:5]
    global_load_dwordx4 v[52:55], v7, s[4:5]
    global_load_dwordx4 v[56:59], v8, s[6:7]
    global_load_dwordx4 v[60:63], v9, s[6:7]
    global_load_dwordx4 v[64:67], v10, s[6:7]
    global_load_dwordx4 v[68:71], v11, s[6:7]
    global_load_dwordx4 v[72:75], v12, s[6:7]
    global_load_dwordx4 v[76:79], v13, s[6:7]
    s_add_u32 s4, s4, 128
    s_addc_u32 s5, s5, 0
    s_add_u32 s6, s6, 393216
    s_addc_u32 s7, s7, 0
    global_load_dwordx4 v[80:83], v4, s[4:5]
    global_load_dwordx4 v[84:87], v5, s[4:5]
    global_load_dwordx4 v[88:91], v6, s[4:5]
    global_load_dwordx4 v[92:95], v7, s[4:5]
    global_load_dwordx4 v[96:99], v8, s[6:7]
    global_load_dwordx4 v[100:103], v9, s[6:7]
    global_load_dwordx4 v[104:107], v10, s[6:7]
    global_load_dwordx4 v[108:111], v11, s[6:7]
    global_load_dwordx4 v[112:115], v12, s[6:7]
    global_load_dwordx4 v[116:119], v13, s[6:7]
    s_add_u32 s4, s4, 128
    s_addc_u32 s5, s5, 0
    s_add_u32 s6, s6, 393216
    s_addc_u32 s7, s7, 0
    s_waitcnt vmcnt(20)
    v_add_f32 v34, v34, v160
    v_add_f32 v35, v35, v161
    v_add_f32 v34, v34, v162
    v_add_f32 v35, v35, v163
    v_add_f32 v34, v34, v164
    v_add_f32 v35, v35, v165
    v_add_f32 v34, v34, v166
    v_add_f32 v35, v35, v167
    v_add_f32 v34, v34, v168
    v_add_f32 v35, v35, v169
    v_add_f32 v34, v34, v170
    v_add_f32 v35, v35, v171
    v_add_f32 v34, v34, v172
    v_add_f32 v35, v35, v173
    v_add_f32 v34, v34, v174
    v_add_f32 v35, v35, v175
    v_add_f32 v34, v34, v176
    v_add_f32 v35, v35, v177
    v_add_f32 v34, v34, v178
    v_add_f32 v35, v35, v179
    v_add_f32 v34, v34, v180
    v_add_f32 v35, v35, v181
    v_add_f32 v34, v34, v182
    v_add_f32 v35, v35, v183
    v_add_f32 v34, v34, v184
    v_add_f32 v35, v35, v185
    v_add_f32 v34, v34, v186
    v_add_f32 v35, v35, v187
    v_add_f32 v34, v34, v188
    v_add_f32 v35, v35, v189
    v_add_f32 v34, v34, v190
    v_add_f32 v35, v35, v191
    s_nop 1
    v_mov_b32_dpp v31, v34 quad_perm:[1,0,3,2] row_mask:0xf bank_mask:0xf
    v_mov_b32_dpp v32, v35 quad_perm:[1,0,3,2] row_mask:0xf bank_mask:0xf
    v_add_f32 v34, v34, v31
    v_add_f32 v35, v35, v32
    v_mul_f32 v34, 0x3a800000, v34
    v_mul_f32 v35, 0x3a800000, v35
    v_fma_f32 v35, -v34, v34, v35
    v_max_f32 v35, 0, v35
    v_add_f32 v35, 0x3727c5ac, v35
    v_rsq_f32 v35, v35
    s_nop 0
    v_mul_f32 v34, v34, v35
    v_sub_f32 v34, 0, v34
    v_lshlrev_b32 v31, 3, v26
    v_add_u32 v31, 94208, v31
    ds_write_b64 v31, v[34:35]
    s_waitcnt lgkmcnt(0)
    s_barrier
    v_lshlrev_b32 v31, 3, v1
    v_add_u32 v31, 94208, v31
    ds_read_b64 v[26:27], v31 offset:0
    ds_read_b64 v[28:29], v31 offset:256
    ds_read_b64 v[30:31], v31 offset:512
    ds_read_b64 v[32:33], v31 offset:768
    s_waitcnt lgkmcnt(0)
    v_mov_b32 v160, 0
    v_mov_b32 v161, 0
    v_mov_b32 v162, 0
    v_mov_b32 v163, 0
    v_mov_b32 v164, 0
    v_mov_b32 v165, 0
    v_mov_b32 v166, 0
    v_mov_b32 v167, 0
    v_mov_b32 v168, 0
    v_mov_b32 v169, 0
    v_mov_b32 v170, 0
    v_mov_b32 v171, 0
    v_mov_b32 v172, 0
    v_mov_b32 v173, 0
    v_mov_b32 v174, 0
    v_mov_b32 v175, 0
    v_mov_b32 v176, 0
    v_mov_b32 v177, 0
    v_mov_b32 v178, 0
    v_mov_b32 v179, 0
    v_mov_b32 v180, 0
    v_mov_b32 v181, 0
    v_mov_b32 v182, 0
    v_mov_b32 v183, 0
    v_mov_b32 v184, 0
    v_mov_b32 v185, 0
    v_mov_b32 v186, 0
    v_mov_b32 v187, 0
    v_mov_b32 v188, 0
    v_mov_b32 v189, 0
    v_mov_b32 v190, 0
    v_mov_b32 v191, 0
    v_mov_b32 v192, 0
    v_mov_b32 v193, 0
    v_mov_b32 v194, 0
    v_mov_b32 v195, 0
    v_mov_b32 v196, 0
    v_mov_b32 v197, 0
    v_mov_b32 v198, 0
    v_mov_b32 v199, 0
    v_mov_b32 v200, 0
    v_mov_b32 v201, 0
    v_mov_b32 v202, 0
    v_mov_b32 v203, 0
    v_mov_b32 v204, 0
    v_mov_b32 v205, 0
    v_mov_b32 v206, 0
    v_mov_b32 v207, 0
    v_mov_b32 v208, 0
    v_mov_b32 v209, 0
    v_mov_b32 v210, 0
    v_mov_b32 v211, 0
    v_mov_b32 v212, 0
    v_mov_b32 v213, 0
    v_mov_b32 v214, 0
    v_mov_b32 v215, 0
    v_mov_b32 v216, 0
    v_mov_b32 v217, 0
    v_mov_b32 v218, 0
    v_mov_b32 v219, 0
    v_mov_b32 v220, 0
    v_mov_b32 v221, 0
    v_mov_b32 v222, 0
    v_mov_b32 v223, 0
    v_mov_b32 v224, 0
    v_mov_b32 v225, 0
    v_mov_b32 v226, 0
    v_mov_b32 v227, 0
    v_mov_b32 v228, 0
    v_mov_b32 v229, 0
    v_mov_b32 v230, 0
    v_mov_b32 v231, 0
    v_mov_b32 v232, 0
    v_mov_b32 v233, 0
    v_mov_b32 v234, 0
    v_mov_b32 v235, 0
    v_mov_b32 v236, 0
    v_mov_b32 v237, 0
    v_mov_b32 v238, 0
    v_mov_b32 v239, 0
    v_mov_b32 v240, 0
    v_mov_b32 v241, 0
    v_mov_b32 v242, 0
    v_mov_b32 v243, 0
    v_mov_b32 v244, 0
    v_mov_b32 v245, 0
    v_mov_b32 v246, 0
    v_mov_b32 v247, 0
    v_mov_b32 v248, 0
    v_mov_b32 v249, 0
    v_mov_b32 v250, 0
    v_mov_b32 v251, 0
    v_mov_b32 v252, 0
    v_mov_b32 v253, 0
    v_mov_b32 v254, 0
    v_mov_b32 v255, 0
    s_waitcnt vmcnt(10)
    v_lshlrev_b32 v36, 16, v40
    v_and_b32 v37, 0xffff0000, v40
    v_fma_f32 v36, v36, v27, v26
    v_fma_f32 v37, v37, v27, v26
    v_cvt_pk_bf16_f32 v40, v36, v37
    v_lshlrev_b32 v36, 16, v41
    v_and_b32 v37, 0xffff0000, v41
    v_fma_f32 v36, v36, v27, v26
    v_fma_f32 v37, v37, v27, v26
    v_cvt_pk_bf16_f32 v41, v36, v37
    v_lshlrev_b32 v36, 16, v42
    v_and_b32 v37, 0xffff0000, v42
    v_fma_f32 v36, v36, v27, v26
    v_fma_f32 v37, v37, v27, v26
    v_cvt_pk_bf16_f32 v42, v36, v37
    v_lshlrev_b32 v36, 16, v43
    v_and_b32 v37, 0xffff0000, v43
    v_fma_f32 v36, v36, v27, v26
    v_fma_f32 v37, v37, v27, v26
    v_cvt_pk_bf16_f32 v43, v36, v37
    ds_write_b128 v14, v[40:43] offset:0
    v_lshlrev_b32 v36, 16, v44
    v_and_b32 v37, 0xffff0000, v44
    v_fma_f32 v36, v36, v29, v28
    v_fma_f32 v37, v37, v29, v28
    v_cvt_pk_bf16_f32 v44, v36, v37
    v_lshlrev_b32 v36, 16, v45
    v_and_b32 v37, 0xffff0000, v45
    v_fma_f32 v36, v36, v29, v28
    v_fma_f32 v37, v37, v29, v28
    v_cvt_pk_bf16_f32 v45, v36, v37
    v_lshlrev_b32 v36, 16, v46
    v_and_b32 v37, 0xffff0000, v46
    v_fma_f32 v36, v36, v29, v28
    v_fma_f32 v37, v37, v29, v28
    v_cvt_pk_bf16_f32 v46, v36, v37
    v_lshlrev_b32 v36, 16, v47
    v_and_b32 v37, 0xffff0000, v47
    v_fma_f32 v36, v36, v29, v28
    v_fma_f32 v37, v37, v29, v28
    v_cvt_pk_bf16_f32 v47, v36, v37
    ds_write_b128 v14, v[44:47] offset:4608
    v_lshlrev_b32 v36, 16, v48
    v_and_b32 v37, 0xffff0000, v48
    v_fma_f32 v36, v36, v31, v30
    v_fma_f32 v37, v37, v31, v30
    v_cvt_pk_bf16_f32 v48, v36, v37
    v_lshlrev_b32 v36, 16, v49
    v_and_b32 v37, 0xffff0000, v49
    v_fma_f32 v36, v36, v31, v30
    v_fma_f32 v37, v37, v31, v30
    v_cvt_pk_bf16_f32 v49, v36, v37
    v_lshlrev_b32 v36, 16, v50
    v_and_b32 v37, 0xffff0000, v50
    v_fma_f32 v36, v36, v31, v30
    v_fma_f32 v37, v37, v31, v30
    v_cvt_pk_bf16_f32 v50, v36, v37
    v_lshlrev_b32 v36, 16, v51
    v_and_b32 v37, 0xffff0000, v51
    v_fma_f32 v36, v36, v31, v30
    v_fma_f32 v37, v37, v31, v30
    v_cvt_pk_bf16_f32 v51, v36, v37
    ds_write_b128 v14, v[48:51] offset:9216
    v_lshlrev_b32 v36, 16, v52
    v_and_b32 v37, 0xffff0000, v52
    v_fma_f32 v36, v36, v33, v32
    v_fma_f32 v37, v37, v33, v32
    v_cvt_pk_bf16_f32 v52, v36, v37
    v_lshlrev_b32 v36, 16, v53
    v_and_b32 v37, 0xffff0000, v53
    v_fma_f32 v36, v36, v33, v32
    v_fma_f32 v37, v37, v33, v32
    v_cvt_pk_bf16_f32 v53, v36, v37
    v_lshlrev_b32 v36, 16, v54
    v_and_b32 v37, 0xffff0000, v54
    v_fma_f32 v36, v36, v33, v32
    v_fma_f32 v37, v37, v33, v32
    v_cvt_pk_bf16_f32 v54, v36, v37
    v_lshlrev_b32 v36, 16, v55
    v_and_b32 v37, 0xffff0000, v55
    v_fma_f32 v36, v36, v33, v32
    v_fma_f32 v37, v37, v33, v32
    v_cvt_pk_bf16_f32 v55, v36, v37
    ds_write_b128 v14, v[52:55] offset:13824
    ds_write_b128 v15, v[56:59] offset:0
    ds_write_b128 v15, v[60:63] offset:128
    ds_write_b128 v15, v[64:67] offset:256
    ds_write_b128 v15, v[68:71] offset:14336
    ds_write_b128 v15, v[72:75] offset:14464
    ds_write_b128 v15, v[76:79] offset:14592
    s_waitcnt lgkmcnt(0)
    s_barrier
    ds_read_b128 v[120:123], v22 offset:0
    ds_read_b128 v[124:127], v22 offset:4608
    ds_read_b64_tr_b16 v[136:137], v23 offset:0
    ds_read_b64_tr_b16 v[138:139], v23 offset:1792
    ds_read_b64_tr_b16 v[140:141], v23 offset:128
    ds_read_b64_tr_b16 v[142:143], v23 offset:1920
    ds_read_b64_tr_b16 v[144:145], v23 offset:256
    ds_read_b64_tr_b16 v[146:147], v23 offset:2048
    s_mov_b32 s20, 0
L_qkv2_loop:
    s_waitcnt lgkmcnt(0)
    v_mfma_f32_32x32x16_bf16 v[160:175], v[136:139], v[120:123], v[160:175]
    ds_read_b128 v[128:131], v22 offset:32
    ds_read_b128 v[132:135], v22 offset:4640
    ds_read_b64_tr_b16 v[148:149], v23 offset:7168
    ds_read_b64_tr_b16 v[150:151], v23 offset:8960
    ds_read_b64_tr_b16 v[152:153], v23 offset:7296
    ds_read_b64_tr_b16 v[154:155], v23 offset:9088
    ds_read_b64_tr_b16 v[156:157], v23 offset:7424
    ds_read_b64_tr_b16 v[158:159], v23 offset:9216
    v_mfma_f32_32x32x16_bf16 v[176:191], v[120:123], v[140:143], v[176:191]
    global_load_dwordx4 v[40:43], v4, s[4:5]
    global_load_dwordx4 v[44:47], v5, s[4:5]
    global_load_dwordx4 v[48:51], v6, s[4:5]
    global_load_dwordx4 v[52:55], v7, s[4:5]
    global_load_dwordx4 v[56:59], v8, s[6:7]
    global_load_dwordx4 v[60:63], v9, s[6:7]
    global_load_dwordx4 v[64:67], v10, s[6:7]
    global_load_dwordx4 v[68:71], v11, s[6:7]
    v_mfma_f32_32x32x16_bf16 v[192:207], v[120:123], v[144:147], v[192:207]
    global_load_dwordx4 v[72:75], v12, s[6:7]
    global_load_dwordx4 v[76:79], v13, s[6:7]
    s_add_u32 s4, s4, 128
    s_addc_u32 s5, s5, 0
    s_add_u32 s6, s6, 393216
    s_addc_u32 s7, s7, 0
    s_waitcnt vmcnt(10)
    v_mfma_f32_32x32x16_bf16 v[208:223], v[136:139], v[124:127], v[208:223]
    v_lshlrev_b32 v36, 16, v80
    v_and_b32 v37, 0xffff0000, v80
    v_fma_f32 v36, v36, v27, v26
    v_fma_f32 v37, v37, v27, v26
    v_cvt_pk_bf16_f32 v80, v36, v37
    v_lshlrev_b32 v36, 16, v81
    v_and_b32 v37, 0xffff0000, v81
    v_mfma_f32_32x32x16_bf16 v[224:239], v[124:127], v[140:143], v[224:239]
    v_fma_f32 v36, v36, v27, v26
    v_fma_f32 v37, v37, v27, v26
    v_cvt_pk_bf16_f32 v81, v36, v37
    v_lshlrev_b32 v36, 16, v82
    v_and_b32 v37, 0xffff0000, v82
    v_fma_f32 v36, v36, v27, v26
    v_fma_f32 v37, v37, v27, v26
    v_mfma_f32_32x32x16_bf16 v[240:255], v[124:127], v[144:147], v[240:255]
    v_cvt_pk_bf16_f32 v82, v36, v37
    v_lshlrev_b32 v36, 16, v83
    v_and_b32 v37, 0xffff0000, v83
    v_fma_f32 v36, v36, v27, v26
    v_fma_f32 v37, v37, v27, v26
    v_cvt_pk_bf16_f32 v83, v36, v37
    ds_write_b128 v14, v[80:83] offset:47104
    s_waitcnt lgkmcnt(1)
    v_mfma_f32_32x32x16_bf16 v[160:175], v[148:151], v[128:131], v[160:175]
    ds_read_b128 v[120:123], v22 offset:64
    ds_read_b128 v[124:127], v22 offset:4672
    ds_read_b64_tr_b16 v[136:137], v23 offset:14336
    ds_read_b64_tr_b16 v[138:139], v23 offset:16128
    ds_read_b64_tr_b16 v[140:141], v23 offset:14464
    ds_read_b64_tr_b16 v[142:143], v23 offset:16256
    ds_read_b64_tr_b16 v[144:145], v23 offset:14592
    ds_read_b64_tr_b16 v[146:147], v23 offset:16384
    v_lshlrev_b32 v36, 16, v84
    v_mfma_f32_32x32x16_bf16 v[176:191], v[128:131], v[152:155], v[176:191]
    v_and_b32 v37, 0xffff0000, v84
    v_fma_f32 v36, v36, v29, v28
    v_fma_f32 v37, v37, v29, v28
    v_cvt_pk_bf16_f32 v84, v36, v37
    v_lshlrev_b32 v36, 16, v85
    v_and_b32 v37, 0xffff0000, v85
    v_fma_f32 v36, v36, v29, v28
    v_fma_f32 v37, v37, v29, v28
    v_cvt_pk_bf16_f32 v85, v36, v37
    v_mfma_f32_32x32x16_bf16 v[192:207], v[128:131], v[156:159], v[192:207]
    v_lshlrev_b32 v36, 16, v86
    v_and_b32 v37, 0xffff0000, v86
    v_fma_f32 v36, v36, v29, v28
    v_fma_f32 v37, v37, v29, v28
    v_cvt_pk_bf16_f32 v86, v36, v37
    v_lshlrev_b32 v36, 16, v87
    v_and_b32 v37, 0xffff0000, v87
    v_fma_f32 v36, v36, v29, v28
    v_mfma_f32_32x32x16_bf16 v[208:223], v[148:151], v[132:135], v[208:223]
    v_fma_f32 v37, v37, v29, v28
    v_cvt_pk_bf16_f32 v87, v36, v37
    ds_write_b128 v14, v[84:87] offset:51712
    v_lshlrev_b32 v36, 16, v88
    v_and_b32 v37, 0xffff0000, v88
    v_fma_f32 v36, v36, v31, v30
    v_fma_f32 v37, v37, v31, v30
    v_cvt_pk_bf16_f32 v88, v36, v37
    v_mfma_f32_32x32x16_bf16 v[224:239], v[132:135], v[152:155], v[224:239]
    v_lshlrev_b32 v36, 16, v89
    v_and_b32 v37, 0xffff0000, v89
    v_fma_f32 v36, v36, v31, v30
    v_fma_f32 v37, v37, v31, v30
    v_cvt_pk_bf16_f32 v89, v36, v37
    v_lshlrev_b32 v36, 16, v90
    v_and_b32 v37, 0xffff0000, v90
    v_fma_f32 v36, v36, v31, v30
    v_mfma_f32_32x32x16_bf16 v[240:255], v[132:135], v[156:159], v[240:255]
    v_fma_f32 v37, v37, v31, v30
    v_cvt_pk_bf16_f32 v90, v36, v37
    v_lshlrev_b32 v36, 16, v91
    v_and_b32 v37, 0xffff0000, v91
    v_fma_f32 v36, v36, v31, v30
    v_fma_f32 v37, v37, v31, v30
    v_cvt_pk_bf16_f32 v91, v36, v37
    ds_write_b128 v14, v[88:91] offset:56320
    s_waitcnt lgkmcnt(2)
    v_mfma_f32_32x32x16_bf16 v[160:175], v[136:139], v[120:123], v[160:175]
    ds_read_b128 v[128:131], v22 offset:96
    ds_read_b128 v[132:135], v22 offset:4704
    ds_read_b64_tr_b16 v[148:149], v23 offset:21504
    ds_read_b64_tr_b16 v[150:151], v23 offset:23296
    ds_read_b64_tr_b16 v[152:153], v23 offset:21632
    ds_read_b64_tr_b16 v[154:155], v23 offset:23424
    v_mfma_f32_32x32x16_bf16 v[176:191], v[120:123], v[140:143], v[176:191]
    ds_read_b64_tr_b16 v[156:157], v23 offset:21760
    ds_read_b64_tr_b16 v[158:159], v23 offset:23552
    v_lshlrev_b32 v36, 16, v92
    v_and_b32 v37, 0xffff0000, v92
    v_fma_f32 v36, v36, v33, v32
    v_fma_f32 v37, v37, v33, v32
    v_mfma_f32_32x32x16_bf16 v[192:207], v[120:123], v[144:147], v[192:207]
    v_cvt_pk_bf16_f32 v92, v36, v37
    v_lshlrev_b32 v36, 16, v93
    v_and_b32 v37, 0xffff0000, v93
    v_fma_f32 v36, v36, v33, v32
    v_fma_f32 v37, v37, v33, v32
    v_cvt_pk_bf16_f32 v93, v36, v37
    v_mfma_f32_32x32x16_bf16 v[208:223], v[136:139], v[124:127], v[208:223]
    v_lshlrev_b32 v36, 16, v94
    v_and_b32 v37, 0xffff0000, v94
    v_fma_f32 v36, v36, v33, v32
    v_fma_f32 v37, v37, v33, v32
    v_cvt_pk_bf16_f32 v94, v36, v37
    v_lshlrev_b32 v36, 16, v95
    v_mfma_f32_32x32x16_bf16 v[224:239], v[124:127], v[140:143], v[224:239]
    v_and_b32 v37, 0xffff0000, v95
    v_fma_f32 v36, v36, v33, v32
    v_fma_f32 v37, v37, v33, v32
    v_cvt_pk_bf16_f32 v95, v36, v37
    ds_write_b128 v14, v[92:95] offset:60928
    ds_write_b128 v15, v[96:99] offset:47104
    v_mfma_f32_32x32x16_bf16 v[240:255], v[124:127], v[144:147], v[240:255]
    ds_write_b128 v15, v[100:103] offset:47232
    ds_write_b128 v15, v[104:107] offset:47360
    ds_write_b128 v15, v[108:111] offset:61440
    ds_write_b128 v15, v[112:115] offset:61568
    ds_write_b128 v15, v[116:119] offset:61696
    s_waitcnt lgkmcnt(0)
    s_barrier
    s_waitcnt lgkmcnt(7)
    v_mfma_f32_32x32x16_bf16 v[160:175], v[148:151], v[128:131], v[160:175]
    ds_read_b128 v[120:123], v24 offset:0
    ds_read_b128 v[124:127], v24 offset:4608
    v_mfma_f32_32x32x16_bf16 v[176:191], v[128:131], v[152:155], v[176:191]
    ds_read_b64_tr_b16 v[136:137], v25 offset:0
    ds_read_b64_tr_b16 v[138:139], v25 offset:1792
    v_mfma_f32_32x32x16_bf16 v[192:207], v[128:131], v[156:159], v[192:207]
    ds_read_b64_tr_b16 v[140:141], v25 offset:128
    v_mfma_f32_32x32x16_bf16 v[208:223], v[148:151], v[132:135], v[208:223]
    ds_read_b64_tr_b16 v[142:143], v25 offset:1920
    v_mfma_f32_32x32x16_bf16 v[224:239], v[132:135], v[152:155], v[224:239]
    ds_read_b64_tr_b16 v[144:145], v25 offset:256
    v_mfma_f32_32x32x16_bf16 v[240:255], v[132:135], v[156:159], v[240:255]
    ds_read_b64_tr_b16 v[146:147], v25 offset:2048
    s_waitcnt lgkmcnt(0)
    v_mfma_f32_32x32x16_bf16 v[160:175], v[136:139], v[120:123], v[160:175]
    ds_read_b128 v[128:131], v24 offset:32
    ds_read_b128 v[132:135], v24 offset:4640
    ds_read_b64_tr_b16 v[148:149], v25 offset:7168
    ds_read_b64_tr_b16 v[150:151], v25 offset:8960
    ds_read_b64_tr_b16 v[152:153], v25 offset:7296
    ds_read_b64_tr_b16 v[154:155], v25 offset:9088
    ds_read_b64_tr_b16 v[156:157], v25 offset:7424
    ds_read_b64_tr_b16 v[158:159], v25 offset:9216
    v_mfma_f32_32x32x16_bf16 v[176:191], v[120:123], v[140:143], v[176:191]
    global_load_dwordx4 v[80:83], v4, s[4:5]
    global_load_dwordx4 v[84:87], v5, s[4:5]
    global_load_dwordx4 v[88:91], v6, s[4:5]
    global_load_dwordx4 v[92:95], v7, s[4:5]
    global_load_dwordx4 v[96:99], v8, s[6:7]
    global_load_dwordx4 v[100:103], v9, s[6:7]
    global_load_dwordx4 v[104:107], v10, s[6:7]
    global_load_dwordx4 v[108:111], v11, s[6:7]
    v_mfma_f32_32x32x16_bf16 v[192:207], v[120:123], v[144:147], v[192:207]
    global_load_dwordx4 v[112:115], v12, s[6:7]
    global_load_dwordx4 v[116:119], v13, s[6:7]
    s_add_u32 s4, s4, 128
    s_addc_u32 s5, s5, 0
    s_add_u32 s6, s6, 393216
    s_addc_u32 s7, s7, 0
    s_waitcnt vmcnt(10)
    v_mfma_f32_32x32x16_bf16 v[208:223], v[136:139], v[124:127], v[208:223]
    v_lshlrev_b32 v36, 16, v40
    v_and_b32 v37, 0xffff0000, v40
    v_fma_f32 v36, v36, v27, v26
    v_fma_f32 v37, v37, v27, v26
    v_cvt_pk_bf16_f32 v40, v36, v37
    v_lshlrev_b32 v36, 16, v41
    v_and_b32 v37, 0xffff0000, v41
    v_mfma_f32_32x32x16_bf16 v[224:239], v[124:127], v[140:143], v[224:239]
    v_fma_f32 v36, v36, v27, v26
    v_fma_f32 v37, v37, v27, v26
    v_cvt_pk_bf16_f32 v41, v36, v37
    v_lshlrev_b32 v36, 16, v42
    v_and_b32 v37, 0xffff0000, v42
    v_fma_f32 v36, v36, v27, v26
    v_fma_f32 v37, v37, v27, v26
    v_mfma_f32_32x32x16_bf16 v[240:255], v[124:127], v[144:147], v[240:255]
    v_cvt_pk_bf16_f32 v42, v36, v37
    v_lshlrev_b32 v36, 16, v43
    v_and_b32 v37, 0xffff0000, v43
    v_fma_f32 v36, v36, v27, v26
    v_fma_f32 v37, v37, v27, v26
    v_cvt_pk_bf16_f32 v43, v36, v37
    ds_write_b128 v14, v[40:43] offset:0
    s_waitcnt lgkmcnt(1)
    v_mfma_f32_32x32x16_bf16 v[160:175], v[148:151], v[128:131], v[160:175]
    ds_read_b128 v[120:123], v24 offset:64
    ds_read_b128 v[124:127], v24 offset:4672
    ds_read_b64_tr_b16 v[136:137], v25 offset:14336
    ds_read_b64_tr_b16 v[138:139], v25 offset:16128
    ds_read_b64_tr_b16 v[140:141], v25 offset:14464
    ds_read_b64_tr_b16 v[142:143], v25 offset:16256
    ds_read_b64_tr_b16 v[144:145], v25 offset:14592
    ds_read_b64_tr_b16 v[146:147], v25 offset:16384
    v_lshlrev_b32 v36, 16, v44
    v_mfma_f32_32x32x16_bf16 v[176:191], v[128:131], v[152:155], v[176:191]
    v_and_b32 v37, 0xffff0000, v44
    v_fma_f32 v36, v36, v29, v28
    v_fma_f32 v37, v37, v29, v28
    v_cvt_pk_bf16_f32 v44, v36, v37
    v_lshlrev_b32 v36, 16, v45
    v_and_b32 v37, 0xffff0000, v45
    v_fma_f32 v36, v36, v29, v28
    v_fma_f32 v37, v37, v29, v28
    v_cvt_pk_bf16_f32 v45, v36, v37
    v_mfma_f32_32x32x16_bf16 v[192:207], v[128:131], v[156:159], v[192:207]
    v_lshlrev_b32 v36, 16, v46
    v_and_b32 v37, 0xffff0000, v46
    v_fma_f32 v36, v36, v29, v28
    v_fma_f32 v37, v37, v29, v28
    v_cvt_pk_bf16_f32 v46, v36, v37
    v_lshlrev_b32 v36, 16, v47
    v_and_b32 v37, 0xffff0000, v47
    v_fma_f32 v36, v36, v29, v28
    v_mfma_f32_32x32x16_bf16 v[208:223], v[148:151], v[132:135], v[208:223]
    v_fma_f32 v37, v37, v29, v28
    v_cvt_pk_bf16_f32 v47, v36, v37
    ds_write_b128 v14, v[44:47] offset:4608
    v_lshlrev_b32 v36, 16, v48
    v_and_b32 v37, 0xffff0000, v48
    v_fma_f32 v36, v36, v31, v30
    v_fma_f32 v37, v37, v31, v30
    v_cvt_pk_bf16_f32 v48, v36, v37
    v_mfma_f32_32x32x16_bf16 v[224:239], v[132:135], v[152:155], v[224:239]
    v_lshlrev_b32 v36, 16, v49
    v_and_b32 v37, 0xffff0000, v49
    v_fma_f32 v36, v36, v31, v30
    v_fma_f32 v37, v37, v31, v30
    v_cvt_pk_bf16_f32 v49, v36, v37
    v_lshlrev_b32 v36, 16, v50
    v_and_b32 v37, 0xffff0000, v50
    v_fma_f32 v36, v36, v31, v30
    v_mfma_f32_32x32x16_bf16 v[240:255], v[132:135], v[156:159], v[240:255]
    v_fma_f32 v37, v37, v31, v30
    v_cvt_pk_bf16_f32 v50, v36, v37
    v_lshlrev_b32 v36, 16, v51
    v_and_b32 v37, 0xffff0000, v51
    v_fma_f32 v36, v36, v31, v30
    v_fma_f32 v37, v37, v31, v30
    v_cvt_pk_bf16_f32 v51, v36, v37
    ds_write_b128 v14, v[48:51] offset:9216
    s_waitcnt lgkmcnt(2)
    v_mfma_f32_32x32x16_bf16 v[160:175], v[136:139], v[120:123], v[160:175]
    ds_read_b128 v[128:131], v24 offset:96
    ds_read_b128 v[132:135], v24 offset:4704
    ds_read_b64_tr_b16 v[148:149], v25 offset:21504
    ds_read_b64_tr_b16 v[150:151], v25 offset:23296
    ds_read_b64_tr_b16 v[152:153], v25 offset:21632
    ds_read_b64_tr_b16 v[154:155], v25 offset:23424
    v_mfma_f32_32x32x16_bf16 v[176:191], v[120:123], v[140:143], v[176:191]
    ds_read_b64_tr_b16 v[156:157], v25 offset:21760
    ds_read_b64_tr_b16 v[158:159], v25 offset:23552
    v_lshlrev_b32 v36, 16, v52
    v_and_b32 v37, 0xffff0000, v52
    v_fma_f32 v36, v36, v33, v32
    v_fma_f32 v37, v37, v33, v32
    v_mfma_f32_32x32x16_bf16 v[192:207], v[120:123], v[144:147], v[192:207]
    v_cvt_pk_bf16_f32 v52, v36, v37
    v_lshlrev_b32 v36, 16, v53
    v_and_b32 v37, 0xffff0000, v53
    v_fma_f32 v36, v36, v33, v32
    v_fma_f32 v37, v37, v33, v32
    v_cvt_pk_bf16_f32 v53, v36, v37
    v_mfma_f32_32x32x16_bf16 v[208:223], v[136:139], v[124:127], v[208:223]
    v_lshlrev_b32 v36, 16, v54
    v_and_b32 v37, 0xffff0000, v54
    v_fma_f32 v36, v36, v33, v32
    v_fma_f32 v37, v37, v33, v32
    v_cvt_pk_bf16_f32 v54, v36, v37
    v_lshlrev_b32 v36, 16, v55
    v_mfma_f32_32x32x16_bf16 v[224:239], v[124:127], v[140:143], v[224:239]
    v_and_b32 v37, 0xffff0000, v55
    v_fma_f32 v36, v36, v33, v32
    v_fma_f32 v37, v37, v33, v32
    v_cvt_pk_bf16_f32 v55, v36, v37
    ds_write_b128 v14, v[52:55] offset:13824
    ds_write_b128 v15, v[56:59] offset:0
    v_mfma_f32_32x32x16_bf16 v[240:255], v[124:127], v[144:147], v[240:255]
    ds_write_b128 v15, v[60:63] offset:128
    ds_write_b128 v15, v[64:67] offset:256
    ds_write_b128 v15, v[68:71] offset:14336
    ds_write_b128 v15, v[72:75] offset:14464
    ds_write_b128 v15, v[76:79] offset:14592
    s_waitcnt lgkmcnt(0)
    s_barrier
    s_waitcnt lgkmcnt(7)
    v_mfma_f32_32x32x16_bf16 v[160:175], v[148:151], v[128:131], v[160:175]
    ds_read_b128 v[120:123], v22 offset:0
    ds_read_b128 v[124:127], v22 offset:4608
    v_mfma_f32_32x32x16_bf16 v[176:191], v[128:131], v[152:155], v[176:191]
    ds_read_b64_tr_b16 v[136:137], v23 offset:0
    ds_read_b64_tr_b16 v[138:139], v23 offset:1792
    v_mfma_f32_32x32x16_bf16 v[192:207], v[128:131], v[156:159], v[192:207]
    ds_read_b64_tr_b16 v[140:141], v23 offset:128
    v_mfma_f32_32x32x16_bf16 v[208:223], v[148:151], v[132:135], v[208:223]
    ds_read_b64_tr_b16 v[142:143], v23 offset:1920
    v_mfma_f32_32x32x16_bf16 v[224:239], v[132:135], v[152:155], v[224:239]
    ds_read_b64_tr_b16 v[144:145], v23 offset:256
    v_mfma_f32_32x32x16_bf16 v[240:255], v[132:135], v[156:159], v[240:255]
    ds_read_b64_tr_b16 v[146:147], v23 offset:2048
    s_add_u32 s20, s20, 2
    s_cmp_lt_u32 s20, 14
    s_cbranch_scc1 L_qkv2_loop
    s_waitcnt lgkmcnt(0)
    v_mfma_f32_32x32x16_bf16 v[160:175], v[136:139], v[120:123], v[160:175]
    ds_read_b128 v[128:131], v22 offset:32
    ds_read_b128 v[132:135], v22 offset:4640
    ds_read_b64_tr_b16 v[148:149], v23 offset:7168
    ds_read_b64_tr_b16 v[150:151], v23 offset:8960
    ds_read_b64_tr_b16 v[152:153], v23 offset:7296
    v_mfma_f32_32x32x16_bf16 v[176:191], v[120:123], v[140:143], v[176:191]
    ds_read_b64_tr_b16 v[154:155], v23 offset:9088
    ds_read_b64_tr_b16 v[156:157], v23 offset:7424
    ds_read_b64_tr_b16 v[158:159], v23 offset:9216
    s_waitcnt vmcnt(0)
    v_lshlrev_b32 v36, 16, v80
    v_mfma_f32_32x32x16_bf16 v[192:207], v[120:123], v[144:147], v[192:207]
    v_and_b32 v37, 0xffff0000, v80
    v_fma_f32 v36, v36, v27, v26
    v_fma_f32 v37, v37, v27, v26
    v_cvt_pk_bf16_f32 v80, v36, v37
    v_lshlrev_b32 v36, 16, v81
    v_mfma_f32_32x32x16_bf16 v[208:223], v[136:139], v[124:127], v[208:223]
    v_and_b32 v37, 0xffff0000, v81
    v_fma_f32 v36, v36, v27, v26
    v_fma_f32 v37, v37, v27, v26
    v_cvt_pk_bf16_f32 v81, v36, v37
    v_lshlrev_b32 v36, 16, v82
    v_mfma_f32_32x32x16_bf16 v[224:239], v[124:127], v[140:143], v[224:239]
    v_and_b32 v37, 0xffff0000, v82
    v_fma_f32 v36, v36, v27, v26
    v_fma_f32 v37, v37, v27, v26
    v_cvt_pk_bf16_f32 v82, v36, v37
    v_lshlrev_b32 v36, 16, v83
    v_mfma_f32_32x32x16_bf16 v[240:255], v[124:127], v[144:147], v[240:255]
    v_and_b32 v37, 0xffff0000, v83
    v_fma_f32 v36, v36, v27, v26
    v_fma_f32 v37, v37, v27, v26
    v_cvt_pk_bf16_f32 v83, v36, v37
    ds_write_b128 v14, v[80:83] offset:47104
    s_waitcnt lgkmcnt(1)
    v_mfma_f32_32x32x16_bf16 v[160:175], v[148:151], v[128:131], v[160:175]
    ds_read_b128 v[120:123], v22 offset:64
    ds_read_b128 v[124:127], v22 offset:4672
    ds_read_b64_tr_b16 v[136:137], v23 offset:14336
    ds_read_b64_tr_b16 v[138:139], v23 offset:16128
    ds_read_b64_tr_b16 v[140:141], v23 offset:14464
    ds_read_b64_tr_b16 v[142:143], v23 offset:16256
    ds_read_b64_tr_b16 v[144:145], v23 offset:14592
    ds_read_b64_tr_b16 v[146:147], v23 offset:16384
    v_lshlrev_b32 v36, 16, v84
    v_mfma_f32_32x32x16_bf16 v[176:191], v[128:131], v[152:155], v[176:191]
    v_and_b32 v37, 0xffff0000, v84
    v_fma_f32 v36, v36, v29, v28
    v_fma_f32 v37, v37, v29, v28
    v_cvt_pk_bf16_f32 v84, v36, v37
    v_lshlrev_b32 v36, 16, v85
    v_and_b32 v37, 0xffff0000, v85
    v_fma_f32 v36, v36, v29, v28
    v_fma_f32 v37, v37, v29, v28
    v_cvt_pk_bf16_f32 v85, v36, v37
    v_mfma_f32_32x32x16_bf16 v[192:207], v[128:131], v[156:159], v[192:207]
    v_lshlrev_b32 v36, 16, v86
    v_and_b32 v37, 0xffff0000, v86
    v_fma_f32 v36, v36, v29, v28
    v_fma_f32 v37, v37, v29, v28
    v_cvt_pk_bf16_f32 v86, v36, v37
    v_lshlrev_b32 v36, 16, v87
    v_and_b32 v37, 0xffff0000, v87
    v_fma_f32 v36, v36, v29, v28
    v_mfma_f32_32x32x16_bf16 v[208:223], v[148:151], v[132:135], v[208:223]
    v_fma_f32 v37, v37, v29, v28
    v_cvt_pk_bf16_f32 v87, v36, v37
    ds_write_b128 v14, v[84:87] offset:51712
    v_lshlrev_b32 v36, 16, v88
    v_and_b32 v37, 0xffff0000, v88
    v_fma_f32 v36, v36, v31, v30
    v_fma_f32 v37, v37, v31, v30
    v_cvt_pk_bf16_f32 v88, v36, v37
    v_mfma_f32_32x32x16_bf16 v[224:239], v[132:135], v[152:155], v[224:239]
    v_lshlrev_b32 v36, 16, v89
    v_and_b32 v37, 0xffff0000, v89
    v_fma_f32 v36, v36, v31, v30
    v_fma_f32 v37, v37, v31, v30
    v_cvt_pk_bf16_f32 v89, v36, v37
    v_lshlrev_b32 v36, 16, v90
    v_and_b32 v37, 0xffff0000, v90
    v_fma_f32 v36, v36, v31, v30
    v_mfma_f32_32x32x16_bf16 v[240:255], v[132:135], v[156:159], v[240:255]
    v_fma_f32 v37, v37, v31, v30
    v_cvt_pk_bf16_f32 v90, v36, v37
    v_lshlrev_b32 v36, 16, v91
    v_and_b32 v37, 0xffff0000, v91
    v_fma_f32 v36, v36, v31, v30
    v_fma_f32 v37, v37, v31, v30
    v_cvt_pk_bf16_f32 v91, v36, v37
    ds_write_b128 v14, v[88:91] offset:56320
    s_waitcnt lgkmcnt(2)
    v_mfma_f32_32x32x16_bf16 v[160:175], v[136:139], v[120:123], v[160:175]
    ds_read_b128 v[128:131], v22 offset:96
    ds_read_b128 v[132:135], v22 offset:4704
    ds_read_b64_tr_b16 v[148:149], v23 offset:21504
    ds_read_b64_tr_b16 v[150:151], v23 offset:23296
    ds_read_b64_tr_b16 v[152:153], v23 offset:21632
    ds_read_b64_tr_b16 v[154:155], v23 offset:23424
    v_mfma_f32_32x32x16_bf16 v[176:191], v[120:123], v[140:143], v[176:191]
    ds_read_b64_tr_b16 v[156:157], v23 offset:21760
    ds_read_b64_tr_b16 v[158:159], v23 offset:23552
    v_lshlrev_b32 v36, 16, v92
    v_and_b32 v37, 0xffff0000, v92
    v_fma_f32 v36, v36, v33, v32
    v_fma_f32 v37, v37, v33, v32
    v_mfma_f32_32x32x16_bf16 v[192:207], v[120:123], v[144:147], v[192:207]
    v_cvt_pk_bf16_f32 v92, v36, v37
    v_lshlrev_b32 v36, 16, v93
    v_and_b32 v37, 0xffff0000, v93
    v_fma_f32 v36, v36, v33, v32
    v_fma_f32 v37, v37, v33, v32
    v_cvt_pk_bf16_f32 v93, v36, v37
    v_mfma_f32_32x32x16_bf16 v[208:223], v[136:139], v[124:127], v[208:223]
    v_lshlrev_b32 v36, 16, v94
    v_and_b32 v37, 0xffff0000, v94
    v_fma_f32 v36, v36, v33, v32
    v_fma_f32 v37, v37, v33, v32
    v_cvt_pk_bf16_f32 v94, v36, v37
    v_lshlrev_b32 v36, 16, v95
    v_mfma_f32_32x32x16_bf16 v[224:239], v[124:127], v[140:143], v[224:239]
    v_and_b32 v37, 0xffff0000, v95
    v_fma_f32 v36, v36, v33, v32
    v_fma_f32 v37, v37, v33, v32
    v_cvt_pk_bf16_f32 v95, v36, v37
    ds_write_b128 v14, v[92:95] offset:60928
    ds_write_b128 v15, v[96:99] offset:47104
    v_mfma_f32_32x32x16_bf16 v[240:255], v[124:127], v[144:147], v[240:255]
    ds_write_b128 v15, v[100:103] offset:47232
    ds_write_b128 v15, v[104:107] offset:47360
    ds_write_b128 v15, v[108:111] offset:61440
    ds_write_b128 v15, v[112:115] offset:61568
    ds_write_b128 v15, v[116:119] offset:61696
    s_waitcnt lgkmcnt(0)
    s_barrier
    s_waitcnt lgkmcnt(7)
    v_mfma_f32_32x32x16_bf16 v[160:175], v[148:151], v[128:131], v[160:175]
    ds_read_b128 v[120:123], v24 offset:0
    ds_read_b128 v[124:127], v24 offset:4608
    v_mfma_f32_32x32x16_bf16 v[176:191], v[128:131], v[152:155], v[176:191]
    ds_read_b64_tr_b16 v[136:137], v25 offset:0
    ds_read_b64_tr_b16 v[138:139], v25 offset:1792
    v_mfma_f32_32x32x16_bf16 v[192:207], v[128:131], v[156:159], v[192:207]
    ds_read_b64_tr_b16 v[140:141], v25 offset:128
    v_mfma_f32_32x32x16_bf16 v[208:223], v[148:151], v[132:135], v[208:223]
    ds_read_b64_tr_b16 v[142:143], v25 offset:1920
    v_mfma_f32_32x32x16_bf16 v[224:239], v[132:135], v[152:155], v[224:239]
    ds_read_b64_tr_b16 v[144:145], v25 offset:256
    v_mfma_f32_32x32x16_bf16 v[240:255], v[132:135], v[156:159], v[240:255]
    ds_read_b64_tr_b16 v[146:147], v25 offset:2048
    s_waitcnt lgkmcnt(0)
    v_mfma_f32_32x32x16_bf16 v[160:175], v[136:139], v[120:123], v[160:175]
    ds_read_b128 v[128:131], v24 offset:32
    ds_read_b128 v[132:135], v24 offset:4640
    v_mfma_f32_32x32x16_bf16 v[176:191], v[120:123], v[140:143], v[176:191]
    ds_read_b64_tr_b16 v[148:149], v25 offset:7168
    ds_read_b64_tr_b16 v[150:151], v25 offset:8960
    v_mfma_f32_32x32x16_bf16 v[192:207], v[120:123], v[144:147], v[192:207]
    ds_read_b64_tr_b16 v[152:153], v25 offset:7296
    v_mfma_f32_32x32x16_bf16 v[208:223], v[136:139], v[124:127], v[208:223]
    ds_read_b64_tr_b16 v[154:155], v25 offset:9088
    v_mfma_f32_32x32x16_bf16 v[224:239], v[124:127], v[140:143], v[224:239]
    ds_read_b64_tr_b16 v[156:157], v25 offset:7424
    v_mfma_f32_32x32x16_bf16 v[240:255], v[124:127], v[144:147], v[240:255]
    ds_read_b64_tr_b16 v[158:159], v25 offset:9216
    s_waitcnt lgkmcnt(0)
    v_mfma_f32_32x32x16_bf16 v[160:175], v[148:151], v[128:131], v[160:175]
    ds_read_b128 v[120:123], v24 offset:64
    ds_read_b128 v[124:127], v24 offset:4672
    v_mfma_f32_32x32x16_bf16 v[176:191], v[128:131], v[152:155], v[176:191]
    ds_read_b64_tr_b16 v[136:137], v25 offset:14336
    ds_read_b64_tr_b16 v[138:139], v25 offset:16128
    v_mfma_f32_32x32x16_bf16 v[192:207], v[128:131], v[156:159], v[192:207]
    ds_read_b64_tr_b16 v[140:141], v25 offset:14464
    v_mfma_f32_32x32x16_bf16 v[208:223], v[148:151], v[132:135], v[208:223]
    ds_read_b64_tr_b16 v[142:143], v25 offset:16256
    v_mfma_f32_32x32x16_bf16 v[224:239], v[132:135], v[152:155], v[224:239]
    ds_read_b64_tr_b16 v[144:145], v25 offset:14592
    v_mfma_f32_32x32x16_bf16 v[240:255], v[132:135], v[156:159], v[240:255]
    ds_read_b64_tr_b16 v[146:147], v25 offset:16384
    s_waitcnt lgkmcnt(0)
    v_mfma_f32_32x32x16_bf16 v[160:175], v[136:139], v[120:123], v[160:175]
    ds_read_b128 v[128:131], v24 offset:96
    ds_read_b128 v[132:135], v24 offset:4704
    v_mfma_f32_32x32x16_bf16 v[176:191], v[120:123], v[140:143], v[176:191]
    ds_read_b64_tr_b16 v[148:149], v25 offset:21504
    ds_read_b64_tr_b16 v[150:151], v25 offset:23296
    v_mfma_f32_32x32x16_bf16 v[192:207], v[120:123], v[144:147], v[192:207]
    ds_read_b64_tr_b16 v[152:153], v25 offset:21632
    v_mfma_f32_32x32x16_bf16 v[208:223], v[136:139], v[124:127], v[208:223]
    ds_read_b64_tr_b16 v[154:155], v25 offset:23424
    v_mfma_f32_32x32x16_bf16 v[224:239], v[124:127], v[140:143], v[224:239]
    ds_read_b64_tr_b16 v[156:157], v25 offset:21760
    v_mfma_f32_32x32x16_bf16 v[240:255], v[124:127], v[144:147], v[240:255]
    ds_read_b64_tr_b16 v[158:159], v25 offset:23552
    s_waitcnt lgkmcnt(0)
    v_mfma_f32_32x32x16_bf16 v[160:175], v[148:151], v[128:131], v[160:175]
    v_mfma_f32_32x32x16_bf16 v[176:191], v[128:131], v[152:155], v[176:191]
    v_mfma_f32_32x32x16_bf16 v[192:207], v[128:131], v[156:159], v[192:207]
    v_mfma_f32_32x32x16_bf16 v[208:223], v[148:151], v[132:135], v[208:223]
    v_mfma_f32_32x32x16_bf16 v[224:239], v[132:135], v[152:155], v[224:239]
    v_mfma_f32_32x32x16_bf16 v[240:255], v[132:135], v[156:159], v[240:255]
    s_nop 15
    s_nop 7
    s_load_dwordx2 s[14:15], s[0:1], 64
    s_waitcnt lgkmcnt(0)
    s_add_u32 s14, s14, 0
    s_addc_u32 s15, s15, 0
    s_barrier
    s_lshl_b32 s12, s9, 1
    v_add_u32 v26, s12, v19
    v_lshl_add_u32 v27, v18, 6, s10
    v_mul_u32_u24 v24, 15360, v17
    v_mul_u32_u24 v22, 80, v20
    v_add_u32 v22, v22, v24
    v_lshl_add_u32 v22, v21, 3, v22
    v_mul_u32_u24 v23, 144, v20
    v_add_u32 v23, v23, v24
    v_lshl_add_u32 v23, v21, 4, v23
    v_lshrrev_b32 v25, 2, v16
    v_mul_u32_u24 v25, 80, v25
    v_and_b32 v30, 3, v16
    v_lshl_add_u32 v25, v30, 4, v25
    v_add_u32 v25, v25, v24
    v_lshrrev_b32 v31, 3, v16
    v_mul_u32_u24 v31, 144, v31
    v_and_b32 v30, 7, v16
    v_lshl_add_u32 v31, v30, 4, v31
    v_add_u32 v31, v31, v24
    v_mov_b32 v15, v31
    v_lshlrev_b32 v28, 11, v26
    v_add_u32 v28, v28, v27
    v_lshlrev_b32 v28, 6, v28
    v_lshl_add_u32 v28, v16, 4, v28
    v_lshrrev_b32 v29, 5, v27
    v_lshl_add_u32 v29, v26, 6, v29
    v_bfe_u32 v30, v16, 2, 1
    v_add_u32 v29, v29, v30
    v_lshrrev_b32 v30, 3, v16
    v_lshl_add_u32 v29, v29, 5, v30
    v_lshlrev_b32 v29, 6, v29
    v_and_b32 v30, 3, v16
    v_lshl_add_u32 v29, v30, 4, v29
    v_mov_b32 v100, 0
    v_mov_b32 v101, 0
    v_mov_b32 v102, 0
    v_mov_b32 v103, 0
    v_mov_b32 v104, 0
    v_mov_b32 v105, 0
    v_mov_b32 v106, 0
    v_mov_b32 v107, 0
    v_mov_b32 v108, 0
    v_mov_b32 v109, 0
    v_mov_b32 v110, 0
    v_mov_b32 v111, 0
    v_mov_b32 v112, 0
    v_mov_b32 v113, 0
    v_mov_b32 v114, 0
    v_mov_b32 v115, 0
    v_mov_b32 v99, 0
    v_mul_f32 v30, 0x3fb8aa3b, v160
    v_exp_f32 v30, v30
    v_add_f32 v31, 1.0, v160
    v_cmp_lt_f32 vcc, 0, v160
    s_nop 1
    v_cndmask_b32 v30, v30, v31, vcc
    v_add_f32 v160, 0x358637bd, v30
    v_mul_f32 v30, 0x3fb8aa3b, v161
    v_exp_f32 v30, v30
    v_add_f32 v31, 1.0, v161
    v_cmp_lt_f32 vcc, 0, v161
    s_nop 1
    v_cndmask_b32 v30, v30, v31, vcc
    v_add_f32 v161, 0x358637bd, v30
    v_mul_f32 v30, 0x3fb8aa3b, v162
    v_exp_f32 v30, v30
    v_add_f32 v31, 1.0, v162
    v_cmp_lt_f32 vcc, 0, v162
    s_nop 1
    v_cndmask_b32 v30, v30, v31, vcc
    v_add_f32 v162, 0x358637bd, v30
    v_mul_f32 v30, 0x3fb8aa3b, v163
    v_exp_f32 v30, v30
    v_add_f32 v31, 1.0, v163
    v_cmp_lt_f32 vcc, 0, v163
    s_nop 1
    v_cndmask_b32 v30, v30, v31, vcc
    v_add_f32 v163, 0x358637bd, v30
    v_mul_f32 v30, 0x3fb8aa3b, v164
    v_exp_f32 v30, v30
    v_add_f32 v31, 1.0, v164
    v_cmp_lt_f32 vcc, 0, v164
    s_nop 1
    v_cndmask_b32 v30, v30, v31, vcc
    v_add_f32 v164, 0x358637bd, v30
    v_mul_f32 v30, 0x3fb8aa3b, v165
    v_exp_f32 v30, v30
    v_add_f32 v31, 1.0, v165
    v_cmp_lt_f32 vcc, 0, v165
    s_nop 1
    v_cndmask_b32 v30, v30, v31, vcc
    v_add_f32 v165, 0x358637bd, v30
    v_mul_f32 v30, 0x3fb8aa3b, v166
    v_exp_f32 v30, v30
    v_add_f32 v31, 1.0, v166
    v_cmp_lt_f32 vcc, 0, v166
    s_nop 1
    v_cndmask_b32 v30, v30, v31, vcc
    v_add_f32 v166, 0x358637bd, v30
    v_mul_f32 v30, 0x3fb8aa3b, v167
    v_exp_f32 v30, v30
    v_add_f32 v31, 1.0, v167
    v_cmp_lt_f32 vcc, 0, v167
    s_nop 1
    v_cndmask_b32 v30, v30, v31, vcc
    v_add_f32 v167, 0x358637bd, v30
    v_mul_f32 v30, 0x3fb8aa3b, v168
    v_exp_f32 v30, v30
    v_add_f32 v31, 1.0, v168
    v_cmp_lt_f32 vcc, 0, v168
    s_nop 1
    v_cndmask_b32 v30, v30, v31, vcc
    v_add_f32 v168, 0x358637bd, v30
    v_mul_f32 v30, 0x3fb8aa3b, v169
    v_exp_f32 v30, v30
    v_add_f32 v31, 1.0, v169
    v_cmp_lt_f32 vcc, 0, v169
    s_nop 1
    v_cndmask_b32 v30, v30, v31, vcc
    v_add_f32 v169, 0x358637bd, v30
    v_mul_f32 v30, 0x3fb8aa3b, v170
    v_exp_f32 v30, v30
    v_add_f32 v31, 1.0, v170
    v_cmp_lt_f32 vcc, 0, v170
    s_nop 1
    v_cndmask_b32 v30, v30, v31, vcc
    v_add_f32 v170, 0x358637bd, v30
    v_mul_f32 v30, 0x3fb8aa3b, v171
    v_exp_f32 v30, v30
    v_add_f32 v31, 1.0, v171
    v_cmp_lt_f32 vcc, 0, v171
    s_nop 1
    v_cndmask_b32 v30, v30, v31, vcc
    v_add_f32 v171, 0x358637bd, v30
    v_mul_f32 v30, 0x3fb8aa3b, v172
    v_exp_f32 v30, v30
    v_add_f32 v31, 1.0, v172
    v_cmp_lt_f32 vcc, 0, v172
    s_nop 1
    v_cndmask_b32 v30, v30, v31, vcc
    v_add_f32 v172, 0x358637bd, v30
    v_mul_f32 v30, 0x3fb8aa3b, v173
    v_exp_f32 v30, v30
    v_add_f32 v31, 1.0, v173
    v_cmp_lt_f32 vcc, 0, v173
    s_nop 1
    v_cndmask_b32 v30, v30, v31, vcc
    v_add_f32 v173, 0x358637bd, v30
    v_mul_f32 v30, 0x3fb8aa3b, v174
    v_exp_f32 v30, v30
    v_add_f32 v31, 1.0, v174
    v_cmp_lt_f32 vcc, 0, v174
    s_nop 1
    v_cndmask_b32 v30, v30, v31, vcc
    v_add_f32 v174, 0x358637bd, v30
    v_mul_f32 v30, 0x3fb8aa3b, v175
    v_exp_f32 v30, v30
    v_add_f32 v31, 1.0, v175
    v_cmp_lt_f32 vcc, 0, v175
    s_nop 1
    v_cndmask_b32 v30, v30, v31, vcc
    v_add_f32 v175, 0x358637bd, v30
    v_cvt_pk_bf16_f32 v32, v160, v161
    v_cvt_pk_bf16_f32 v33, v162, v163
    v_cvt_pk_bf16_f32 v34, v164, v165
    v_cvt_pk_bf16_f32 v35, v166, v167
    v_cvt_pk_bf16_f32 v36, v168, v169
    v_cvt_pk_bf16_f32 v37, v170, v171
    v_cvt_pk_bf16_f32 v38, v172, v173
    v_cvt_pk_bf16_f32 v39, v174, v175
    ds_write_b64 v22, v[32:33] offset:0
    ds_write_b64 v22, v[34:35] offset:16
    ds_write_b64 v22, v[36:37] offset:32
    ds_write_b64 v22, v[38:39] offset:48
    v_mul_f32 v30, 0x3fb8aa3b, v208
    v_exp_f32 v30, v30
    v_add_f32 v31, 1.0, v208
    v_cmp_lt_f32 vcc, 0, v208
    s_nop 1
    v_cndmask_b32 v30, v30, v31, vcc
    v_add_f32 v208, 0x358637bd, v30
    v_mul_f32 v30, 0x3fb8aa3b, v209
    v_exp_f32 v30, v30
    v_add_f32 v31, 1.0, v209
    v_cmp_lt_f32 vcc, 0, v209
    s_nop 1
    v_cndmask_b32 v30, v30, v31, vcc
    v_add_f32 v209, 0x358637bd, v30
    v_mul_f32 v30, 0x3fb8aa3b, v210
    v_exp_f32 v30, v30
    v_add_f32 v31, 1.0, v210
    v_cmp_lt_f32 vcc, 0, v210
    s_nop 1
    v_cndmask_b32 v30, v30, v31, vcc
    v_add_f32 v210, 0x358637bd, v30
    v_mul_f32 v30, 0x3fb8aa3b, v211
    v_exp_f32 v30, v30
    v_add_f32 v31, 1.0, v211
    v_cmp_lt_f32 vcc, 0, v211
    s_nop 1
    v_cndmask_b32 v30, v30, v31, vcc
    v_add_f32 v211, 0x358637bd, v30
    v_mul_f32 v30, 0x3fb8aa3b, v212
    v_exp_f32 v30, v30
    v_add_f32 v31, 1.0, v212
    v_cmp_lt_f32 vcc, 0, v212
    s_nop 1
    v_cndmask_b32 v30, v30, v31, vcc
    v_add_f32 v212, 0x358637bd, v30
    v_mul_f32 v30, 0x3fb8aa3b, v213
    v_exp_f32 v30, v30
    v_add_f32 v31, 1.0, v213
    v_cmp_lt_f32 vcc, 0, v213
    s_nop 1
    v_cndmask_b32 v30, v30, v31, vcc
    v_add_f32 v213, 0x358637bd, v30
    v_mul_f32 v30, 0x3fb8aa3b, v214
    v_exp_f32 v30, v30
    v_add_f32 v31, 1.0, v214
    v_cmp_lt_f32 vcc, 0, v214
    s_nop 1
    v_cndmask_b32 v30, v30, v31, vcc
    v_add_f32 v214, 0x358637bd, v30
    v_mul_f32 v30, 0x3fb8aa3b, v215
    v_exp_f32 v30, v30
    v_add_f32 v31, 1.0, v215
    v_cmp_lt_f32 vcc, 0, v215
    s_nop 1
    v_cndmask_b32 v30, v30, v31, vcc
    v_add_f32 v215, 0x358637bd, v30
    v_mul_f32 v30, 0x3fb8aa3b, v216
    v_exp_f32 v30, v30
    v_add_f32 v31, 1.0, v216
    v_cmp_lt_f32 vcc, 0, v216
    s_nop 1
    v_cndmask_b32 v30, v30, v31, vcc
    v_add_f32 v216, 0x358637bd, v30
    v_mul_f32 v30, 0x3fb8aa3b, v217
    v_exp_f32 v30, v30
    v_add_f32 v31, 1.0, v217
    v_cmp_lt_f32 vcc, 0, v217
    s_nop 1
    v_cndmask_b32 v30, v30, v31, vcc
    v_add_f32 v217, 0x358637bd, v30
    v_mul_f32 v30, 0x3fb8aa3b, v218
    v_exp_f32 v30, v30
    v_add_f32 v31, 1.0, v218
    v_cmp_lt_f32 vcc, 0, v218
    s_nop 1
    v_cndmask_b32 v30, v30, v31, vcc
    v_add_f32 v218, 0x358637bd, v30
    v_mul_f32 v30, 0x3fb8aa3b, v219
    v_exp_f32 v30, v30
    v_add_f32 v31, 1.0, v219
    v_cmp_lt_f32 vcc, 0, v219
    s_nop 1
    v_cndmask_b32 v30, v30, v31, vcc
    v_add_f32 v219, 0x358637bd, v30
    v_mul_f32 v30, 0x3fb8aa3b, v220
    v_exp_f32 v30, v30
    v_add_f32 v31, 1.0, v220
    v_cmp_lt_f32 vcc, 0, v220
    s_nop 1
    v_cndmask_b32 v30, v30, v31, vcc
    v_add_f32 v220, 0x358637bd, v30
    v_mul_f32 v30, 0x3fb8aa3b, v221
    v_exp_f32 v30, v30
    v_add_f32 v31, 1.0, v221
    v_cmp_lt_f32 vcc, 0, v221
    s_nop 1
    v_cndmask_b32 v30, v30, v31, vcc
    v_add_f32 v221, 0x358637bd, v30
    v_mul_f32 v30, 0x3fb8aa3b, v222
    v_exp_f32 v30, v30
    v_add_f32 v31, 1.0, v222
    v_cmp_lt_f32 vcc, 0, v222
    s_nop 1
    v_cndmask_b32 v30, v30, v31, vcc
    v_add_f32 v222, 0x358637bd, v30
    v_mul_f32 v30, 0x3fb8aa3b, v223
    v_exp_f32 v30, v30
    v_add_f32 v31, 1.0, v223
    v_cmp_lt_f32 vcc, 0, v223
    s_nop 1
    v_cndmask_b32 v30, v30, v31, vcc
    v_add_f32 v223, 0x358637bd, v30
    v_cvt_pk_bf16_f32 v32, v208, v209
    v_cvt_pk_bf16_f32 v33, v210, v211
    v_cvt_pk_bf16_f32 v34, v212, v213
    v_cvt_pk_bf16_f32 v35, v214, v215
    v_cvt_pk_bf16_f32 v36, v216, v217
    v_cvt_pk_bf16_f32 v37, v218, v219
    v_cvt_pk_bf16_f32 v38, v220, v221
    v_cvt_pk_bf16_f32 v39, v222, v223
    ds_write_b64 v22, v[32:33] offset:2560
    ds_write_b64 v22, v[34:35] offset:2576
    ds_write_b64 v22, v[36:37] offset:2592
    ds_write_b64 v22, v[38:39] offset:2608
    v_mul_f32 v30, 0x3fb8aa3b, v176
    v_exp_f32 v30, v30
    v_add_f32 v31, 1.0, v176
    v_cmp_lt_f32 vcc, 0, v176
    s_nop 1
    v_cndmask_b32 v30, v30, v31, vcc
    v_add_f32 v176, 0x358637bd, v30
    v_mul_f32 v30, 0x3fb8aa3b, v177
    v_exp_f32 v30, v30
    v_add_f32 v31, 1.0, v177
    v_cmp_lt_f32 vcc, 0, v177
    s_nop 1
    v_cndmask_b32 v30, v30, v31, vcc
    v_add_f32 v177, 0x358637bd, v30
    v_mul_f32 v30, 0x3fb8aa3b, v178
    v_exp_f32 v30, v30
    v_add_f32 v31, 1.0, v178
    v_cmp_lt_f32 vcc, 0, v178
    s_nop 1
    v_cndmask_b32 v30, v30, v31, vcc
    v_add_f32 v178, 0x358637bd, v30
    v_mul_f32 v30, 0x3fb8aa3b, v179
    v_exp_f32 v30, v30
    v_add_f32 v31, 1.0, v179
    v_cmp_lt_f32 vcc, 0, v179
    s_nop 1
    v_cndmask_b32 v30, v30, v31, vcc
    v_add_f32 v179, 0x358637bd, v30
    v_mul_f32 v30, 0x3fb8aa3b, v180
    v_exp_f32 v30, v30
    v_add_f32 v31, 1.0, v180
    v_cmp_lt_f32 vcc, 0, v180
    s_nop 1
    v_cndmask_b32 v30, v30, v31, vcc
    v_add_f32 v180, 0x358637bd, v30
    v_mul_f32 v30, 0x3fb8aa3b, v181
    v_exp_f32 v30, v30
    v_add_f32 v31, 1.0, v181
    v_cmp_lt_f32 vcc, 0, v181
    s_nop 1
    v_cndmask_b32 v30, v30, v31, vcc
    v_add_f32 v181, 0x358637bd, v30
    v_mul_f32 v30, 0x3fb8aa3b, v182
    v_exp_f32 v30, v30
    v_add_f32 v31, 1.0, v182
    v_cmp_lt_f32 vcc, 0, v182
    s_nop 1
    v_cndmask_b32 v30, v30, v31, vcc
    v_add_f32 v182, 0x358637bd, v30
    v_mul_f32 v30, 0x3fb8aa3b, v183
    v_exp_f32 v30, v30
    v_add_f32 v31, 1.0, v183
    v_cmp_lt_f32 vcc, 0, v183
    s_nop 1
    v_cndmask_b32 v30, v30, v31, vcc
    v_add_f32 v183, 0x358637bd, v30
    v_mul_f32 v30, 0x3fb8aa3b, v184
    v_exp_f32 v30, v30
    v_add_f32 v31, 1.0, v184
    v_cmp_lt_f32 vcc, 0, v184
    s_nop 1
    v_cndmask_b32 v30, v30, v31, vcc
    v_add_f32 v184, 0x358637bd, v30
    v_mul_f32 v30, 0x3fb8aa3b, v185
    v_exp_f32 v30, v30
    v_add_f32 v31, 1.0, v185
    v_cmp_lt_f32 vcc, 0, v185
    s_nop 1
    v_cndmask_b32 v30, v30, v31, vcc
    v_add_f32 v185, 0x358637bd, v30
    v_mul_f32 v30, 0x3fb8aa3b, v186
    v_exp_f32 v30, v30
    v_add_f32 v31, 1.0, v186
    v_cmp_lt_f32 vcc, 0, v186
    s_nop 1
    v_cndmask_b32 v30, v30, v31, vcc
    v_add_f32 v186, 0x358637bd, v30
    v_mul_f32 v30, 0x3fb8aa3b, v187
    v_exp_f32 v30, v30
    v_add_f32 v31, 1.0, v187
    v_cmp_lt_f32 vcc, 0, v187
    s_nop 1
    v_cndmask_b32 v30, v30, v31, vcc
    v_add_f32 v187, 0x358637bd, v30
    v_mul_f32 v30, 0x3fb8aa3b, v188
    v_exp_f32 v30, v30
    v_add_f32 v31, 1.0, v188
    v_cmp_lt_f32 vcc, 0, v188
    s_nop 1
    v_cndmask_b32 v30, v30, v31, vcc
    v_add_f32 v188, 0x358637bd, v30
    v_mul_f32 v30, 0x3fb8aa3b, v189
    v_exp_f32 v30, v30
    v_add_f32 v31, 1.0, v189
    v_cmp_lt_f32 vcc, 0, v189
    s_nop 1
    v_cndmask_b32 v30, v30, v31, vcc
    v_add_f32 v189, 0x358637bd, v30
    v_mul_f32 v30, 0x3fb8aa3b, v190
    v_exp_f32 v30, v30
    v_add_f32 v31, 1.0, v190
    v_cmp_lt_f32 vcc, 0, v190
    s_nop 1
    v_cndmask_b32 v30, v30, v31, vcc
    v_add_f32 v190, 0x358637bd, v30
    v_mul_f32 v30, 0x3fb8aa3b, v191
    v_exp_f32 v30, v30
    v_add_f32 v31, 1.0, v191
    v_cmp_lt_f32 vcc, 0, v191
    s_nop 1
    v_cndmask_b32 v30, v30, v31, vcc
    v_add_f32 v191, 0x358637bd, v30
    v_cvt_pk_bf16_f32 v120, v176, v177
    v_cvt_pk_bf16_f32 v121, v178, v179
    v_cvt_pk_bf16_f32 v122, v180, v181
    v_cvt_pk_bf16_f32 v123, v182, v183
    v_cvt_pk_bf16_f32 v124, v184, v185
    v_cvt_pk_bf16_f32 v125, v186, v187
    v_cvt_pk_bf16_f32 v126, v188, v189
    v_cvt_pk_bf16_f32 v127, v190, v191
    v_lshlrev_b32 v30, 16, v120
    v_and_b32 v31, 0xffff0000, v120
    v_add_f32 v99, v99, v30
    v_add_f32 v99, v99, v31
    v_lshlrev_b32 v30, 16, v121
    v_and_b32 v31, 0xffff0000, v121
    v_add_f32 v99, v99, v30
    v_add_f32 v99, v99, v31
    v_lshlrev_b32 v30, 16, v122
    v_and_b32 v31, 0xffff0000, v122
    v_add_f32 v99, v99, v30
    v_add_f32 v99, v99, v31
    v_lshlrev_b32 v30, 16, v123
    v_and_b32 v31, 0xffff0000, v123
    v_add_f32 v99, v99, v30
    v_add_f32 v99, v99, v31
    v_lshlrev_b32 v30, 16, v124
    v_and_b32 v31, 0xffff0000, v124
    v_add_f32 v99, v99, v30
    v_add_f32 v99, v99, v31
    v_lshlrev_b32 v30, 16, v125
    v_and_b32 v31, 0xffff0000, v125
    v_add_f32 v99, v99, v30
    v_add_f32 v99, v99, v31
    v_lshlrev_b32 v30, 16, v126
    v_and_b32 v31, 0xffff0000, v126
    v_add_f32 v99, v99, v30
    v_add_f32 v99, v99, v31
    v_lshlrev_b32 v30, 16, v127
    v_and_b32 v31, 0xffff0000, v127
    v_add_f32 v99, v99, v30
    v_add_f32 v99, v99, v31
    v_mul_f32 v30, 0x3fb8aa3b, v224
    v_exp_f32 v30, v30
    v_add_f32 v31, 1.0, v224
    v_cmp_lt_f32 vcc, 0, v224
    s_nop 1
    v_cndmask_b32 v30, v30, v31, vcc
    v_add_f32 v224, 0x358637bd, v30
    v_mul_f32 v30, 0x3fb8aa3b, v225
    v_exp_f32 v30, v30
    v_add_f32 v31, 1.0, v225
    v_cmp_lt_f32 vcc, 0, v225
    s_nop 1
    v_cndmask_b32 v30, v30, v31, vcc
    v_add_f32 v225, 0x358637bd, v30
    v_mul_f32 v30, 0x3fb8aa3b, v226
    v_exp_f32 v30, v30
    v_add_f32 v31, 1.0, v226
    v_cmp_lt_f32 vcc, 0, v226
    s_nop 1
    v_cndmask_b32 v30, v30, v31, vcc
    v_add_f32 v226, 0x358637bd, v30
    v_mul_f32 v30, 0x3fb8aa3b, v227
    v_exp_f32 v30, v30
    v_add_f32 v31, 1.0, v227
    v_cmp_lt_f32 vcc, 0, v227
    s_nop 1
    v_cndmask_b32 v30, v30, v31, vcc
    v_add_f32 v227, 0x358637bd, v30
    v_mul_f32 v30, 0x3fb8aa3b, v228
    v_exp_f32 v30, v30
    v_add_f32 v31, 1.0, v228
    v_cmp_lt_f32 vcc, 0, v228
    s_nop 1
    v_cndmask_b32 v30, v30, v31, vcc
    v_add_f32 v228, 0x358637bd, v30
    v_mul_f32 v30, 0x3fb8aa3b, v229
    v_exp_f32 v30, v30
    v_add_f32 v31, 1.0, v229
    v_cmp_lt_f32 vcc, 0, v229
    s_nop 1
    v_cndmask_b32 v30, v30, v31, vcc
    v_add_f32 v229, 0x358637bd, v30
    v_mul_f32 v30, 0x3fb8aa3b, v230
    v_exp_f32 v30, v30
    v_add_f32 v31, 1.0, v230
    v_cmp_lt_f32 vcc, 0, v230
    s_nop 1
    v_cndmask_b32 v30, v30, v31, vcc
    v_add_f32 v230, 0x358637bd, v30
    v_mul_f32 v30, 0x3fb8aa3b, v231
    v_exp_f32 v30, v30
    v_add_f32 v31, 1.0, v231
    v_cmp_lt_f32 vcc, 0, v231
    s_nop 1
    v_cndmask_b32 v30, v30, v31, vcc
    v_add_f32 v231, 0x358637bd, v30
    v_mul_f32 v30, 0x3fb8aa3b, v232
    v_exp_f32 v30, v30
    v_add_f32 v31, 1.0, v232
    v_cmp_lt_f32 vcc, 0, v232
    s_nop 1
    v_cndmask_b32 v30, v30, v31, vcc
    v_add_f32 v232, 0x358637bd, v30
    v_mul_f32 v30, 0x3fb8aa3b, v233
    v_exp_f32 v30, v30
    v_add_f32 v31, 1.0, v233
    v_cmp_lt_f32 vcc, 0, v233
    s_nop 1
    v_cndmask_b32 v30, v30, v31, vcc
    v_add_f32 v233, 0x358637bd, v30
    v_mul_f32 v30, 0x3fb8aa3b, v234
    v_exp_f32 v30, v30
    v_add_f32 v31, 1.0, v234
    v_cmp_lt_f32 vcc, 0, v234
    s_nop 1
    v_cndmask_b32 v30, v30, v31, vcc
    v_add_f32 v234, 0x358637bd, v30
    v_mul_f32 v30, 0x3fb8aa3b, v235
    v_exp_f32 v30, v30
    v_add_f32 v31, 1.0, v235
    v_cmp_lt_f32 vcc, 0, v235
    s_nop 1
    v_cndmask_b32 v30, v30, v31, vcc
    v_add_f32 v235, 0x358637bd, v30
    v_mul_f32 v30, 0x3fb8aa3b, v236
    v_exp_f32 v30, v30
    v_add_f32 v31, 1.0, v236
    v_cmp_lt_f32 vcc, 0, v236
    s_nop 1
    v_cndmask_b32 v30, v30, v31, vcc
    v_add_f32 v236, 0x358637bd, v30
    v_mul_f32 v30, 0x3fb8aa3b, v237
    v_exp_f32 v30, v30
    v_add_f32 v31, 1.0, v237
    v_cmp_lt_f32 vcc, 0, v237
    s_nop 1
    v_cndmask_b32 v30, v30, v31, vcc
    v_add_f32 v237, 0x358637bd, v30
    v_mul_f32 v30, 0x3fb8aa3b, v238
    v_exp_f32 v30, v30
    v_add_f32 v31, 1.0, v238
    v_cmp_lt_f32 vcc, 0, v238
    s_nop 1
    v_cndmask_b32 v30, v30, v31, vcc
    v_add_f32 v238, 0x358637bd, v30
    v_mul_f32 v30, 0x3fb8aa3b, v239
    v_exp_f32 v30, v30
    v_add_f32 v31, 1.0, v239
    v_cmp_lt_f32 vcc, 0, v239
    s_nop 1
    v_cndmask_b32 v30, v30, v31, vcc
    v_add_f32 v239, 0x358637bd, v30
    v_cvt_pk_bf16_f32 v128, v224, v225
    v_cvt_pk_bf16_f32 v129, v226, v227
    v_cvt_pk_bf16_f32 v130, v228, v229
    v_cvt_pk_bf16_f32 v131, v230, v231
    v_cvt_pk_bf16_f32 v132, v232, v233
    v_cvt_pk_bf16_f32 v133, v234, v235
    v_cvt_pk_bf16_f32 v134, v236, v237
    v_cvt_pk_bf16_f32 v135, v238, v239
    v_lshlrev_b32 v30, 16, v128
    v_and_b32 v31, 0xffff0000, v128
    v_add_f32 v99, v99, v30
    v_add_f32 v99, v99, v31
    v_lshlrev_b32 v30, 16, v129
    v_and_b32 v31, 0xffff0000, v129
    v_add_f32 v99, v99, v30
    v_add_f32 v99, v99, v31
    v_lshlrev_b32 v30, 16, v130
    v_and_b32 v31, 0xffff0000, v130
    v_add_f32 v99, v99, v30
    v_add_f32 v99, v99, v31
    v_lshlrev_b32 v30, 16, v131
    v_and_b32 v31, 0xffff0000, v131
    v_add_f32 v99, v99, v30
    v_add_f32 v99, v99, v31
    v_lshlrev_b32 v30, 16, v132
    v_and_b32 v31, 0xffff0000, v132
    v_add_f32 v99, v99, v30
    v_add_f32 v99, v99, v31
    v_lshlrev_b32 v30, 16, v133
    v_and_b32 v31, 0xffff0000, v133
    v_add_f32 v99, v99, v30
    v_add_f32 v99, v99, v31
    v_lshlrev_b32 v30, 16, v134
    v_and_b32 v31, 0xffff0000, v134
    v_add_f32 v99, v99, v30
    v_add_f32 v99, v99, v31
    v_lshlrev_b32 v30, 16, v135
    v_and_b32 v31, 0xffff0000, v135
    v_add_f32 v99, v99, v30
    v_add_f32 v99, v99, v31
    v_cvt_pk_bf16_f32 v136, v192, v193
    v_cvt_pk_bf16_f32 v137, v194, v195
    v_cvt_pk_bf16_f32 v138, v196, v197
    v_cvt_pk_bf16_f32 v139, v198, v199
    v_cvt_pk_bf16_f32 v140, v200, v201
    v_cvt_pk_bf16_f32 v141, v202, v203
    v_cvt_pk_bf16_f32 v142, v204, v205
    v_cvt_pk_bf16_f32 v143, v206, v207
    v_cvt_pk_bf16_f32 v144, v240, v241
    v_cvt_pk_bf16_f32 v145, v242, v243
    v_cvt_pk_bf16_f32 v146, v244, v245
    v_cvt_pk_bf16_f32 v147, v246, v247
    v_cvt_pk_bf16_f32 v148, v248, v249
    v_cvt_pk_bf16_f32 v149, v250, v251
    v_cvt_pk_bf16_f32 v150, v252, v253
    v_cvt_pk_bf16_f32 v151, v254, v255
    s_nop 1
    v_mfma_f32_32x32x16_bf16 v[100:115], v[120:123], v[136:139], v[100:115]
    v_mfma_f32_32x32x16_bf16 v[100:115], v[124:127], v[140:143], v[100:115]
    v_mfma_f32_32x32x16_bf16 v[100:115], v[128:131], v[144:147], v[100:115]
    v_mfma_f32_32x32x16_bf16 v[100:115], v[132:135], v[148:151], v[100:115]
    s_lshl_b32 s13, s8, 1
    v_lshl_add_u32 v30, v26, 5, s13
    v_add_u32 v30, v30, v18
    v_lshlrev_b32 v31, 8, v30
    v_lshl_add_u32 v31, v16, 2, v31
    v_add_u32 v31, 16777216, v31
    global_store_dword v31, v99, s[14:15]
    v_lshlrev_b32 v30, 12, v30
    v_lshl_add_u32 v30, v16, 6, v30
    v_add_u32 v30, 12582912, v30
    s_waitcnt lgkmcnt(0)
    ds_read_b128 v[40:43], v25 offset:0
    ds_read_b128 v[44:47], v25 offset:1280
    ds_read_b128 v[48:51], v25 offset:2560
    ds_read_b128 v[52:55], v25 offset:3840
    s_nop 7
    s_nop 7
    global_store_dwordx4 v30, v[100:103], s[14:15] offset:0
    global_store_dwordx4 v30, v[104:107], s[14:15] offset:16
    global_store_dwordx4 v30, v[108:111], s[14:15] offset:32
    global_store_dwordx4 v30, v[112:115], s[14:15] offset:48
    s_waitcnt lgkmcnt(0)
    v_add_u32 v30, 8388608, v28
    global_store_dwordx4 v30, v[40:43], s[14:15]
    v_add_u32 v30, 8389632, v28
    global_store_dwordx4 v30, v[44:47], s[14:15]
    v_add_u32 v30, 8390656, v28
    global_store_dwordx4 v30, v[48:51], s[14:15]
    v_add_u32 v30, 8391680, v28
    global_store_dwordx4 v30, v[52:55], s[14:15]
L_qkv2_end:
    s_endpgm
.globl wo2_kernel
.p2align 8
.type wo2_kernel,@function
wo2_kernel:
    s_cmp_ge_u32 s2, 256
    s_cbranch_scc1 L_wo2_end
    s_load_dwordx2 s[4:5], s[0:1], 64
    s_load_dwordx2 s[6:7], s[0:1], 16
    s_load_dwordx2 s[14:15], s[0:1], 64
    s_waitcnt lgkmcnt(0)
    s_add_u32 s4, s4, 20971520
    s_addc_u32 s5, s5, 0
    s_add_u32 s14, s14, 4194304
    s_addc_u32 s15, s15, 0
    s_lshr_b32 s8, s2, 4
    s_and_b32 s9, s2, 15
    v_lshrrev_b32 v1, 3, v0
    v_and_b32 v2, 7, v0
    s_lshl_b32 s10, s8, 7
    v_add_u32 v3, s10, v1
    v_lshlrev_b32 v3, 11, v3
    v_lshl_add_u32 v3, v2, 4, v3
    v_add_u32 v4, 0, v3
    v_add_u32 v5, 65536, v3
    v_add_u32 v6, 131072, v3
    v_add_u32 v7, 196608, v3
    s_mov_b32 s11, 2048
    v_mul_lo_u32 v3, v1, s11
    v_lshl_add_u32 v3, v2, 4, v3
    s_lshl_b32 s12, s9, 7
    v_add_u32 v3, s12, v3
    v_add_u32 v8, 0, v3
    v_add_u32 v9, 65536, v3
    v_mul_u32_u24 v14, 144, v1
    v_lshl_add_u32 v14, v2, 4, v14
    v_mul_u32_u24 v15, 192, v1
    v_lshl_add_u32 v15, v2, 4, v15
    v_add_u32 v15, 18432, v15
    v_and_b32 v16, 63, v0
    v_lshrrev_b32 v17, 6, v0
    v_lshrrev_b32 v18, 1, v17
    v_and_b32 v19, 1, v17
    v_and_b32 v20, 31, v16
    v_lshrrev_b32 v21, 5, v16
    v_lshl_add_u32 v22, v18, 6, v20
    v_mul_u32_u24 v22, 144, v22
    v_lshl_add_u32 v22, v21, 4, v22
    v_bfe_u32 v23, v16, 2, 2
    v_lshl_add_u32 v23, v21, 3, v23
    v_mul_u32_u24 v23, 192, v23
    v_bfe_u32 v24, v16, 4, 1
    v_lshlrev_b32 v24, 5, v24
    v_lshl_add_u32 v24, v19, 6, v24
    v_and_b32 v25, 3, v16
    v_lshl_add_u32 v24, v25, 3, v24
    v_add_u32 v23, v23, v24
    v_add_u32 v23, 18432, v23
    v_add_u32 v24, 30720, v22
    v_add_u32 v25, 30720, v23
    v_mov_b32 v160, 0
    v_mov_b32 v161, 0
    v_mov_b32 v162, 0
    v_mov_b32 v163, 0
    v_mov_b32 v164, 0
    v_mov_b32 v165, 0
    v_mov_b32 v166, 0
    v_mov_b32 v167, 0
    v_mov_b32 v168, 0
    v_mov_b32 v169, 0
    v_mov_b32 v170, 0
    v_mov_b32 v171, 0
    v_mov_b32 v172, 0
    v_mov_b32 v173, 0
    v_mov_b32 v174, 0
    v_mov_b32 v175, 0
    v_mov_b32 v176, 0
    v_mov_b32 v177, 0
    v_mov_b32 v178, 0
    v_mov_b32 v179, 0
    v_mov_b32 v180, 0
    v_mov_b32 v181, 0
    v_mov_b32 v182, 0
    v_mov_b32 v183, 0
    v_mov_b32 v184, 0
    v_mov_b32 v185, 0
    v_mov_b32 v186, 0
    v_mov_b32 v187, 0
    v_mov_b32 v188, 0
    v_mov_b32 v189, 0
    v_mov_b32 v190, 0
    v_mov_b32 v191, 0
    global_load_dwordx4 v[40:43], v4, s[4:5]
    global_load_dwordx4 v[44:47], v5, s[4:5]
    global_load_dwordx4 v[48:51], v6, s[4:5]
    global_load_dwordx4 v[52:55], v7, s[4:5]
    global_load_dwordx4 v[56:59], v8, s[6:7]
    global_load_dwordx4 v[60:63], v9, s[6:7]
    s_add_u32 s4, s4, 128
    s_addc_u32 s5, s5, 0
    s_add_u32 s6, s6, 131072
    s_addc_u32 s7, s7, 0
    global_load_dwordx4 v[64:67], v4, s[4:5]
    global_load_dwordx4 v[68:71], v5, s[4:5]
    global_load_dwordx4 v[72:75], v6, s[4:5]
    global_load_dwordx4 v[76:79], v7, s[4:5]
    global_load_dwordx4 v[80:83], v8, s[6:7]
    global_load_dwordx4 v[84:87], v9, s[6:7]
    s_add_u32 s4, s4, 128
    s_addc_u32 s5, s5, 0
    s_add_u32 s6, s6, 131072
    s_addc_u32 s7, s7, 0
    global_load_dwordx4 v[88:91], v4, s[4:5]
    global_load_dwordx4 v[92:95], v5, s[4:5]
    global_load_dwordx4 v[96:99], v6, s[4:5]
    global_load_dwordx4 v[100:103], v7, s[4:5]
    global_load_dwordx4 v[104:107], v8, s[6:7]
    global_load_dwordx4 v[108:111], v9, s[6:7]
    s_add_u32 s4, s4, 128
    s_addc_u32 s5, s5, 0
    s_add_u32 s6, s6, 131072
    s_addc_u32 s7, s7, 0
    global_load_dwordx4 v[112:115], v4, s[4:5]
    global_load_dwordx4 v[116:119], v5, s[4:5]
    global_load_dwordx4 v[120:123], v6, s[4:5]
    global_load_dwordx4 v[124:127], v7, s[4:5]
    global_load_dwordx4 v[128:131], v8, s[6:7]
    global_load_dwordx4 v[132:135], v9, s[6:7]
    s_add_u32 s4, s4, 128
    s_addc_u32 s5, s5, 0
    s_add_u32 s6, s6, 131072
    s_addc_u32 s7, s7, 0
    s_waitcnt vmcnt(18)
    ds_write_b128 v14, v[40:43] offset:0
    ds_write_b128 v14, v[44:47] offset:4608
    ds_write_b128 v14, v[48:51] offset:9216
    ds_write_b128 v14, v[52:55] offset:13824
    ds_write_b128 v15, v[56:59] offset:0
    ds_write_b128 v15, v[60:63] offset:6144
    s_waitcnt lgkmcnt(0)
    s_barrier
    ds_read_b128 v[208:211], v22 offset:0
    ds_read_b128 v[212:215], v22 offset:4608
    ds_read_b64_tr_b16 v[192:193], v23 offset:0
    ds_read_b64_tr_b16 v[194:195], v23 offset:768
    ds_read_b128 v[216:219], v22 offset:32
    ds_read_b128 v[220:223], v22 offset:4640
    ds_read_b64_tr_b16 v[196:197], v23 offset:3072
    ds_read_b64_tr_b16 v[198:199], v23 offset:3840
    ds_read_b128 v[224:227], v22 offset:64
    ds_read_b128 v[228:231], v22 offset:4672
    ds_read_b64_tr_b16 v[200:201], v23 offset:6144
    ds_read_b64_tr_b16 v[202:203], v23 offset:6912
    ds_read_b128 v[232:235], v22 offset:96
    ds_read_b128 v[236:239], v22 offset:4704
    ds_read_b64_tr_b16 v[204:205], v23 offset:9216
    ds_read_b64_tr_b16 v[206:207], v23 offset:9984
    s_mov_b32 s20, 0
L_wo2_loop:
    s_waitcnt lgkmcnt(12)
    v_mfma_f32_32x32x16_bf16 v[160:175], v[192:195], v[208:211], v[160:175]
    global_load_dwordx4 v[40:43], v4, s[4:5]
    global_load_dwordx4 v[44:47], v5, s[4:5]
    global_load_dwordx4 v[48:51], v6, s[4:5]
    v_mfma_f32_32x32x16_bf16 v[176:191], v[192:195], v[212:215], v[176:191]
    global_load_dwordx4 v[52:55], v7, s[4:5]
    global_load_dwordx4 v[56:59], v8, s[6:7]
    s_waitcnt lgkmcnt(8)
    v_mfma_f32_32x32x16_bf16 v[160:175], v[196:199], v[216:219], v[160:175]
    global_load_dwordx4 v[60:63], v9, s[6:7]
    s_add_u32 s4, s4, 128
    v_mfma_f32_32x32x16_bf16 v[176:191], v[196:199], v[220:223], v[176:191]
    s_addc_u32 s5, s5, 0
    s_add_u32 s6, s6, 131072
    s_waitcnt lgkmcnt(4)
    v_mfma_f32_32x32x16_bf16 v[160:175], v[200:203], v[224:227], v[160:175]
    s_addc_u32 s7, s7, 0
    s_waitcnt vmcnt(18)
    v_mfma_f32_32x32x16_bf16 v[176:191], v[200:203], v[228:231], v[176:191]
    ds_write_b128 v14, v[64:67] offset:30720
    ds_write_b128 v14, v[68:71] offset:35328
    s_waitcnt lgkmcnt(2)
    v_mfma_f32_32x32x16_bf16 v[160:175], v[204:207], v[232:235], v[160:175]
    ds_write_b128 v14, v[72:75] offset:39936
    ds_write_b128 v14, v[76:79] offset:44544
    v_mfma_f32_32x32x16_bf16 v[176:191], v[204:207], v[236:239], v[176:191]
    ds_write_b128 v15, v[80:83] offset:30720
    ds_write_b128 v15, v[84:87] offset:36864
    s_waitcnt lgkmcnt(0)
    s_barrier
    ds_read_b128 v[208:211], v24 offset:0
    ds_read_b128 v[212:215], v24 offset:4608
    ds_read_b64_tr_b16 v[192:193], v25 offset:0
    ds_read_b64_tr_b16 v[194:195], v25 offset:768
    ds_read_b128 v[216:219], v24 offset:32
    ds_read_b128 v[220:223], v24 offset:4640
    ds_read_b64_tr_b16 v[196:197], v25 offset:3072
    ds_read_b64_tr_b16 v[198:199], v25 offset:3840
    ds_read_b128 v[224:227], v24 offset:64
    ds_read_b128 v[228:231], v24 offset:4672
    ds_read_b64_tr_b16 v[200:201], v25 offset:6144
    ds_read_b64_tr_b16 v[202:203], v25 offset:6912
    ds_read_b128 v[232:235], v24 offset:96
    ds_read_b128 v[236:239], v24 offset:4704
    ds_read_b64_tr_b16 v[204:205], v25 offset:9216
    ds_read_b64_tr_b16 v[206:207], v25 offset:9984
    s_waitcnt lgkmcnt(12)
    v_mfma_f32_32x32x16_bf16 v[160:175], v[192:195], v[208:211], v[160:175]
    global_load_dwordx4 v[64:67], v4, s[4:5]
    global_load_dwordx4 v[68:71], v5, s[4:5]
    global_load_dwordx4 v[72:75], v6, s[4:5]
    v_mfma_f32_32x32x16_bf16 v[176:191], v[192:195], v[212:215], v[176:191]
    global_load_dwordx4 v[76:79], v7, s[4:5]
    global_load_dwordx4 v[80:83], v8, s[6:7]
    s_waitcnt lgkmcnt(8)
    v_mfma_f32_32x32x16_bf16 v[160:175], v[196:199], v[216:219], v[160:175]
    global_load_dwordx4 v[84:87], v9, s[6:7]
    s_add_u32 s4, s4, 128
    v_mfma_f32_32x32x16_bf16 v[176:191], v[196:199], v[220:223], v[176:191]
    s_addc_u32 s5, s5, 0
    s_add_u32 s6, s6, 131072
    s_waitcnt lgkmcnt(4)
    v_mfma_f32_32x32x16_bf16 v[160:175], v[200:203], v[224:227], v[160:175]
    s_addc_u32 s7, s7, 0
    s_waitcnt vmcnt(18)
    v_mfma_f32_32x32x16_bf16 v[176:191], v[200:203], v[228:231], v[176:191]
    ds_write_b128 v14, v[88:91] offset:0
    ds_write_b128 v14, v[92:95] offset:4608
    s_waitcnt lgkmcnt(2)
    v_mfma_f32_32x32x16_bf16 v[160:175], v[204:207], v[232:235], v[160:175]
    ds_write_b128 v14, v[96:99] offset:9216
    ds_write_b128 v14, v[100:103] offset:13824
    v_mfma_f32_32x32x16_bf16 v[176:191], v[204:207], v[236:239], v[176:191]
    ds_write_b128 v15, v[104:107] offset:0
    ds_write_b128 v15, v[108:111] offset:6144
    s_waitcnt lgkmcnt(0)
    s_barrier
    ds_read_b128 v[208:211], v22 offset:0
    ds_read_b128 v[212:215], v22 offset:4608
    ds_read_b64_tr_b16 v[192:193], v23 offset:0
    ds_read_b64_tr_b16 v[194:195], v23 offset:768
    ds_read_b128 v[216:219], v22 offset:32
    ds_read_b128 v[220:223], v22 offset:4640
    ds_read_b64_tr_b16 v[196:197], v23 offset:3072
    ds_read_b64_tr_b16 v[198:199], v23 offset:3840
    ds_read_b128 v[224:227], v22 offset:64
    ds_read_b128 v[228:231], v22 offset:4672
    ds_read_b64_tr_b16 v[200:201], v23 offset:6144
    ds_read_b64_tr_b16 v[202:203], v23 offset:6912
    ds_read_b128 v[232:235], v22 offset:96
    ds_read_b128 v[236:239], v22 offset:4704
    ds_read_b64_tr_b16 v[204:205], v23 offset:9216
    ds_read_b64_tr_b16 v[206:207], v23 offset:9984
    s_waitcnt lgkmcnt(12)
    v_mfma_f32_32x32x16_bf16 v[160:175], v[192:195], v[208:211], v[160:175]
    global_load_dwordx4 v[88:91], v4, s[4:5]
    global_load_dwordx4 v[92:95], v5, s[4:5]
    global_load_dwordx4 v[96:99], v6, s[4:5]
    v_mfma_f32_32x32x16_bf16 v[176:191], v[192:195], v[212:215], v[176:191]
    global_load_dwordx4 v[100:103], v7, s[4:5]
    global_load_dwordx4 v[104:107], v8, s[6:7]
    s_waitcnt lgkmcnt(8)
    v_mfma_f32_32x32x16_bf16 v[160:175], v[196:199], v[216:219], v[160:175]
    global_load_dwordx4 v[108:111], v9, s[6:7]
    s_add_u32 s4, s4, 128
    v_mfma_f32_32x32x16_bf16 v[176:191], v[196:199], v[220:223], v[176:191]
    s_addc_u32 s5, s5, 0
    s_add_u32 s6, s6, 131072
    s_waitcnt lgkmcnt(4)
    v_mfma_f32_32x32x16_bf16 v[160:175], v[200:203], v[224:227], v[160:175]
    s_addc_u32 s7, s7, 0
    s_waitcnt vmcnt(18)
    v_mfma_f32_32x32x16_bf16 v[176:191], v[200:203], v[228:231], v[176:191]
    ds_write_b128 v14, v[112:115] offset:30720
    ds_write_b128 v14, v[116:119] offset:35328
    s_waitcnt lgkmcnt(2)
    v_mfma_f32_32x32x16_bf16 v[160:175], v[204:207], v[232:235], v[160:175]
    ds_write_b128 v14, v[120:123] offset:39936
    ds_write_b128 v14, v[124:127] offset:44544
    v_mfma_f32_32x32x16_bf16 v[176:191], v[204:207], v[236:239], v[176:191]
    ds_write_b128 v15, v[128:131] offset:30720
    ds_write_b128 v15, v[132:135] offset:36864
    s_waitcnt lgkmcnt(0)
    s_barrier
    ds_read_b128 v[208:211], v24 offset:0
    ds_read_b128 v[212:215], v24 offset:4608
    ds_read_b64_tr_b16 v[192:193], v25 offset:0
    ds_read_b64_tr_b16 v[194:195], v25 offset:768
    ds_read_b128 v[216:219], v24 offset:32
    ds_read_b128 v[220:223], v24 offset:4640
    ds_read_b64_tr_b16 v[196:197], v25 offset:3072
    ds_read_b64_tr_b16 v[198:199], v25 offset:3840
    ds_read_b128 v[224:227], v24 offset:64
    ds_read_b128 v[228:231], v24 offset:4672
    ds_read_b64_tr_b16 v[200:201], v25 offset:6144
    ds_read_b64_tr_b16 v[202:203], v25 offset:6912
    ds_read_b128 v[232:235], v24 offset:96
    ds_read_b128 v[236:239], v24 offset:4704
    ds_read_b64_tr_b16 v[204:205], v25 offset:9216
    ds_read_b64_tr_b16 v[206:207], v25 offset:9984
    s_waitcnt lgkmcnt(12)
    v_mfma_f32_32x32x16_bf16 v[160:175], v[192:195], v[208:211], v[160:175]
    global_load_dwordx4 v[112:115], v4, s[4:5]
    global_load_dwordx4 v[116:119], v5, s[4:5]
    global_load_dwordx4 v[120:123], v6, s[4:5]
    v_mfma_f32_32x32x16_bf16 v[176:191], v[192:195], v[212:215], v[176:191]
    global_load_dwordx4 v[124:127], v7, s[4:5]
    global_load_dwordx4 v[128:131], v8, s[6:7]
    s_waitcnt lgkmcnt(8)
    v_mfma_f32_32x32x16_bf16 v[160:175], v[196:199], v[216:219], v[160:175]
    global_load_dwordx4 v[132:135], v9, s[6:7]
    s_add_u32 s4, s4, 128
    v_mfma_f32_32x32x16_bf16 v[176:191], v[196:199], v[220:223], v[176:191]
    s_addc_u32 s5, s5, 0
    s_add_u32 s6, s6, 131072
    s_waitcnt lgkmcnt(4)
    v_mfma_f32_32x32x16_bf16 v[160:175], v[200:203], v[224:227], v[160:175]
    s_addc_u32 s7, s7, 0
    s_waitcnt vmcnt(18)
    v_mfma_f32_32x32x16_bf16 v[176:191], v[200:203], v[228:231], v[176:191]
    ds_write_b128 v14, v[40:43] offset:0
    ds_write_b128 v14, v[44:47] offset:4608
    s_waitcnt lgkmcnt(2)
    v_mfma_f32_32x32x16_bf16 v[160:175], v[204:207], v[232:235], v[160:175]
    ds_write_b128 v14, v[48:51] offset:9216
    ds_write_b128 v14, v[52:55] offset:13824
    v_mfma_f32_32x32x16_bf16 v[176:191], v[204:207], v[236:239], v[176:191]
    ds_write_b128 v15, v[56:59] offset:0
    ds_write_b128 v15, v[60:63] offset:6144
    s_waitcnt lgkmcnt(0)
    s_barrier
    ds_read_b128 v[208:211], v22 offset:0
    ds_read_b128 v[212:215], v22 offset:4608
    ds_read_b64_tr_b16 v[192:193], v23 offset:0
    ds_read_b64_tr_b16 v[194:195], v23 offset:768
    ds_read_b128 v[216:219], v22 offset:32
    ds_read_b128 v[220:223], v22 offset:4640
    ds_read_b64_tr_b16 v[196:197], v23 offset:3072
    ds_read_b64_tr_b16 v[198:199], v23 offset:3840
    ds_read_b128 v[224:227], v22 offset:64
    ds_read_b128 v[228:231], v22 offset:4672
    ds_read_b64_tr_b16 v[200:201], v23 offset:6144
    ds_read_b64_tr_b16 v[202:203], v23 offset:6912
    ds_read_b128 v[232:235], v22 offset:96
    ds_read_b128 v[236:239], v22 offset:4704
    ds_read_b64_tr_b16 v[204:205], v23 offset:9216
    ds_read_b64_tr_b16 v[206:207], v23 offset:9984
    s_add_u32 s20, s20, 4
    s_cmp_lt_u32 s20, 12
    s_cbranch_scc1 L_wo2_loop
    s_waitcnt lgkmcnt(12)
    v_mfma_f32_32x32x16_bf16 v[160:175], v[192:195], v[208:211], v[160:175]
    s_waitcnt vmcnt(12)
    v_mfma_f32_32x32x16_bf16 v[176:191], v[192:195], v[212:215], v[176:191]
    ds_write_b128 v14, v[64:67] offset:30720
    s_waitcnt lgkmcnt(9)
    v_mfma_f32_32x32x16_bf16 v[160:175], v[196:199], v[216:219], v[160:175]
    ds_write_b128 v14, v[68:71] offset:35328
    v_mfma_f32_32x32x16_bf16 v[176:191], v[196:199], v[220:223], v[176:191]
    ds_write_b128 v14, v[72:75] offset:39936
    s_waitcnt lgkmcnt(7)
    v_mfma_f32_32x32x16_bf16 v[160:175], v[200:203], v[224:227], v[160:175]
    ds_write_b128 v14, v[76:79] offset:44544
    v_mfma_f32_32x32x16_bf16 v[176:191], v[200:203], v[228:231], v[176:191]
    ds_write_b128 v15, v[80:83] offset:30720
    s_waitcnt lgkmcnt(5)
    v_mfma_f32_32x32x16_bf16 v[160:175], v[204:207], v[232:235], v[160:175]
    ds_write_b128 v15, v[84:87] offset:36864
    v_mfma_f32_32x32x16_bf16 v[176:191], v[204:207], v[236:239], v[176:191]
    s_waitcnt lgkmcnt(0)
    s_barrier
    ds_read_b128 v[208:211], v24 offset:0
    ds_read_b128 v[212:215], v24 offset:4608
    ds_read_b64_tr_b16 v[192:193], v25 offset:0
    ds_read_b64_tr_b16 v[194:195], v25 offset:768
    ds_read_b128 v[216:219], v24 offset:32
    ds_read_b128 v[220:223], v24 offset:4640
    ds_read_b64_tr_b16 v[196:197], v25 offset:3072
    ds_read_b64_tr_b16 v[198:199], v25 offset:3840
    ds_read_b128 v[224:227], v24 offset:64
    ds_read_b128 v[228:231], v24 offset:4672
    ds_read_b64_tr_b16 v[200:201], v25 offset:6144
    ds_read_b64_tr_b16 v[202:203], v25 offset:6912
    ds_read_b128 v[232:235], v24 offset:96
    ds_read_b128 v[236:239], v24 offset:4704
    ds_read_b64_tr_b16 v[204:205], v25 offset:9216
    ds_read_b64_tr_b16 v[206:207], v25 offset:9984
    s_waitcnt lgkmcnt(12)
    v_mfma_f32_32x32x16_bf16 v[160:175], v[192:195], v[208:211], v[160:175]
    s_waitcnt vmcnt(6)
    v_mfma_f32_32x32x16_bf16 v[176:191], v[192:195], v[212:215], v[176:191]
    ds_write_b128 v14, v[88:91] offset:0
    s_waitcnt lgkmcnt(9)
    v_mfma_f32_32x32x16_bf16 v[160:175], v[196:199], v[216:219], v[160:175]
    ds_write_b128 v14, v[92:95] offset:4608
    v_mfma_f32_32x32x16_bf16 v[176:191], v[196:199], v[220:223], v[176:191]
    ds_write_b128 v14, v[96:99] offset:9216
    s_waitcnt lgkmcnt(7)
    v_mfma_f32_32x32x16_bf16 v[160:175], v[200:203], v[224:227], v[160:175]
    ds_write_b128 v14, v[100:103] offset:13824
    v_mfma_f32_32x32x16_bf16 v[176:191], v[200:203], v[228:231], v[176:191]
    ds_write_b128 v15, v[104:107] offset:0
    s_waitcnt lgkmcnt(5)
    v_mfma_f32_32x32x16_bf16 v[160:175], v[204:207], v[232:235], v[160:175]
    ds_write_b128 v15, v[108:111] offset:6144
    v_mfma_f32_32x32x16_bf16 v[176:191], v[204:207], v[236:239], v[176:191]
    s_waitcnt lgkmcnt(0)
    s_barrier
    ds_read_b128 v[208:211], v22 offset:0
    ds_read_b128 v[212:215], v22 offset:4608
    ds_read_b64_tr_b16 v[192:193], v23 offset:0
    ds_read_b64_tr_b16 v[194:195], v23 offset:768
    ds_read_b128 v[216:219], v22 offset:32
    ds_read_b128 v[220:223], v22 offset:4640
    ds_read_b64_tr_b16 v[196:197], v23 offset:3072
    ds_read_b64_tr_b16 v[198:199], v23 offset:3840
    ds_read_b128 v[224:227], v22 offset:64
    ds_read_b128 v[228:231], v22 offset:4672
    ds_read_b64_tr_b16 v[200:201], v23 offset:6144
    ds_read_b64_tr_b16 v[202:203], v23 offset:6912
    ds_read_b128 v[232:235], v22 offset:96
    ds_read_b128 v[236:239], v22 offset:4704
    ds_read_b64_tr_b16 v[204:205], v23 offset:9216
    ds_read_b64_tr_b16 v[206:207], v23 offset:9984
    s_waitcnt lgkmcnt(12)
    v_mfma_f32_32x32x16_bf16 v[160:175], v[192:195], v[208:211], v[160:175]
    s_waitcnt vmcnt(0)
    v_mfma_f32_32x32x16_bf16 v[176:191], v[192:195], v[212:215], v[176:191]
    ds_write_b128 v14, v[112:115] offset:30720
    s_waitcnt lgkmcnt(9)
    v_mfma_f32_32x32x16_bf16 v[160:175], v[196:199], v[216:219], v[160:175]
    ds_write_b128 v14, v[116:119] offset:35328
    v_mfma_f32_32x32x16_bf16 v[176:191], v[196:199], v[220:223], v[176:191]
    ds_write_b128 v14, v[120:123] offset:39936
    s_waitcnt lgkmcnt(7)
    v_mfma_f32_32x32x16_bf16 v[160:175], v[200:203], v[224:227], v[160:175]
    ds_write_b128 v14, v[124:127] offset:44544
    v_mfma_f32_32x32x16_bf16 v[176:191], v[200:203], v[228:231], v[176:191]
    ds_write_b128 v15, v[128:131] offset:30720
    s_waitcnt lgkmcnt(5)
    v_mfma_f32_32x32x16_bf16 v[160:175], v[204:207], v[232:235], v[160:175]
    ds_write_b128 v15, v[132:135] offset:36864
    v_mfma_f32_32x32x16_bf16 v[176:191], v[204:207], v[236:239], v[176:191]
    s_waitcnt lgkmcnt(0)
    s_barrier
    ds_read_b128 v[208:211], v24 offset:0
    ds_read_b128 v[212:215], v24 offset:4608
    ds_read_b64_tr_b16 v[192:193], v25 offset:0
    ds_read_b64_tr_b16 v[194:195], v25 offset:768
    ds_read_b128 v[216:219], v24 offset:32
    ds_read_b128 v[220:223], v24 offset:4640
    ds_read_b64_tr_b16 v[196:197], v25 offset:3072
    ds_read_b64_tr_b16 v[198:199], v25 offset:3840
    ds_read_b128 v[224:227], v24 offset:64
    ds_read_b128 v[228:231], v24 offset:4672
    ds_read_b64_tr_b16 v[200:201], v25 offset:6144
    ds_read_b64_tr_b16 v[202:203], v25 offset:6912
    ds_read_b128 v[232:235], v24 offset:96
    ds_read_b128 v[236:239], v24 offset:4704
    ds_read_b64_tr_b16 v[204:205], v25 offset:9216
    ds_read_b64_tr_b16 v[206:207], v25 offset:9984
    s_waitcnt lgkmcnt(12)
    v_mfma_f32_32x32x16_bf16 v[160:175], v[192:195], v[208:211], v[160:175]
    v_mfma_f32_32x32x16_bf16 v[176:191], v[192:195], v[212:215], v[176:191]
    s_waitcnt lgkmcnt(8)
    v_mfma_f32_32x32x16_bf16 v[160:175], v[196:199], v[216:219], v[160:175]
    v_mfma_f32_32x32x16_bf16 v[176:191], v[196:199], v[220:223], v[176:191]
    s_waitcnt lgkmcnt(4)
    v_mfma_f32_32x32x16_bf16 v[160:175], v[200:203], v[224:227], v[160:175]
    v_mfma_f32_32x32x16_bf16 v[176:191], v[200:203], v[228:231], v[176:191]
    s_waitcnt lgkmcnt(0)
    v_mfma_f32_32x32x16_bf16 v[160:175], v[204:207], v[232:235], v[160:175]
    v_mfma_f32_32x32x16_bf16 v[176:191], v[204:207], v[236:239], v[176:191]
    s_nop 15
    s_nop 7
    s_load_dwordx2 s[14:15], s[0:1], 64
    s_load_dwordx2 s[16:17], s[0:1], 64
    s_load_dwordx2 s[18:19], s[0:1], 64
    s_waitcnt lgkmcnt(0)
    s_add_u32 s18, s18, 4194304
    s_addc_u32 s19, s19, 0
    s_barrier
    v_lshlrev_b32 v24, 13, v17
    v_lshl_add_u32 v22, v20, 7, v24
    v_lshl_add_u32 v22, v21, 4, v22
    ds_write_b128 v22, v[160:163] offset:0
    ds_write_b128 v22, v[164:167] offset:32
    ds_write_b128 v22, v[168:171] offset:64
    ds_write_b128 v22, v[172:175] offset:96
    ds_write_b128 v22, v[176:179] offset:4096
    ds_write_b128 v22, v[180:183] offset:4128
    ds_write_b128 v22, v[184:187] offset:4160
    ds_write_b128 v22, v[188:191] offset:4192
    v_lshl_add_u32 v23, v16, 5, v24
    v_lshrrev_b32 v25, 2, v16
    v_and_b32 v26, 3, v16
    v_lshl_add_u32 v27, v18, 6, s10
    v_add_u32 v27, v27, v25
    s_lshl_b32 s12, s9, 6
    v_lshl_add_u32 v28, v19, 5, s12
    v_lshl_add_u32 v28, v26, 3, v28
    v_lshlrev_b32 v29, 10, v27
    v_add_u32 v29, v29, v28
    v_lshlrev_b32 v29, 1, v29
    s_lshl_b32 s13, s9, 1
    v_lshl_add_u32 v30, v27, 5, s13
    v_add_u32 v30, v30, v19
    v_lshlrev_b32 v30, 3, v30
    global_load_dwordx4 v[40:43], v29, s[14:15] offset:0
    v_add_u32 v31, 32768, v29
    global_load_dwordx4 v[44:47], v31, s[14:15]
    v_add_u32 v31, 65536, v29
    global_load_dwordx4 v[48:51], v31, s[14:15]
    v_add_u32 v31, 98304, v29
    global_load_dwordx4 v[52:55], v31, s[14:15]
    s_waitcnt lgkmcnt(0)
    ds_read_b128 v[64:67], v23 offset:0
    ds_read_b128 v[68:71], v23 offset:16
    ds_read_b128 v[72:75], v23 offset:2048
    ds_read_b128 v[76:79], v23 offset:2064
    ds_read_b128 v[80:83], v23 offset:4096
    ds_read_b128 v[84:87], v23 offset:4112
    ds_read_b128 v[88:91], v23 offset:6144
    ds_read_b128 v[92:95], v23 offset:6160
    s_waitcnt vmcnt(0) lgkmcnt(0)
    v_mov_b32 v56, 0
    v_mov_b32 v57, 0
    v_lshlrev_b32 v58, 16, v40
    v_and_b32 v59, 0xffff0000, v40
    v_add_f32 v58, v58, v64
    v_add_f32 v59, v59, v65
    v_cvt_pk_bf16_f32 v40, v58, v59
    v_lshlrev_b32 v58, 16, v40
    v_and_b32 v59, 0xffff0000, v40
    v_add_f32 v56, v56, v58
    v_fmac_f32 v57, v58, v58
    v_add_f32 v56, v56, v59
    v_fmac_f32 v57, v59, v59
    v_lshlrev_b32 v58, 16, v41
    v_and_b32 v59, 0xffff0000, v41
    v_add_f32 v58, v58, v66
    v_add_f32 v59, v59, v67
    v_cvt_pk_bf16_f32 v41, v58, v59
    v_lshlrev_b32 v58, 16, v41
    v_and_b32 v59, 0xffff0000, v41
    v_add_f32 v56, v56, v58
    v_fmac_f32 v57, v58, v58
    v_add_f32 v56, v56, v59
    v_fmac_f32 v57, v59, v59
    v_lshlrev_b32 v58, 16, v42
    v_and_b32 v59, 0xffff0000, v42
    v_add_f32 v58, v58, v68
    v_add_f32 v59, v59, v69
    v_cvt_pk_bf16_f32 v42, v58, v59
    v_lshlrev_b32 v58, 16, v42
    v_and_b32 v59, 0xffff0000, v42
    v_add_f32 v56, v56, v58
    v_fmac_f32 v57, v58, v58
    v_add_f32 v56, v56, v59
    v_fmac_f32 v57, v59, v59
    v_lshlrev_b32 v58, 16, v43
    v_and_b32 v59, 0xffff0000, v43
    v_add_f32 v58, v58, v70
    v_add_f32 v59, v59, v71
    v_cvt_pk_bf16_f32 v43, v58, v59
    v_lshlrev_b32 v58, 16, v43
    v_and_b32 v59, 0xffff0000, v43
    v_add_f32 v56, v56, v58
    v_fmac_f32 v57, v58, v58
    v_add_f32 v56, v56, v59
    v_fmac_f32 v57, v59, v59
    v_add_u32 v31, 0, v29
    global_store_dwordx4 v31, v[40:43], s[16:17]
    s_nop 1
    v_mov_b32_dpp v58, v56 quad_perm:[1,0,3,2] row_mask:0xf bank_mask:0xf
    v_mov_b32_dpp v59, v57 quad_perm:[1,0,3,2] row_mask:0xf bank_mask:0xf
    v_add_f32 v56, v56, v58
    v_add_f32 v57, v57, v59
    s_nop 1
    v_mov_b32_dpp v58, v56 quad_perm:[2,3,0,1] row_mask:0xf bank_mask:0xf
    v_mov_b32_dpp v59, v57 quad_perm:[2,3,0,1] row_mask:0xf bank_mask:0xf
    v_add_f32 v56, v56, v58
    v_add_f32 v57, v57, v59
    v_cmp_eq_u32 vcc, 0, v26
    s_and_saveexec_b64 s[22:23], vcc
    v_add_u32 v31, 0, v30
    global_store_dwordx2 v31, v[56:57], s[18:19]
    s_mov_b64 exec, s[22:23]
    v_mov_b32 v56, 0
    v_mov_b32 v57, 0
    v_lshlrev_b32 v58, 16, v44
    v_and_b32 v59, 0xffff0000, v44
    v_add_f32 v58, v58, v72
    v_add_f32 v59, v59, v73
    v_cvt_pk_bf16_f32 v44, v58, v59
    v_lshlrev_b32 v58, 16, v44
    v_and_b32 v59, 0xffff0000, v44
    v_add_f32 v56, v56, v58
    v_fmac_f32 v57, v58, v58
    v_add_f32 v56, v56, v59
    v_fmac_f32 v57, v59, v59
    v_lshlrev_b32 v58, 16, v45
    v_and_b32 v59, 0xffff0000, v45
    v_add_f32 v58, v58, v74
    v_add_f32 v59, v59, v75
    v_cvt_pk_bf16_f32 v45, v58, v59
    v_lshlrev_b32 v58, 16, v45
    v_and_b32 v59, 0xffff0000, v45
    v_add_f32 v56, v56, v58
    v_fmac_f32 v57, v58, v58
    v_add_f32 v56, v56, v59
    v_fmac_f32 v57, v59, v59
    v_lshlrev_b32 v58, 16, v46
    v_and_b32 v59, 0xffff0000, v46
    v_add_f32 v58, v58, v76
    v_add_f32 v59, v59, v77
    v_cvt_pk_bf16_f32 v46, v58, v59
    v_lshlrev_b32 v58, 16, v46
    v_and_b32 v59, 0xffff0000, v46
    v_add_f32 v56, v56, v58
    v_fmac_f32 v57, v58, v58
    v_add_f32 v56, v56, v59
    v_fmac_f32 v57, v59, v59
    v_lshlrev_b32 v58, 16, v47
    v_and_b32 v59, 0xffff0000, v47
    v_add_f32 v58, v58, v78
    v_add_f32 v59, v59, v79
    v_cvt_pk_bf16_f32 v47, v58, v59
    v_lshlrev_b32 v58, 16, v47
    v_and_b32 v59, 0xffff0000, v47
    v_add_f32 v56, v56, v58
    v_fmac_f32 v57, v58, v58
    v_add_f32 v56, v56, v59
    v_fmac_f32 v57, v59, v59
    v_add_u32 v31, 32768, v29
    global_store_dwordx4 v31, v[44:47], s[16:17]
    s_nop 1
    v_mov_b32_dpp v58, v56 quad_perm:[1,0,3,2] row_mask:0xf bank_mask:0xf
    v_mov_b32_dpp v59, v57 quad_perm:[1,0,3,2] row_mask:0xf bank_mask:0xf
    v_add_f32 v56, v56, v58
    v_add_f32 v57, v57, v59
    s_nop 1
    v_mov_b32_dpp v58, v56 quad_perm:[2,3,0,1] row_mask:0xf bank_mask:0xf
    v_mov_b32_dpp v59, v57 quad_perm:[2,3,0,1] row_mask:0xf bank_mask:0xf
    v_add_f32 v56, v56, v58
    v_add_f32 v57, v57, v59
    v_cmp_eq_u32 vcc, 0, v26
    s_and_saveexec_b64 s[22:23], vcc
    v_add_u32 v31, 4096, v30
    global_store_dwordx2 v31, v[56:57], s[18:19]
    s_mov_b64 exec, s[22:23]
    v_mov_b32 v56, 0
    v_mov_b32 v57, 0
    v_lshlrev_b32 v58, 16, v48
    v_and_b32 v59, 0xffff0000, v48
    v_add_f32 v58, v58, v80
    v_add_f32 v59, v59, v81
    v_cvt_pk_bf16_f32 v48, v58, v59
    v_lshlrev_b32 v58, 16, v48
    v_and_b32 v59, 0xffff0000, v48
    v_add_f32 v56, v56, v58
    v_fmac_f32 v57, v58, v58
    v_add_f32 v56, v56, v59
    v_fmac_f32 v57, v59, v59
    v_lshlrev_b32 v58, 16, v49
    v_and_b32 v59, 0xffff0000, v49
    v_add_f32 v58, v58, v82
    v_add_f32 v59, v59, v83
    v_cvt_pk_bf16_f32 v49, v58, v59
    v_lshlrev_b32 v58, 16, v49
    v_and_b32 v59, 0xffff0000, v49
    v_add_f32 v56, v56, v58
    v_fmac_f32 v57, v58, v58
    v_add_f32 v56, v56, v59
    v_fmac_f32 v57, v59, v59
    v_lshlrev_b32 v58, 16, v50
    v_and_b32 v59, 0xffff0000, v50
    v_add_f32 v58, v58, v84
    v_add_f32 v59, v59, v85
    v_cvt_pk_bf16_f32 v50, v58, v59
    v_lshlrev_b32 v58, 16, v50
    v_and_b32 v59, 0xffff0000, v50
    v_add_f32 v56, v56, v58
    v_fmac_f32 v57, v58, v58
    v_add_f32 v56, v56, v59
    v_fmac_f32 v57, v59, v59
    v_lshlrev_b32 v58, 16, v51
    v_and_b32 v59, 0xffff0000, v51
    v_add_f32 v58, v58, v86
    v_add_f32 v59, v59, v87
    v_cvt_pk_bf16_f32 v51, v58, v59
    v_lshlrev_b32 v58, 16, v51
    v_and_b32 v59, 0xffff0000, v51
    v_add_f32 v56, v56, v58
    v_fmac_f32 v57, v58, v58
    v_add_f32 v56, v56, v59
    v_fmac_f32 v57, v59, v59
    v_add_u32 v31, 65536, v29
    global_store_dwordx4 v31, v[48:51], s[16:17]
    s_nop 1
    v_mov_b32_dpp v58, v56 quad_perm:[1,0,3,2] row_mask:0xf bank_mask:0xf
    v_mov_b32_dpp v59, v57 quad_perm:[1,0,3,2] row_mask:0xf bank_mask:0xf
    v_add_f32 v56, v56, v58
    v_add_f32 v57, v57, v59
    s_nop 1
    v_mov_b32_dpp v58, v56 quad_perm:[2,3,0,1] row_mask:0xf bank_mask:0xf
    v_mov_b32_dpp v59, v57 quad_perm:[2,3,0,1] row_mask:0xf bank_mask:0xf
    v_add_f32 v56, v56, v58
    v_add_f32 v57, v57, v59
    v_cmp_eq_u32 vcc, 0, v26
    s_and_saveexec_b64 s[22:23], vcc
    v_add_u32 v31, 8192, v30
    global_store_dwordx2 v31, v[56:57], s[18:19]
    s_mov_b64 exec, s[22:23]
    v_mov_b32 v56, 0
    v_mov_b32 v57, 0
    v_lshlrev_b32 v58, 16, v52
    v_and_b32 v59, 0xffff0000, v52
    v_add_f32 v58, v58, v88
    v_add_f32 v59, v59, v89
    v_cvt_pk_bf16_f32 v52, v58, v59
    v_lshlrev_b32 v58, 16, v52
    v_and_b32 v59, 0xffff0000, v52
    v_add_f32 v56, v56, v58
    v_fmac_f32 v57, v58, v58
    v_add_f32 v56, v56, v59
    v_fmac_f32 v57, v59, v59
    v_lshlrev_b32 v58, 16, v53
    v_and_b32 v59, 0xffff0000, v53
    v_add_f32 v58, v58, v90
    v_add_f32 v59, v59, v91
    v_cvt_pk_bf16_f32 v53, v58, v59
    v_lshlrev_b32 v58, 16, v53
    v_and_b32 v59, 0xffff0000, v53
    v_add_f32 v56, v56, v58
    v_fmac_f32 v57, v58, v58
    v_add_f32 v56, v56, v59
    v_fmac_f32 v57, v59, v59
    v_lshlrev_b32 v58, 16, v54
    v_and_b32 v59, 0xffff0000, v54
    v_add_f32 v58, v58, v92
    v_add_f32 v59, v59, v93
    v_cvt_pk_bf16_f32 v54, v58, v59
    v_lshlrev_b32 v58, 16, v54
    v_and_b32 v59, 0xffff0000, v54
    v_add_f32 v56, v56, v58
    v_fmac_f32 v57, v58, v58
    v_add_f32 v56, v56, v59
    v_fmac_f32 v57, v59, v59
    v_lshlrev_b32 v58, 16, v55
    v_and_b32 v59, 0xffff0000, v55
    v_add_f32 v58, v58, v94
    v_add_f32 v59, v59, v95
    v_cvt_pk_bf16_f32 v55, v58, v59
    v_lshlrev_b32 v58, 16, v55
    v_and_b32 v59, 0xffff0000, v55
    v_add_f32 v56, v56, v58
    v_fmac_f32 v57, v58, v58
    v_add_f32 v56, v56, v59
    v_fmac_f32 v57, v59, v59
    v_add_u32 v31, 98304, v29
    global_store_dwordx4 v31, v[52:55], s[16:17]
    s_nop 1
    v_mov_b32_dpp v58, v56 quad_perm:[1,0,3,2] row_mask:0xf bank_mask:0xf
    v_mov_b32_dpp v59, v57 quad_perm:[1,0,3,2] row_mask:0xf bank_mask:0xf
    v_add_f32 v56, v56, v58
    v_add_f32 v57, v57, v59
    s_nop 1
    v_mov_b32_dpp v58, v56 quad_perm:[2,3,0,1] row_mask:0xf bank_mask:0xf
    v_mov_b32_dpp v59, v57 quad_perm:[2,3,0,1] row_mask:0xf bank_mask:0xf
    v_add_f32 v56, v56, v58
    v_add_f32 v57, v57, v59
    v_cmp_eq_u32 vcc, 0, v26
    s_and_saveexec_b64 s[22:23], vcc
    v_add_u32 v31, 12288, v30
    global_store_dwordx2 v31, v[56:57], s[18:19]
    s_mov_b64 exec, s[22:23]
L_wo2_end:
    s_endpgm
.globl qkv3_kernel
.p2align 8
.type qkv3_kernel,@function
qkv3_kernel:
    s_cmp_ge_u32 s2, 256
    s_cbranch_scc1 L_qkv3_end
    s_load_dwordx2 s[4:5], s[0:1], 64
    s_load_dwordx2 s[6:7], s[0:1], 32
    s_load_dwordx2 s[14:15], s[0:1], 64
    s_waitcnt lgkmcnt(0)
    s_add_u32 s14, s14, 4194304
    s_addc_u32 s15, s15, 0
    s_lshr_b32 s8, s2, 4
    s_and_b32 s9, s2, 15
    v_lshrrev_b32 v1, 3, v0
    v_and_b32 v2, 7, v0
    s_lshl_b32 s10, s8, 7
    v_add_u32 v3, s10, v1
    v_lshlrev_b32 v3, 11, v3
    v_lshl_add_u32 v3, v2, 4, v3
    v_add_u32 v4, 0, v3
    v_add_u32 v5, 65536, v3
    v_add_u32 v6, 131072, v3
    v_add_u32 v7, 196608, v3
    s_mov_b32 s11, 6144
    v_mul_lo_u32 v3, v1, s11
    v_lshl_add_u32 v3, v2, 4, v3
    s_lshl_b32 s12, s9, 7
    v_add_u32 v3, s12, v3
    v_add_u32 v8, 0, v3
    v_add_u32 v9, 2048, v3
    v_add_u32 v10, 4096, v3
    v_add_u32 v11, 196608, v3
    v_add_u32 v12, 198656, v3
    v_add_u32 v13, 200704, v3
    v_mul_u32_u24 v14, 144, v1
    v_lshl_add_u32 v14, v2, 4, v14
    v_mul_u32_u24 v15, 448, v1
    v_lshl_add_u32 v15, v2, 4, v15
    v_add_u32 v15, 18432, v15
    v_and_b32 v16, 63, v0
    v_lshrrev_b32 v17, 6, v0
    v_lshrrev_b32 v18, 1, v17
    v_and_b32 v19, 1, v17
    v_and_b32 v20, 31, v16
    v_lshrrev_b32 v21, 5, v16
    v_lshl_add_u32 v22, v18, 6, v20
    v_mul_u32_u24 v22, 144, v22
    v_lshl_add_u32 v22, v21, 4, v22
    v_bfe_u32 v23, v16, 2, 2
    v_lshl_add_u32 v23, v21, 3, v23
    v_mul_u32_u24 v23, 448, v23
    v_bfe_u32 v24, v16, 4, 1
    v_lshlrev_b32 v24, 5, v24
    v_lshl_add_u32 v24, v19, 6, v24
    v_and_b32 v25, 3, v16
    v_lshl_add_u32 v24, v25, 3, v24
    v_add_u32 v23, v23, v24
    v_add_u32 v23, 18432, v23
    v_add_u32 v24, 47104, v22
    v_add_u32 v25, 47104, v23
    v_lshrrev_b32 v26, 1, v0
    v_and_b32 v27, 1, v0
    v_add_u32 v28, s10, v26
    v_lshlrev_b32 v28, 8, v28
    v_lshl_add_u32 v28, v27, 7, v28
    global_load_dwordx4 v[160:163], v28, s[14:15] offset:0
    global_load_dwordx4 v[164:167], v28, s[14:15] offset:16
    global_load_dwordx4 v[168:171], v28, s[14:15] offset:32
    global_load_dwordx4 v[172:175], v28, s[14:15] offset:48
    global_load_dwordx4 v[176:179], v28, s[14:15] offset:64
    global_load_dwordx4 v[180:183], v28, s[14:15] offset:80
    global_load_dwordx4 v[184:187], v28, s[14:15] offset:96
    global_load_dwordx4 v[188:191], v28, s[14:15] offset:112
    v_mov_b32 v34, 0
    v_mov_b32 v35, 0
    global_load_dwordx4 v[40:43], v4, s[4:5]
    global_load_dwordx4 v[44:47], v5, s[4:5]
    global_load_dwordx4 v[48:51], v6, s[4:5]
    global_load_dwordx4 v[52:55], v7, s[4:5]
    global_load_dwordx4 v[56:59], v8, s[6:7]
    global_load_dwordx4 v[60:63], v9, s[6:7]
    global_load_dwordx4 v[64:67], v10, s[6:7]
    global_load_dwordx4 v[68:71], v11, s[6:7]
    global_load_dwordx4 v[72:75], v12, s[6:7]
    global_load_dwordx4 v[76:79], v13, s[6:7]
    s_add_u32 s4, s4, 128
    s_addc_u32 s5, s5, 0
    s_add_u32 s6, s6, 393216
    s_addc_u32 s7, s7, 0
    global_load_dwordx4 v[80:83], v4, s[4:5]
    global_load_dwordx4 v[84:87], v5, s[4:5]
    global_load_dwordx4 v[88:91], v6, s[4:5]
    global_load_dwordx4 v[92:95], v7, s[4:5]
    global_load_dwordx4 v[96:99], v8, s[6:7]
    global_load_dwordx4 v[100:103], v9, s[6:7]
    global_load_dwordx4 v[104:107], v10, s[6:7]
    global_load_dwordx4 v[108:111], v11, s[6:7]
    global_load_dwordx4 v[112:115], v12, s[6:7]
    global_load_dwordx4 v[116:119], v13, s[6:7]
    s_add_u32 s4, s4, 128
    s_addc_u32 s5, s5, 0
    s_add_u32 s6, s6, 393216
    s_addc_u32 s7, s7, 0
    s_waitcnt vmcnt(20)
    v_add_f32 v34, v34, v160
    v_add_f32 v35, v35, v161
    v_add_f32 v34, v34, v162
    v_add_f32 v35, v35, v163
    v_add_f32 v34, v34, v164
    v_add_f32 v35, v35, v165
    v_add_f32 v34, v34, v166
    v_add_f32 v35, v35, v167
    v_add_f32 v34, v34, v168
    v_add_f32 v35, v35, v169
    v_add_f32 v34, v34, v170
    v_add_f32 v35, v35, v171
    v_add_f32 v34, v34, v172
    v_add_f32 v35, v35, v173
    v_add_f32 v34, v34, v174
    v_add_f32 v35, v35, v175
    v_add_f32 v34, v34, v176
    v_add_f32 v35, v35, v177
    v_add_f32 v34, v34, v178
    v_add_f32 v35, v35, v179
    v_add_f32 v34, v34, v180
    v_add_f32 v35, v35, v181
    v_add_f32 v34, v34, v182
    v_add_f32 v35, v35, v183
    v_add_f32 v34, v34, v184
    v_add_f32 v35, v35, v185
    v_add_f32 v34, v34, v186
    v_add_f32 v35, v35, v187
    v_add_f32 v34, v34, v188
    v_add_f32 v35, v35, v189
    v_add_f32 v34, v34, v190
    v_add_f32 v35, v35, v191
    s_nop 1
    v_mov_b32_dpp v31, v34 quad_perm:[1,0,3,2] row_mask:0xf bank_mask:0xf
    v_mov_b32_dpp v32, v35 quad_perm:[1,0,3,2] row_mask:0xf bank_mask:0xf
    v_add_f32 v34, v34, v31
    v_add_f32 v35, v35, v32
    v_mul_f32 v34, 0x3a800000, v34
    v_mul_f32 v35, 0x3a800000, v35
    v_fma_f32 v35, -v34, v34, v35
    v_max_f32 v35, 0, v35
    v_add_f32 v35, 0x3727c5ac, v35
    v_rsq_f32 v35, v35
    s_nop 0
    v_mul_f32 v34, v34, v35
    v_sub_f32 v34, 0, v34
    v_lshlrev_b32 v31, 3, v26
    v_add_u32 v31, 94208, v31
    ds_write_b64 v31, v[34:35]
    s_waitcnt lgkmcnt(0)
    s_barrier
    v_lshlrev_b32 v31, 3, v1
    v_add_u32 v31, 94208, v31
    ds_read_b64 v[26:27], v31 offset:0
    ds_read_b64 v[28:29], v31 offset:256
    ds_read_b64 v[30:31], v31 offset:512
    ds_read_b64 v[32:33], v31 offset:768
    s_waitcnt lgkmcnt(0)
    v_mov_b32 v160, 0
    v_mov_b32 v161, 0
    v_mov_b32 v162, 0
    v_mov_b32 v163, 0
    v_mov_b32 v164, 0
    v_mov_b32 v165, 0
    v_mov_b32 v166, 0
    v_mov_b32 v167, 0
    v_mov_b32 v168, 0
    v_mov_b32 v169, 0
    v_mov_b32 v170, 0
    v_mov_b32 v171, 0
    v_mov_b32 v172, 0
    v_mov_b32 v173, 0
    v_mov_b32 v174, 0
    v_mov_b32 v175, 0
    v_mov_b32 v176, 0
    v_mov_b32 v177, 0
    v_mov_b32 v178, 0
    v_mov_b32 v179, 0
    v_mov_b32 v180, 0
    v_mov_b32 v181, 0
    v_mov_b32 v182, 0
    v_mov_b32 v183, 0
    v_mov_b32 v184, 0
    v_mov_b32 v185, 0
    v_mov_b32 v186, 0
    v_mov_b32 v187, 0
    v_mov_b32 v188, 0
    v_mov_b32 v189, 0
    v_mov_b32 v190, 0
    v_mov_b32 v191, 0
    v_mov_b32 v192, 0
    v_mov_b32 v193, 0
    v_mov_b32 v194, 0
    v_mov_b32 v195, 0
    v_mov_b32 v196, 0
    v_mov_b32 v197, 0
    v_mov_b32 v198, 0
    v_mov_b32 v199, 0
    v_mov_b32 v200, 0
    v_mov_b32 v201, 0
    v_mov_b32 v202, 0
    v_mov_b32 v203, 0
    v_mov_b32 v204, 0
    v_mov_b32 v205, 0
    v_mov_b32 v206, 0
    v_mov_b32 v207, 0
    v_mov_b32 v208, 0
    v_mov_b32 v209, 0
    v_mov_b32 v210, 0
    v_mov_b32 v211, 0
    v_mov_b32 v212, 0
    v_mov_b32 v213, 0
    v_mov_b32 v214, 0
    v_mov_b32 v215, 0
    v_mov_b32 v216, 0
    v_mov_b32 v217, 0
    v_mov_b32 v218, 0
    v_mov_b32 v219, 0
    v_mov_b32 v220, 0
    v_mov_b32 v221, 0
    v_mov_b32 v222, 0
    v_mov_b32 v223, 0
    v_mov_b32 v224, 0
    v_mov_b32 v225, 0
    v_mov_b32 v226, 0
    v_mov_b32 v227, 0
    v_mov_b32 v228, 0
    v_mov_b32 v229, 0
    v_mov_b32 v230, 0
    v_mov_b32 v231, 0
    v_mov_b32 v232, 0
    v_mov_b32 v233, 0
    v_mov_b32 v234, 0
    v_mov_b32 v235, 0
    v_mov_b32 v236, 0
    v_mov_b32 v237, 0
    v_mov_b32 v238, 0
    v_mov_b32 v239, 0
    v_mov_b32 v240, 0
    v_mov_b32 v241, 0
    v_mov_b32 v242, 0
    v_mov_b32 v243, 0
    v_mov_b32 v244, 0
    v_mov_b32 v245, 0
    v_mov_b32 v246, 0
    v_mov_b32 v247, 0
    v_mov_b32 v248, 0
    v_mov_b32 v249, 0
    v_mov_b32 v250, 0
    v_mov_b32 v251, 0
    v_mov_b32 v252, 0
    v_mov_b32 v253, 0
    v_mov_b32 v254, 0
    v_mov_b32 v255, 0
    s_waitcnt vmcnt(10)
    v_lshlrev_b32 v36, 16, v40
    v_and_b32 v37, 0xffff0000, v40
    v_fma_f32 v36, v36, v27, v26
    v_fma_f32 v37, v37, v27, v26
    v_cvt_pk_bf16_f32 v40, v36, v37
    v_lshlrev_b32 v36, 16, v41
    v_and_b32 v37, 0xffff0000, v41
    v_fma_f32 v36, v36, v27, v26
    v_fma_f32 v37, v37, v27, v26
    v_cvt_pk_bf16_f32 v41, v36, v37
    v_lshlrev_b32 v36, 16, v42
    v_and_b32 v37, 0xffff0000, v42
    v_fma_f32 v36, v36, v27, v26
    v_fma_f32 v37, v37, v27, v26
    v_cvt_pk_bf16_f32 v42, v36, v37
    v_lshlrev_b32 v36, 16, v43
    v_and_b32 v37, 0xffff0000, v43
    v_fma_f32 v36, v36, v27, v26
    v_fma_f32 v37, v37, v27, v26
    v_cvt_pk_bf16_f32 v43, v36, v37
    ds_write_b128 v14, v[40:43] offset:0
    v_lshlrev_b32 v36, 16, v44
    v_and_b32 v37, 0xffff0000, v44
    v_fma_f32 v36, v36, v29, v28
    v_fma_f32 v37, v37, v29, v28
    v_cvt_pk_bf16_f32 v44, v36, v37
    v_lshlrev_b32 v36, 16, v45
    v_and_b32 v37, 0xffff0000, v45
    v_fma_f32 v36, v36, v29, v28
    v_fma_f32 v37, v37, v29, v28
    v_cvt_pk_bf16_f32 v45, v36, v37
    v_lshlrev_b32 v36, 16, v46
    v_and_b32 v37, 0xffff0000, v46
    v_fma_f32 v36, v36, v29, v28
    v_fma_f32 v37, v37, v29, v28
    v_cvt_pk_bf16_f32 v46, v36, v37
    v_lshlrev_b32 v36, 16, v47
    v_and_b32 v37, 0xffff0000, v47
    v_fma_f32 v36, v36, v29, v28
    v_fma_f32 v37, v37, v29, v28
    v_cvt_pk_bf16_f32 v47, v36, v37
    ds_write_b128 v14, v[44:47] offset:4608
    v_lshlrev_b32 v36, 16, v48
    v_and_b32 v37, 0xffff0000, v48
    v_fma_f32 v36, v36, v31, v30
    v_fma_f32 v37, v37, v31, v30
    v_cvt_pk_bf16_f32 v48, v36, v37
    v_lshlrev_b32 v36, 16, v49
    v_and_b32 v37, 0xffff0000, v49
    v_fma_f32 v36, v36, v31, v30
    v_fma_f32 v37, v37, v31, v30
    v_cvt_pk_bf16_f32 v49, v36, v37
    v_lshlrev_b32 v36, 16, v50
    v_and_b32 v37, 0xffff0000, v50
    v_fma_f32 v36, v36, v31, v30
    v_fma_f32 v37, v37, v31, v30
    v_cvt_pk_bf16_f32 v50, v36, v37
    v_lshlrev_b32 v36, 16, v51
    v_and_b32 v37, 0xffff0000, v51
    v_fma_f32 v36, v36, v31, v30
    v_fma_f32 v37, v37, v31, v30
    v_cvt_pk_bf16_f32 v51, v36, v37
    ds_write_b128 v14, v[48:51] offset:9216
    v_lshlrev_b32 v36, 16, v52
    v_and_b32 v37, 0xffff0000, v52
    v_fma_f32 v36, v36, v33, v32
    v_fma_f32 v37, v37, v33, v32
    v_cvt_pk_bf16_f32 v52, v36, v37
    v_lshlrev_b32 v36, 16, v53
    v_and_b32 v37, 0xffff0000, v53
    v_fma_f32 v36, v36, v33, v32
    v_fma_f32 v37, v37, v33, v32
    v_cvt_pk_bf16_f32 v53, v36, v37
    v_lshlrev_b32 v36, 16, v54
    v_and_b32 v37, 0xffff0000, v54
    v_fma_f32 v36, v36, v33, v32
    v_fma_f32 v37, v37, v33, v32
    v_cvt_pk_bf16_f32 v54, v36, v37
    v_lshlrev_b32 v36, 16, v55
    v_and_b32 v37, 0xffff0000, v55
    v_fma_f32 v36, v36, v33, v32
    v_fma_f32 v37, v37, v33, v32
    v_cvt_pk_bf16_f32 v55, v36, v37
    ds_write_b128 v14, v[52:55] offset:13824
    ds_write_b128 v15, v[56:59] offset:0
    ds_write_b128 v15, v[60:63] offset:128
    ds_write_b128 v15, v[64:67] offset:256
    ds_write_b128 v15, v[68:71] offset:14336
    ds_write_b128 v15, v[72:75] offset:14464
    ds_write_b128 v15, v[76:79] offset:14592
    s_waitcnt lgkmcnt(0)
    s_barrier
    ds_read_b128 v[120:123], v22 offset:0
    ds_read_b128 v[124:127], v22 offset:4608
    ds_read_b64_tr_b16 v[136:137], v23 offset:0
    ds_read_b64_tr_b16 v[138:139], v23 offset:1792
    ds_read_b64_tr_b16 v[140:141], v23 offset:128
    ds_read_b64_tr_b16 v[142:143], v23 offset:1920
    ds_read_b64_tr_b16 v[144:145], v23 offset:256
    ds_read_b64_tr_b16 v[146:147], v23 offset:2048
    s_mov_b32 s20, 0
L_qkv3_loop:
    s_waitcnt lgkmcnt(0)
    v_mfma_f32_32x32x16_bf16 v[160:175], v[136:139], v[120:123], v[160:175]
    ds_read_b128 v[128:131], v22 offset:32
    ds_read_b128 v[132:135], v22 offset:4640
    ds_read_b64_tr_b16 v[148:149], v23 offset:7168
    ds_read_b64_tr_b16 v[150:151], v23 offset:8960
    ds_read_b64_tr_b16 v[152:153], v23 offset:7296
    ds_read_b64_tr_b16 v[154:155], v23 offset:9088
    ds_read_b64_tr_b16 v[156:157], v23 offset:7424
    ds_read_b64_tr_b16 v[158:159], v23 offset:9216
    v_mfma_f32_32x32x16_bf16 v[176:191], v[140:143], v[120:123], v[176:191]
    global_load_dwordx4 v[40:43], v4, s[4:5]
    global_load_dwordx4 v[44:47], v5, s[4:5]
    global_load_dwordx4 v[48:51], v6, s[4:5]
    global_load_dwordx4 v[52:55], v7, s[4:5]
    global_load_dwordx4 v[56:59], v8, s[6:7]
    global_load_dwordx4 v[60:63], v9, s[6:7]
    global_load_dwordx4 v[64:67], v10, s[6:7]
    global_load_dwordx4 v[68:71], v11, s[6:7]
    v_mfma_f32_32x32x16_bf16 v[192:207], v[120:123], v[144:147], v[192:207]
    global_load_dwordx4 v[72:75], v12, s[6:7]
    global_load_dwordx4 v[76:79], v13, s[6:7]
    s_add_u32 s4, s4, 128
    s_addc_u32 s5, s5, 0
    s_add_u32 s6, s6, 393216
    s_addc_u32 s7, s7, 0
    s_waitcnt vmcnt(10)
    v_mfma_f32_32x32x16_bf16 v[208:223], v[136:139], v[124:127], v[208:223]
    v_lshlrev_b32 v36, 16, v80
    v_and_b32 v37, 0xffff0000, v80
    v_fma_f32 v36, v36, v27, v26
    v_fma_f32 v37, v37, v27, v26
    v_cvt_pk_bf16_f32 v80, v36, v37
    v_lshlrev_b32 v36, 16, v81
    v_and_b32 v37, 0xffff0000, v81
    v_mfma_f32_32x32x16_bf16 v[224:239], v[140:143], v[124:127], v[224:239]
    v_fma_f32 v36, v36, v27, v26
    v_fma_f32 v37, v37, v27, v26
    v_cvt_pk_bf16_f32 v81, v36, v37
    v_lshlrev_b32 v36, 16, v82
    v_and_b32 v37, 0xffff0000, v82
    v_fma_f32 v36, v36, v27, v26
    v_fma_f32 v37, v37, v27, v26
    v_mfma_f32_32x32x16_bf16 v[240:255], v[124:127], v[144:147], v[240:255]
    v_cvt_pk_bf16_f32 v82, v36, v37
    v_lshlrev_b32 v36, 16, v83
    v_and_b32 v37, 0xffff0000, v83
    v_fma_f32 v36, v36, v27, v26
    v_fma_f32 v37, v37, v27, v26
    v_cvt_pk_bf16_f32 v83, v36, v37
    ds_write_b128 v14, v[80:83] offset:47104
    s_waitcnt lgkmcnt(1)
    v_mfma_f32_32x32x16_bf16 v[160:175], v[148:151], v[128:131], v[160:175]
    ds_read_b128 v[120:123], v22 offset:64
    ds_read_b128 v[124:127], v22 offset:4672
    ds_read_b64_tr_b16 v[136:137], v23 offset:14336
    ds_read_b64_tr_b16 v[138:139], v23 offset:16128
    ds_read_b64_tr_b16 v[140:141], v23 offset:14464
    ds_read_b64_tr_b16 v[142:143], v23 offset:16256
    ds_read_b64_tr_b16 v[144:145], v23 offset:14592
    ds_read_b64_tr_b16 v[146:147], v23 offset:16384
    v_lshlrev_b32 v36, 16, v84
    v_mfma_f32_32x32x16_bf16 v[176:191], v[152:155], v[128:131], v[176:191]
    v_and_b32 v37, 0xffff0000, v84
    v_fma_f32 v36, v36, v29, v28
    v_fma_f32 v37, v37, v29, v28
    v_cvt_pk_bf16_f32 v84, v36, v37
    v_lshlrev_b32 v36, 16, v85
    v_and_b32 v37, 0xffff0000, v85
    v_fma_f32 v36, v36, v29, v28
    v_fma_f32 v37, v37, v29, v28
    v_cvt_pk_bf16_f32 v85, v36, v37
    v_mfma_f32_32x32x16_bf16 v[192:207], v[128:131], v[156:159], v[192:207]
    v_lshlrev_b32 v36, 16, v86
    v_and_b32 v37, 0xffff0000, v86
    v_fma_f32 v36, v36, v29, v28
    v_fma_f32 v37, v37, v29, v28
    v_cvt_pk_bf16_f32 v86, v36, v37
    v_lshlrev_b32 v36, 16, v87
    v_and_b32 v37, 0xffff0000, v87
    v_fma_f32 v36, v36, v29, v28
    v_mfma_f32_32x32x16_bf16 v[208:223], v[148:151], v[132:135], v[208:223]
    v_fma_f32 v37, v37, v29, v28
    v_cvt_pk_bf16_f32 v87, v36, v37
    ds_write_b128 v14, v[84:87] offset:51712
    v_lshlrev_b32 v36, 16, v88
    v_and_b32 v37, 0xffff0000, v88
    v_fma_f32 v36, v36, v31, v30
    v_fma_f32 v37, v37, v31, v30
    v_cvt_pk_bf16_f32 v88, v36, v37
    v_mfma_f32_32x32x16_bf16 v[224:239], v[152:155], v[132:135], v[224:239]
    v_lshlrev_b32 v36, 16, v89
    v_and_b32 v37, 0xffff0000, v89
    v_fma_f32 v36, v36, v31, v30
    v_fma_f32 v37, v37, v31, v30
    v_cvt_pk_bf16_f32 v89, v36, v37
    v_lshlrev_b32 v36, 16, v90
    v_and_b32 v37, 0xffff0000, v90
    v_fma_f32 v36, v36, v31, v30
    v_mfma_f32_32x32x16_bf16 v[240:255], v[132:135], v[156:159], v[240:255]
    v_fma_f32 v37, v37, v31, v30
    v_cvt_pk_bf16_f32 v90, v36, v37
    v_lshlrev_b32 v36, 16, v91
    v_and_b32 v37, 0xffff0000, v91
    v_fma_f32 v36, v36, v31, v30
    v_fma_f32 v37, v37, v31, v30
    v_cvt_pk_bf16_f32 v91, v36, v37
    ds_write_b128 v14, v[88:91] offset:56320
    s_waitcnt lgkmcnt(2)
    v_mfma_f32_32x32x16_bf16 v[160:175], v[136:139], v[120:123], v[160:175]
    ds_read_b128 v[128:131], v22 offset:96
    ds_read_b128 v[132:135], v22 offset:4704
    ds_read_b64_tr_b16 v[148:149], v23 offset:21504
    ds_read_b64_tr_b16 v[150:151], v23 offset:23296
    ds_read_b64_tr_b16 v[152:153], v23 offset:21632
    ds_read_b64_tr_b16 v[154:155], v23 offset:23424
    v_mfma_f32_32x32x16_bf16 v[176:191], v[140:143], v[120:123], v[176:191]
    ds_read_b64_tr_b16 v[156:157], v23 offset:21760
    ds_read_b64_tr_b16 v[158:159], v23 offset:23552
    v_lshlrev_b32 v36, 16, v92
    v_and_b32 v37, 0xffff0000, v92
    v_fma_f32 v36, v36, v33, v32
    v_fma_f32 v37, v37, v33, v32
    v_mfma_f32_32x32x16_bf16 v[192:207], v[120:123], v[144:147], v[192:207]
    v_cvt_pk_bf16_f32 v92, v36, v37
    v_lshlrev_b32 v36, 16, v93
    v_and_b32 v37, 0xffff0000, v93
    v_fma_f32 v36, v36, v33, v32
    v_fma_f32 v37, v37, v33, v32
    v_cvt_pk_bf16_f32 v93, v36, v37
    v_mfma_f32_32x32x16_bf16 v[208:223], v[136:139], v[124:127], v[208:223]
    v_lshlrev_b32 v36, 16, v94
    v_and_b32 v37, 0xffff0000, v94
    v_fma_f32 v36, v36, v33, v32
    v_fma_f32 v37, v37, v33, v32
    v_cvt_pk_bf16_f32 v94, v36, v37
    v_lshlrev_b32 v36, 16, v95
    v_mfma_f32_32x32x16_bf16 v[224:239], v[140:143], v[124:127], v[224:239]
    v_and_b32 v37, 0xffff0000, v95
    v_fma_f32 v36, v36, v33, v32
    v_fma_f32 v37, v37, v33, v32
    v_cvt_pk_bf16_f32 v95, v36, v37
    ds_write_b128 v14, v[92:95] offset:60928
    ds_write_b128 v15, v[96:99] offset:47104
    v_mfma_f32_32x32x16_bf16 v[240:255], v[124:127], v[144:147], v[240:255]
    ds_write_b128 v15, v[100:103] offset:47232
    ds_write_b128 v15, v[104:107] offset:47360
    ds_write_b128 v15, v[108:111] offset:61440
    ds_write_b128 v15, v[112:115] offset:61568
    ds_write_b128 v15, v[116:119] offset:61696
    s_waitcnt lgkmcnt(0)
    s_barrier
    s_waitcnt lgkmcnt(7)
    v_mfma_f32_32x32x16_bf16 v[160:175], v[148:151], v[128:131], v[160:175]
    ds_read_b128 v[120:123], v24 offset:0
    ds_read_b128 v[124:127], v24 offset:4608
    v_mfma_f32_32x32x16_bf16 v[176:191], v[152:155], v[128:131], v[176:191]
    ds_read_b64_tr_b16 v[136:137], v25 offset:0
    ds_read_b64_tr_b16 v[138:139], v25 offset:1792
    v_mfma_f32_32x32x16_bf16 v[192:207], v[128:131], v[156:159], v[192:207]
    ds_read_b64_tr_b16 v[140:141], v25 offset:128
    v_mfma_f32_32x32x16_bf16 v[208:223], v[148:151], v[132:135], v[208:223]
    ds_read_b64_tr_b16 v[142:143], v25 offset:1920
    v_mfma_f32_32x32x16_bf16 v[224:239], v[152:155], v[132:135], v[224:239]
    ds_read_b64_tr_b16 v[144:145], v25 offset:256
    v_mfma_f32_32x32x16_bf16 v[240:255], v[132:135], v[156:159], v[240:255]
    ds_read_b64_tr_b16 v[146:147], v25 offset:2048
    s_waitcnt lgkmcnt(0)
    v_mfma_f32_32x32x16_bf16 v[160:175], v[136:139], v[120:123], v[160:175]
    ds_read_b128 v[128:131], v24 offset:32
    ds_read_b128 v[132:135], v24 offset:4640
    ds_read_b64_tr_b16 v[148:149], v25 offset:7168
    ds_read_b64_tr_b16 v[150:151], v25 offset:8960
    ds_read_b64_tr_b16 v[152:153], v25 offset:7296
    ds_read_b64_tr_b16 v[154:155], v25 offset:9088
    ds_read_b64_tr_b16 v[156:157], v25 offset:7424
    ds_read_b64_tr_b16 v[158:159], v25 offset:9216
    v_mfma_f32_32x32x16_bf16 v[176:191], v[140:143], v[120:123], v[176:191]
    global_load_dwordx4 v[80:83], v4, s[4:5]
    global_load_dwordx4 v[84:87], v5, s[4:5]
    global_load_dwordx4 v[88:91], v6, s[4:5]
    global_load_dwordx4 v[92:95], v7, s[4:5]
    global_load_dwordx4 v[96:99], v8, s[6:7]
    global_load_dwordx4 v[100:103], v9, s[6:7]
    global_load_dwordx4 v[104:107], v10, s[6:7]
    global_load_dwordx4 v[108:111], v11, s[6:7]
    v_mfma_f32_32x32x16_bf16 v[192:207], v[120:123], v[144:147], v[192:207]
    global_load_dwordx4 v[112:115], v12, s[6:7]
    global_load_dwordx4 v[116:119], v13, s[6:7]
    s_add_u32 s4, s4, 128
    s_addc_u32 s5, s5, 0
    s_add_u32 s6, s6, 393216
    s_addc_u32 s7, s7, 0
    s_waitcnt vmcnt(10)
    v_mfma_f32_32x32x16_bf16 v[208:223], v[136:139], v[124:127], v[208:223]
    v_lshlrev_b32 v36, 16, v40
    v_and_b32 v37, 0xffff0000, v40
    v_fma_f32 v36, v36, v27, v26
    v_fma_f32 v37, v37, v27, v26
    v_cvt_pk_bf16_f32 v40, v36, v37
    v_lshlrev_b32 v36, 16, v41
    v_and_b32 v37, 0xffff0000, v41
    v_mfma_f32_32x32x16_bf16 v[224:239], v[140:143], v[124:127], v[224:239]
    v_fma_f32 v36, v36, v27, v26
    v_fma_f32 v37, v37, v27, v26
    v_cvt_pk_bf16_f32 v41, v36, v37
    v_lshlrev_b32 v36, 16, v42
    v_and_b32 v37, 0xffff0000, v42
    v_fma_f32 v36, v36, v27, v26
    v_fma_f32 v37, v37, v27, v26
    v_mfma_f32_32x32x16_bf16 v[240:255], v[124:127], v[144:147], v[240:255]
    v_cvt_pk_bf16_f32 v42, v36, v37
    v_lshlrev_b32 v36, 16, v43
    v_and_b32 v37, 0xffff0000, v43
    v_fma_f32 v36, v36, v27, v26
    v_fma_f32 v37, v37, v27, v26
    v_cvt_pk_bf16_f32 v43, v36, v37
    ds_write_b128 v14, v[40:43] offset:0
    s_waitcnt lgkmcnt(1)
    v_mfma_f32_32x32x16_bf16 v[160:175], v[148:151], v[128:131], v[160:175]
    ds_read_b128 v[120:123], v24 offset:64
    ds_read_b128 v[124:127], v24 offset:4672
    ds_read_b64_tr_b16 v[136:137], v25 offset:14336
    ds_read_b64_tr_b16 v[138:139], v25 offset:16128
    ds_read_b64_tr_b16 v[140:141], v25 offset:14464
    ds_read_b64_tr_b16 v[142:143], v25 offset:16256
    ds_read_b64_tr_b16 v[144:145], v25 offset:14592
    ds_read_b64_tr_b16 v[146:147], v25 offset:16384
    v_lshlrev_b32 v36, 16, v44
    v_mfma_f32_32x32x16_bf16 v[176:191], v[152:155], v[128:131], v[176:191]
    v_and_b32 v37, 0xffff0000, v44
    v_fma_f32 v36, v36, v29, v28
    v_fma_f32 v37, v37, v29, v28
    v_cvt_pk_bf16_f32 v44, v36, v37
    v_lshlrev_b32 v36, 16, v45
    v_and_b32 v37, 0xffff0000, v45
    v_fma_f32 v36, v36, v29, v28
    v_fma_f32 v37, v37, v29, v28
    v_cvt_pk_bf16_f32 v45, v36, v37
    v_mfma_f32_32x32x16_bf16 v[192:207], v[128:131], v[156:159], v[192:207]
    v_lshlrev_b32 v36, 16, v46
    v_and_b32 v37, 0xffff0000, v46
    v_fma_f32 v36, v36, v29, v28
    v_fma_f32 v37, v37, v29, v28
    v_cvt_pk_bf16_f32 v46, v36, v37
    v_lshlrev_b32 v36, 16, v47
    v_and_b32 v37, 0xffff0000, v47
    v_fma_f32 v36, v36, v29, v28
    v_mfma_f32_32x32x16_bf16 v[208:223], v[148:151], v[132:135], v[208:223]
    v_fma_f32 v37, v37, v29, v28
    v_cvt_pk_bf16_f32 v47, v36, v37
    ds_write_b128 v14, v[44:47] offset:4608
    v_lshlrev_b32 v36, 16, v48
    v_and_b32 v37, 0xffff0000, v48
    v_fma_f32 v36, v36, v31, v30
    v_fma_f32 v37, v37, v31, v30
    v_cvt_pk_bf16_f32 v48, v36, v37
    v_mfma_f32_32x32x16_bf16 v[224:239], v[152:155], v[132:135], v[224:239]
    v_lshlrev_b32 v36, 16, v49
    v_and_b32 v37, 0xffff0000, v49
    v_fma_f32 v36, v36, v31, v30
    v_fma_f32 v37, v37, v31, v30
    v_cvt_pk_bf16_f32 v49, v36, v37
    v_lshlrev_b32 v36, 16, v50
    v_and_b32 v37, 0xffff0000, v50
    v_fma_f32 v36, v36, v31, v30
    v_mfma_f32_32x32x16_bf16 v[240:255], v[132:135], v[156:159], v[240:255]
    v_fma_f32 v37, v37, v31, v30
    v_cvt_pk_bf16_f32 v50, v36, v37
    v_lshlrev_b32 v36, 16, v51
    v_and_b32 v37, 0xffff0000, v51
    v_fma_f32 v36, v36, v31, v30
    v_fma_f32 v37, v37, v31, v30
    v_cvt_pk_bf16_f32 v51, v36, v37
    ds_write_b128 v14, v[48:51] offset:9216
    s_waitcnt lgkmcnt(2)
    v_mfma_f32_32x32x16_bf16 v[160:175], v[136:139], v[120:123], v[160:175]
    ds_read_b128 v[128:131], v24 offset:96
    ds_read_b128 v[132:135], v24 offset:4704
    ds_read_b64_tr_b16 v[148:149], v25 offset:21504
    ds_read_b64_tr_b16 v[150:151], v25 offset:23296
    ds_read_b64_tr_b16 v[152:153], v25 offset:21632
    ds_read_b64_tr_b16 v[154:155], v25 offset:23424
    v_mfma_f32_32x32x16_bf16 v[176:191], v[140:143], v[120:123], v[176:191]
    ds_read_b64_tr_b16 v[156:157], v25 offset:21760
    ds_read_b64_tr_b16 v[158:159], v25 offset:23552
    v_lshlrev_b32 v36, 16, v52
    v_and_b32 v37, 0xffff0000, v52
    v_fma_f32 v36, v36, v33, v32
    v_fma_f32 v37, v37, v33, v32
    v_mfma_f32_32x32x16_bf16 v[192:207], v[120:123], v[144:147], v[192:207]
    v_cvt_pk_bf16_f32 v52, v36, v37
    v_lshlrev_b32 v36, 16, v53
    v_and_b32 v37, 0xffff0000, v53
    v_fma_f32 v36, v36, v33, v32
    v_fma_f32 v37, v37, v33, v32
    v_cvt_pk_bf16_f32 v53, v36, v37
    v_mfma_f32_32x32x16_bf16 v[208:223], v[136:139], v[124:127], v[208:223]
    v_lshlrev_b32 v36, 16, v54
    v_and_b32 v37, 0xffff0000, v54
    v_fma_f32 v36, v36, v33, v32
    v_fma_f32 v37, v37, v33, v32
    v_cvt_pk_bf16_f32 v54, v36, v37
    v_lshlrev_b32 v36, 16, v55
    v_mfma_f32_32x32x16_bf16 v[224:239], v[140:143], v[124:127], v[224:239]
    v_and_b32 v37, 0xffff0000, v55
    v_fma_f32 v36, v36, v33, v32
    v_fma_f32 v37, v37, v33, v32
    v_cvt_pk_bf16_f32 v55, v36, v37
    ds_write_b128 v14, v[52:55] offset:13824
    ds_write_b128 v15, v[56:59] offset:0
    v_mfma_f32_32x32x16_bf16 v[240:255], v[124:127], v[144:147], v[240:255]
    ds_write_b128 v15, v[60:63] offset:128
    ds_write_b128 v15, v[64:67] offset:256
    ds_write_b128 v15, v[68:71] offset:14336
    ds_write_b128 v15, v[72:75] offset:14464
    ds_write_b128 v15, v[76:79] offset:14592
    s_waitcnt lgkmcnt(0)
    s_barrier
    s_waitcnt lgkmcnt(7)
    v_mfma_f32_32x32x16_bf16 v[160:175], v[148:151], v[128:131], v[160:175]
    ds_read_b128 v[120:123], v22 offset:0
    ds_read_b128 v[124:127], v22 offset:4608
    v_mfma_f32_32x32x16_bf16 v[176:191], v[152:155], v[128:131], v[176:191]
    ds_read_b64_tr_b16 v[136:137], v23 offset:0
    ds_read_b64_tr_b16 v[138:139], v23 offset:1792
    v_mfma_f32_32x32x16_bf16 v[192:207], v[128:131], v[156:159], v[192:207]
    ds_read_b64_tr_b16 v[140:141], v23 offset:128
    v_mfma_f32_32x32x16_bf16 v[208:223], v[148:151], v[132:135], v[208:223]
    ds_read_b64_tr_b16 v[142:143], v23 offset:1920
    v_mfma_f32_32x32x16_bf16 v[224:239], v[152:155], v[132:135], v[224:239]
    ds_read_b64_tr_b16 v[144:145], v23 offset:256
    v_mfma_f32_32x32x16_bf16 v[240:255], v[132:135], v[156:159], v[240:255]
    ds_read_b64_tr_b16 v[146:147], v23 offset:2048
    s_add_u32 s20, s20, 2
    s_cmp_lt_u32 s20, 14
    s_cbranch_scc1 L_qkv3_loop
    s_waitcnt lgkmcnt(0)
    v_mfma_f32_32x32x16_bf16 v[160:175], v[136:139], v[120:123], v[160:175]
    ds_read_b128 v[128:131], v22 offset:32
    ds_read_b128 v[132:135], v22 offset:4640
    ds_read_b64_tr_b16 v[148:149], v23 offset:7168
    ds_read_b64_tr_b16 v[150:151], v23 offset:8960
    ds_read_b64_tr_b16 v[152:153], v23 offset:7296
    v_mfma_f32_32x32x16_bf16 v[176:191], v[140:143], v[120:123], v[176:191]
    ds_read_b64_tr_b16 v[154:155], v23 offset:9088
    ds_read_b64_tr_b16 v[156:157], v23 offset:7424
    ds_read_b64_tr_b16 v[158:159], v23 offset:9216
    s_waitcnt vmcnt(0)
    v_lshlrev_b32 v36, 16, v80
    v_mfma_f32_32x32x16_bf16 v[192:207], v[120:123], v[144:147], v[192:207]
    v_and_b32 v37, 0xffff0000, v80
    v_fma_f32 v36, v36, v27, v26
    v_fma_f32 v37, v37, v27, v26
    v_cvt_pk_bf16_f32 v80, v36, v37
    v_lshlrev_b32 v36, 16, v81
    v_mfma_f32_32x32x16_bf16 v[208:223], v[136:139], v[124:127], v[208:223]
    v_and_b32 v37, 0xffff0000, v81
    v_fma_f32 v36, v36, v27, v26
    v_fma_f32 v37, v37, v27, v26
    v_cvt_pk_bf16_f32 v81, v36, v37
    v_lshlrev_b32 v36, 16, v82
    v_mfma_f32_32x32x16_bf16 v[224:239], v[140:143], v[124:127], v[224:239]
    v_and_b32 v37, 0xffff0000, v82
    v_fma_f32 v36, v36, v27, v26
    v_fma_f32 v37, v37, v27, v26
    v_cvt_pk_bf16_f32 v82, v36, v37
    v_lshlrev_b32 v36, 16, v83
    v_mfma_f32_32x32x16_bf16 v[240:255], v[124:127], v[144:147], v[240:255]
    v_and_b32 v37, 0xffff0000, v83
    v_fma_f32 v36, v36, v27, v26
    v_fma_f32 v37, v37, v27, v26
    v_cvt_pk_bf16_f32 v83, v36, v37
    ds_write_b128 v14, v[80:83] offset:47104
    s_waitcnt lgkmcnt(1)
    v_mfma_f32_32x32x16_bf16 v[160:175], v[148:151], v[128:131], v[160:175]
    ds_read_b128 v[120:123], v22 offset:64
    ds_read_b128 v[124:127], v22 offset:4672
    ds_read_b64_tr_b16 v[136:137], v23 offset:14336
    ds_read_b64_tr_b16 v[138:139], v23 offset:16128
    ds_read_b64_tr_b16 v[140:141], v23 offset:14464
    ds_read_b64_tr_b16 v[142:143], v23 offset:16256
    ds_read_b64_tr_b16 v[144:145], v23 offset:14592
    ds_read_b64_tr_b16 v[146:147], v23 offset:16384
    v_lshlrev_b32 v36, 16, v84
    v_mfma_f32_32x32x16_bf16 v[176:191], v[152:155], v[128:131], v[176:191]
    v_and_b32 v37, 0xffff0000, v84
    v_fma_f32 v36, v36, v29, v28
    v_fma_f32 v37, v37, v29, v28
    v_cvt_pk_bf16_f32 v84, v36, v37
    v_lshlrev_b32 v36, 16, v85
    v_and_b32 v37, 0xffff0000, v85
    v_fma_f32 v36, v36, v29, v28
    v_fma_f32 v37, v37, v29, v28
    v_cvt_pk_bf16_f32 v85, v36, v37
    v_mfma_f32_32x32x16_bf16 v[192:207], v[128:131], v[156:159], v[192:207]
    v_lshlrev_b32 v36, 16, v86
    v_and_b32 v37, 0xffff0000, v86
    v_fma_f32 v36, v36, v29, v28
    v_fma_f32 v37, v37, v29, v28
    v_cvt_pk_bf16_f32 v86, v36, v37
    v_lshlrev_b32 v36, 16, v87
    v_and_b32 v37, 0xffff0000, v87
    v_fma_f32 v36, v36, v29, v28
    v_mfma_f32_32x32x16_bf16 v[208:223], v[148:151], v[132:135], v[208:223]
    v_fma_f32 v37, v37, v29, v28
    v_cvt_pk_bf16_f32 v87, v36, v37
    ds_write_b128 v14, v[84:87] offset:51712
    v_lshlrev_b32 v36, 16, v88
    v_and_b32 v37, 0xffff0000, v88
    v_fma_f32 v36, v36, v31, v30
    v_fma_f32 v37, v37, v31, v30
    v_cvt_pk_bf16_f32 v88, v36, v37
    v_mfma_f32_32x32x16_bf16 v[224:239], v[152:155], v[132:135], v[224:239]
    v_lshlrev_b32 v36, 16, v89
    v_and_b32 v37, 0xffff0000, v89
    v_fma_f32 v36, v36, v31, v30
    v_fma_f32 v37, v37, v31, v30
    v_cvt_pk_bf16_f32 v89, v36, v37
    v_lshlrev_b32 v36, 16, v90
    v_and_b32 v37, 0xffff0000, v90
    v_fma_f32 v36, v36, v31, v30
    v_mfma_f32_32x32x16_bf16 v[240:255], v[132:135], v[156:159], v[240:255]
    v_fma_f32 v37, v37, v31, v30
    v_cvt_pk_bf16_f32 v90, v36, v37
    v_lshlrev_b32 v36, 16, v91
    v_and_b32 v37, 0xffff0000, v91
    v_fma_f32 v36, v36, v31, v30
    v_fma_f32 v37, v37, v31, v30
    v_cvt_pk_bf16_f32 v91, v36, v37
    ds_write_b128 v14, v[88:91] offset:56320
    s_waitcnt lgkmcnt(2)
    v_mfma_f32_32x32x16_bf16 v[160:175], v[136:139], v[120:123], v[160:175]
    ds_read_b128 v[128:131], v22 offset:96
    ds_read_b128 v[132:135], v22 offset:4704
    ds_read_b64_tr_b16 v[148:149], v23 offset:21504
    ds_read_b64_tr_b16 v[150:151], v23 offset:23296
    ds_read_b64_tr_b16 v[152:153], v23 offset:21632
    ds_read_b64_tr_b16 v[154:155], v23 offset:23424
    v_mfma_f32_32x32x16_bf16 v[176:191], v[140:143], v[120:123], v[176:191]
    ds_read_b64_tr_b16 v[156:157], v23 offset:21760
    ds_read_b64_tr_b16 v[158:159], v23 offset:23552
    v_lshlrev_b32 v36, 16, v92
    v_and_b32 v37, 0xffff0000, v92
    v_fma_f32 v36, v36, v33, v32
    v_fma_f32 v37, v37, v33, v32
    v_mfma_f32_32x32x16_bf16 v[192:207], v[120:123], v[144:147], v[192:207]
    v_cvt_pk_bf16_f32 v92, v36, v37
    v_lshlrev_b32 v36, 16, v93
    v_and_b32 v37, 0xffff0000, v93
    v_fma_f32 v36, v36, v33, v32
    v_fma_f32 v37, v37, v33, v32
    v_cvt_pk_bf16_f32 v93, v36, v37
    v_mfma_f32_32x32x16_bf16 v[208:223], v[136:139], v[124:127], v[208:223]
    v_lshlrev_b32 v36, 16, v94
    v_and_b32 v37, 0xffff0000, v94
    v_fma_f32 v36, v36, v33, v32
    v_fma_f32 v37, v37, v33, v32
    v_cvt_pk_bf16_f32 v94, v36, v37
    v_lshlrev_b32 v36, 16, v95
    v_mfma_f32_32x32x16_bf16 v[224:239], v[140:143], v[124:127], v[224:239]
    v_and_b32 v37, 0xffff0000, v95
    v_fma_f32 v36, v36, v33, v32
    v_fma_f32 v37, v37, v33, v32
    v_cvt_pk_bf16_f32 v95, v36, v37
    ds_write_b128 v14, v[92:95] offset:60928
    ds_write_b128 v15, v[96:99] offset:47104
    v_mfma_f32_32x32x16_bf16 v[240:255], v[124:127], v[144:147], v[240:255]
    ds_write_b128 v15, v[100:103] offset:47232
    ds_write_b128 v15, v[104:107] offset:47360
    ds_write_b128 v15, v[108:111] offset:61440
    ds_write_b128 v15, v[112:115] offset:61568
    ds_write_b128 v15, v[116:119] offset:61696
    s_waitcnt lgkmcnt(0)
    s_barrier
    s_waitcnt lgkmcnt(7)
    v_mfma_f32_32x32x16_bf16 v[160:175], v[148:151], v[128:131], v[160:175]
    ds_read_b128 v[120:123], v24 offset:0
    ds_read_b128 v[124:127], v24 offset:4608
    v_mfma_f32_32x32x16_bf16 v[176:191], v[152:155], v[128:131], v[176:191]
    ds_read_b64_tr_b16 v[136:137], v25 offset:0
    ds_read_b64_tr_b16 v[138:139], v25 offset:1792
    v_mfma_f32_32x32x16_bf16 v[192:207], v[128:131], v[156:159], v[192:207]
    ds_read_b64_tr_b16 v[140:141], v25 offset:128
    v_mfma_f32_32x32x16_bf16 v[208:223], v[148:151], v[132:135], v[208:223]
    ds_read_b64_tr_b16 v[142:143], v25 offset:1920
    v_mfma_f32_32x32x16_bf16 v[224:239], v[152:155], v[132:135], v[224:239]
    ds_read_b64_tr_b16 v[144:145], v25 offset:256
    v_mfma_f32_32x32x16_bf16 v[240:255], v[132:135], v[156:159], v[240:255]
    ds_read_b64_tr_b16 v[146:147], v25 offset:2048
    s_waitcnt lgkmcnt(0)
    v_mfma_f32_32x32x16_bf16 v[160:175], v[136:139], v[120:123], v[160:175]
    ds_read_b128 v[128:131], v24 offset:32
    ds_read_b128 v[132:135], v24 offset:4640
    v_mfma_f32_32x32x16_bf16 v[176:191], v[140:143], v[120:123], v[176:191]
    ds_read_b64_tr_b16 v[148:149], v25 offset:7168
    ds_read_b64_tr_b16 v[150:151], v25 offset:8960
    v_mfma_f32_32x32x16_bf16 v[192:207], v[120:123], v[144:147], v[192:207]
    ds_read_b64_tr_b16 v[152:153], v25 offset:7296
    v_mfma_f32_32x32x16_bf16 v[208:223], v[136:139], v[124:127], v[208:223]
    ds_read_b64_tr_b16 v[154:155], v25 offset:9088
    v_mfma_f32_32x32x16_bf16 v[224:239], v[140:143], v[124:127], v[224:239]
    ds_read_b64_tr_b16 v[156:157], v25 offset:7424
    v_mfma_f32_32x32x16_bf16 v[240:255], v[124:127], v[144:147], v[240:255]
    ds_read_b64_tr_b16 v[158:159], v25 offset:9216
    s_waitcnt lgkmcnt(0)
    v_mfma_f32_32x32x16_bf16 v[160:175], v[148:151], v[128:131], v[160:175]
    ds_read_b128 v[120:123], v24 offset:64
    ds_read_b128 v[124:127], v24 offset:4672
    v_mfma_f32_32x32x16_bf16 v[176:191], v[152:155], v[128:131], v[176:191]
    ds_read_b64_tr_b16 v[136:137], v25 offset:14336
    ds_read_b64_tr_b16 v[138:139], v25 offset:16128
    v_mfma_f32_32x32x16_bf16 v[192:207], v[128:131], v[156:159], v[192:207]
    ds_read_b64_tr_b16 v[140:141], v25 offset:14464
    v_mfma_f32_32x32x16_bf16 v[208:223], v[148:151], v[132:135], v[208:223]
    ds_read_b64_tr_b16 v[142:143], v25 offset:16256
    v_mfma_f32_32x32x16_bf16 v[224:239], v[152:155], v[132:135], v[224:239]
    ds_read_b64_tr_b16 v[144:145], v25 offset:14592
    v_mfma_f32_32x32x16_bf16 v[240:255], v[132:135], v[156:159], v[240:255]
    ds_read_b64_tr_b16 v[146:147], v25 offset:16384
    s_waitcnt lgkmcnt(0)
    v_mfma_f32_32x32x16_bf16 v[160:175], v[136:139], v[120:123], v[160:175]
    ds_read_b128 v[128:131], v24 offset:96
    ds_read_b128 v[132:135], v24 offset:4704
    v_mfma_f32_32x32x16_bf16 v[176:191], v[140:143], v[120:123], v[176:191]
    ds_read_b64_tr_b16 v[148:149], v25 offset:21504
    ds_read_b64_tr_b16 v[150:151], v25 offset:23296
    v_mfma_f32_32x32x16_bf16 v[192:207], v[120:123], v[144:147], v[192:207]
    ds_read_b64_tr_b16 v[152:153], v25 offset:21632
    v_mfma_f32_32x32x16_bf16 v[208:223], v[136:139], v[124:127], v[208:223]
    ds_read_b64_tr_b16 v[154:155], v25 offset:23424
    v_mfma_f32_32x32x16_bf16 v[224:239], v[140:143], v[124:127], v[224:239]
    ds_read_b64_tr_b16 v[156:157], v25 offset:21760
    v_mfma_f32_32x32x16_bf16 v[240:255], v[124:127], v[144:147], v[240:255]
    ds_read_b64_tr_b16 v[158:159], v25 offset:23552
    s_waitcnt lgkmcnt(0)
    v_mfma_f32_32x32x16_bf16 v[160:175], v[148:151], v[128:131], v[160:175]
    v_mfma_f32_32x32x16_bf16 v[176:191], v[152:155], v[128:131], v[176:191]
    v_mfma_f32_32x32x16_bf16 v[192:207], v[128:131], v[156:159], v[192:207]
    v_mfma_f32_32x32x16_bf16 v[208:223], v[148:151], v[132:135], v[208:223]
    v_mfma_f32_32x32x16_bf16 v[224:239], v[152:155], v[132:135], v[224:239]
    v_mfma_f32_32x32x16_bf16 v[240:255], v[132:135], v[156:159], v[240:255]
    s_nop 15
    s_nop 7
    s_load_dwordx2 s[14:15], s[0:1], 64
    s_waitcnt lgkmcnt(0)
    s_add_u32 s14, s14, 0
    s_addc_u32 s15, s15, 0
    s_barrier
    s_lshl_b32 s12, s9, 1
    v_add_u32 v26, s12, v19
    v_lshl_add_u32 v27, v18, 6, s10
    v_mul_u32_u24 v24, 15360, v17
    v_mul_u32_u24 v22, 80, v20
    v_add_u32 v22, v22, v24
    v_lshl_add_u32 v22, v21, 3, v22
    v_mul_u32_u24 v23, 144, v20
    v_add_u32 v23, v23, v24
    v_lshl_add_u32 v23, v21, 4, v23
    v_lshrrev_b32 v25, 2, v16
    v_mul_u32_u24 v25, 80, v25
    v_and_b32 v30, 3, v16
    v_lshl_add_u32 v25, v30, 4, v25
    v_add_u32 v25, v25, v24
    v_lshrrev_b32 v31, 3, v16
    v_mul_u32_u24 v31, 144, v31
    v_and_b32 v30, 7, v16
    v_lshl_add_u32 v31, v30, 4, v31
    v_add_u32 v31, v31, v24
    v_mov_b32 v15, v31
    v_lshlrev_b32 v28, 11, v26
    v_add_u32 v28, v28, v27
    v_lshlrev_b32 v28, 6, v28
    v_lshl_add_u32 v28, v16, 4, v28
    v_lshrrev_b32 v29, 5, v27
    v_lshl_add_u32 v29, v26, 6, v29
    v_bfe_u32 v30, v16, 2, 1
    v_add_u32 v29, v29, v30
    v_lshrrev_b32 v30, 3, v16
    v_lshl_add_u32 v29, v29, 5, v30
    v_lshlrev_b32 v29, 6, v29
    v_and_b32 v30, 3, v16
    v_lshl_add_u32 v29, v30, 4, v29
    v_cvt_pk_bf16_f32 v32, v160, v161
    v_cvt_pk_bf16_f32 v33, v162, v163
    v_cvt_pk_bf16_f32 v34, v164, v165
    v_cvt_pk_bf16_f32 v35, v166, v167
    v_cvt_pk_bf16_f32 v36, v168, v169
    v_cvt_pk_bf16_f32 v37, v170, v171
    v_cvt_pk_bf16_f32 v38, v172, v173
    v_cvt_pk_bf16_f32 v39, v174, v175
    ds_write_b64 v22, v[32:33] offset:0
    ds_write_b64 v22, v[34:35] offset:16
    ds_write_b64 v22, v[36:37] offset:32
    ds_write_b64 v22, v[38:39] offset:48
    v_cvt_pk_bf16_f32 v32, v208, v209
    v_cvt_pk_bf16_f32 v33, v210, v211
    v_cvt_pk_bf16_f32 v34, v212, v213
    v_cvt_pk_bf16_f32 v35, v214, v215
    v_cvt_pk_bf16_f32 v36, v216, v217
    v_cvt_pk_bf16_f32 v37, v218, v219
    v_cvt_pk_bf16_f32 v38, v220, v221
    v_cvt_pk_bf16_f32 v39, v222, v223
    ds_write_b64 v22, v[32:33] offset:2560
    ds_write_b64 v22, v[34:35] offset:2576
    ds_write_b64 v22, v[36:37] offset:2592
    ds_write_b64 v22, v[38:39] offset:2608
    v_cvt_pk_bf16_f32 v32, v176, v177
    v_cvt_pk_bf16_f32 v33, v178, v179
    v_cvt_pk_bf16_f32 v34, v180, v181
    v_cvt_pk_bf16_f32 v35, v182, v183
    v_cvt_pk_bf16_f32 v36, v184, v185
    v_cvt_pk_bf16_f32 v37, v186, v187
    v_cvt_pk_bf16_f32 v38, v188, v189
    v_cvt_pk_bf16_f32 v39, v190, v191
    ds_write_b64 v22, v[32:33] offset:5120
    ds_write_b64 v22, v[34:35] offset:5136
    ds_write_b64 v22, v[36:37] offset:5152
    ds_write_b64 v22, v[38:39] offset:5168
    v_cvt_pk_bf16_f32 v32, v224, v225
    v_cvt_pk_bf16_f32 v33, v226, v227
    v_cvt_pk_bf16_f32 v34, v228, v229
    v_cvt_pk_bf16_f32 v35, v230, v231
    v_cvt_pk_bf16_f32 v36, v232, v233
    v_cvt_pk_bf16_f32 v37, v234, v235
    v_cvt_pk_bf16_f32 v38, v236, v237
    v_cvt_pk_bf16_f32 v39, v238, v239
    ds_write_b64 v22, v[32:33] offset:7680
    ds_write_b64 v22, v[34:35] offset:7696
    ds_write_b64 v22, v[36:37] offset:7712
    ds_write_b64 v22, v[38:39] offset:7728
    v_cvt_pk_bf16_f32 v32, v192, v193
    v_cvt_pk_bf16_f32 v33, v194, v195
    v_cvt_pk_bf16_f32 v34, v196, v197
    v_cvt_pk_bf16_f32 v35, v198, v199
    v_cvt_pk_bf16_f32 v36, v200, v201
    v_cvt_pk_bf16_f32 v37, v202, v203
    v_cvt_pk_bf16_f32 v38, v204, v205
    v_cvt_pk_bf16_f32 v39, v206, v207
    ds_write_b64 v23, v[32:33] offset:10240
    ds_write_b64 v23, v[34:35] offset:10248
    ds_write_b64 v23, v[36:37] offset:10272
    ds_write_b64 v23, v[38:39] offset:10280
    v_cvt_pk_bf16_f32 v32, v240, v241
    v_cvt_pk_bf16_f32 v33, v242, v243
    v_cvt_pk_bf16_f32 v34, v244, v245
    v_cvt_pk_bf16_f32 v35, v246, v247
    v_cvt_pk_bf16_f32 v36, v248, v249
    v_cvt_pk_bf16_f32 v37, v250, v251
    v_cvt_pk_bf16_f32 v38, v252, v253
    v_cvt_pk_bf16_f32 v39, v254, v255
    ds_write_b64 v23, v[32:33] offset:10304
    ds_write_b64 v23, v[34:35] offset:10312
    ds_write_b64 v23, v[36:37] offset:10336
    ds_write_b64 v23, v[38:39] offset:10344
    s_waitcnt lgkmcnt(0)
    ds_read_b128 v[40:43], v25 offset:0
    ds_read_b128 v[44:47], v25 offset:1280
    ds_read_b128 v[48:51], v25 offset:2560
    ds_read_b128 v[52:55], v25 offset:3840
    ds_read_b128 v[56:59], v25 offset:5120
    ds_read_b128 v[60:63], v25 offset:6400
    ds_read_b128 v[64:67], v25 offset:7680
    ds_read_b128 v[68:71], v25 offset:8960
    ds_read_b128 v[72:75], v15 offset:10240
    ds_read_b128 v[76:79], v15 offset:11392
    ds_read_b128 v[80:83], v15 offset:12544
    ds_read_b128 v[84:87], v15 offset:13696
    s_waitcnt lgkmcnt(8)
    v_add_u32 v30, 8388608, v28
    global_store_dwordx4 v30, v[40:43], s[14:15]
    v_add_u32 v30, 8389632, v28
    global_store_dwordx4 v30, v[44:47], s[14:15]
    v_add_u32 v30, 8390656, v28
    global_store_dwordx4 v30, v[48:51], s[14:15]
    v_add_u32 v30, 8391680, v28
    global_store_dwordx4 v30, v[52:55], s[14:15]
    s_waitcnt lgkmcnt(4)
    v_add_u32 v30, 12582912, v28
    global_store_dwordx4 v30, v[56:59], s[14:15]
    v_add_u32 v30, 12583936, v28
    global_store_dwordx4 v30, v[60:63], s[14:15]
    v_add_u32 v30, 12584960, v28
    global_store_dwordx4 v30, v[64:67], s[14:15]
    v_add_u32 v30, 12585984, v28
    global_store_dwordx4 v30, v[68:71], s[14:15]
    s_waitcnt lgkmcnt(0)
    v_add_u32 v30, 16777216, v29
    global_store_dwordx4 v30, v[72:75], s[14:15]
    v_add_u32 v30, 16777728, v29
    global_store_dwordx4 v30, v[76:79], s[14:15]
    v_add_u32 v30, 16778240, v29
    global_store_dwordx4 v30, v[80:83], s[14:15]
    v_add_u32 v30, 16778752, v29
    global_store_dwordx4 v30, v[84:87], s[14:15]
L_qkv3_end:
    s_endpgm
.globl wo3_kernel
.p2align 8
.type wo3_kernel,@function
wo3_kernel:
    s_cmp_ge_u32 s2, 256
    s_cbranch_scc1 L_wo3_end
    s_load_dwordx2 s[4:5], s[0:1], 64
    s_load_dwordx2 s[6:7], s[0:1], 40
    s_load_dwordx2 s[14:15], s[0:1], 64
    s_waitcnt lgkmcnt(0)
    s_add_u32 s4, s4, 20971520
    s_addc_u32 s5, s5, 0
    s_add_u32 s14, s14, 4194304
    s_addc_u32 s15, s15, 0
    s_lshr_b32 s8, s2, 4
    s_and_b32 s9, s2, 15
    v_lshrrev_b32 v1, 3, v0
    v_and_b32 v2, 7, v0
    s_lshl_b32 s10, s8, 7
    v_add_u32 v3, s10, v1
    v_lshlrev_b32 v3, 11, v3
    v_lshl_add_u32 v3, v2, 4, v3
    v_add_u32 v4, 0, v3
    v_add_u32 v5, 65536, v3
    v_add_u32 v6, 131072, v3
    v_add_u32 v7, 196608, v3
    s_mov_b32 s11, 2048
    v_mul_lo_u32 v3, v1, s11
    v_lshl_add_u32 v3, v2, 4, v3
    s_lshl_b32 s12, s9, 7
    v_add_u32 v3, s12, v3
    v_add_u32 v8, 0, v3
    v_add_u32 v9, 65536, v3
    v_mul_u32_u24 v14, 144, v1
    v_lshl_add_u32 v14, v2, 4, v14
    v_mul_u32_u24 v15, 192, v1
    v_lshl_add_u32 v15, v2, 4, v15
    v_add_u32 v15, 18432, v15
    v_and_b32 v16, 63, v0
    v_lshrrev_b32 v17, 6, v0
    v_lshrrev_b32 v18, 1, v17
    v_and_b32 v19, 1, v17
    v_and_b32 v20, 31, v16
    v_lshrrev_b32 v21, 5, v16
    v_lshl_add_u32 v22, v18, 6, v20
    v_mul_u32_u24 v22, 144, v22
    v_lshl_add_u32 v22, v21, 4, v22
    v_bfe_u32 v23, v16, 2, 2
    v_lshl_add_u32 v23, v21, 3, v23
    v_mul_u32_u24 v23, 192, v23
    v_bfe_u32 v24, v16, 4, 1
    v_lshlrev_b32 v24, 5, v24
    v_lshl_add_u32 v24, v19, 6, v24
    v_and_b32 v25, 3, v16
    v_lshl_add_u32 v24, v25, 3, v24
    v_add_u32 v23, v23, v24
    v_add_u32 v23, 18432, v23
    v_add_u32 v24, 30720, v22
    v_add_u32 v25, 30720, v23
    v_mov_b32 v160, 0
    v_mov_b32 v161, 0
    v_mov_b32 v162, 0
    v_mov_b32 v163, 0
    v_mov_b32 v164, 0
    v_mov_b32 v165, 0
    v_mov_b32 v166, 0
    v_mov_b32 v167, 0
    v_mov_b32 v168, 0
    v_mov_b32 v169, 0
    v_mov_b32 v170, 0
    v_mov_b32 v171, 0
    v_mov_b32 v172, 0
    v_mov_b32 v173, 0
    v_mov_b32 v174, 0
    v_mov_b32 v175, 0
    v_mov_b32 v176, 0
    v_mov_b32 v177, 0
    v_mov_b32 v178, 0
    v_mov_b32 v179, 0
    v_mov_b32 v180, 0
    v_mov_b32 v181, 0
    v_mov_b32 v182, 0
    v_mov_b32 v183, 0
    v_mov_b32 v184, 0
    v_mov_b32 v185, 0
    v_mov_b32 v186, 0
    v_mov_b32 v187, 0
    v_mov_b32 v188, 0
    v_mov_b32 v189, 0
    v_mov_b32 v190, 0
    v_mov_b32 v191, 0
    global_load_dwordx4 v[40:43], v4, s[4:5]
    global_load_dwordx4 v[44:47], v5, s[4:5]
    global_load_dwordx4 v[48:51], v6, s[4:5]
    global_load_dwordx4 v[52:55], v7, s[4:5]
    global_load_dwordx4 v[56:59], v8, s[6:7]
    global_load_dwordx4 v[60:63], v9, s[6:7]
    s_add_u32 s4, s4, 128
    s_addc_u32 s5, s5, 0
    s_add_u32 s6, s6, 131072
    s_addc_u32 s7, s7, 0
    global_load_dwordx4 v[64:67], v4, s[4:5]
    global_load_dwordx4 v[68:71], v5, s[4:5]
    global_load_dwordx4 v[72:75], v6, s[4:5]
    global_load_dwordx4 v[76:79], v7, s[4:5]
    global_load_dwordx4 v[80:83], v8, s[6:7]
    global_load_dwordx4 v[84:87], v9, s[6:7]
    s_add_u32 s4, s4, 128
    s_addc_u32 s5, s5, 0
    s_add_u32 s6, s6, 131072
    s_addc_u32 s7, s7, 0
    global_load_dwordx4 v[88:91], v4, s[4:5]
    global_load_dwordx4 v[92:95], v5, s[4:5]
    global_load_dwordx4 v[96:99], v6, s[4:5]
    global_load_dwordx4 v[100:103], v7, s[4:5]
    global_load_dwordx4 v[104:107], v8, s[6:7]
    global_load_dwordx4 v[108:111], v9, s[6:7]
    s_add_u32 s4, s4, 128
    s_addc_u32 s5, s5, 0
    s_add_u32 s6, s6, 131072
    s_addc_u32 s7, s7, 0
    global_load_dwordx4 v[112:115], v4, s[4:5]
    global_load_dwordx4 v[116:119], v5, s[4:5]
    global_load_dwordx4 v[120:123], v6, s[4:5]
    global_load_dwordx4 v[124:127], v7, s[4:5]
    global_load_dwordx4 v[128:131], v8, s[6:7]
    global_load_dwordx4 v[132:135], v9, s[6:7]
    s_add_u32 s4, s4, 128
    s_addc_u32 s5, s5, 0
    s_add_u32 s6, s6, 131072
    s_addc_u32 s7, s7, 0
    s_waitcnt vmcnt(18)
    ds_write_b128 v14, v[40:43] offset:0
    ds_write_b128 v14, v[44:47] offset:4608
    ds_write_b128 v14, v[48:51] offset:9216
    ds_write_b128 v14, v[52:55] offset:13824
    ds_write_b128 v15, v[56:59] offset:0
    ds_write_b128 v15, v[60:63] offset:6144
    s_waitcnt lgkmcnt(0)
    s_barrier
    ds_read_b128 v[208:211], v22 offset:0
    ds_read_b128 v[212:215], v22 offset:4608
    ds_read_b64_tr_b16 v[192:193], v23 offset:0
    ds_read_b64_tr_b16 v[194:195], v23 offset:768
    ds_read_b128 v[216:219], v22 offset:32
    ds_read_b128 v[220:223], v22 offset:4640
    ds_read_b64_tr_b16 v[196:197], v23 offset:3072
    ds_read_b64_tr_b16 v[198:199], v23 offset:3840
    ds_read_b128 v[224:227], v22 offset:64
    ds_read_b128 v[228:231], v22 offset:4672
    ds_read_b64_tr_b16 v[200:201], v23 offset:6144
    ds_read_b64_tr_b16 v[202:203], v23 offset:6912
    ds_read_b128 v[232:235], v22 offset:96
    ds_read_b128 v[236:239], v22 offset:4704
    ds_read_b64_tr_b16 v[204:205], v23 offset:9216
    ds_read_b64_tr_b16 v[206:207], v23 offset:9984
    s_mov_b32 s20, 0
L_wo3_loop:
    s_waitcnt lgkmcnt(12)
    v_mfma_f32_32x32x16_bf16 v[160:175], v[192:195], v[208:211], v[160:175]
    global_load_dwordx4 v[40:43], v4, s[4:5]
    global_load_dwordx4 v[44:47], v5, s[4:5]
    global_load_dwordx4 v[48:51], v6, s[4:5]
    v_mfma_f32_32x32x16_bf16 v[176:191], v[192:195], v[212:215], v[176:191]
    global_load_dwordx4 v[52:55], v7, s[4:5]
    global_load_dwordx4 v[56:59], v8, s[6:7]
    s_waitcnt lgkmcnt(8)
    v_mfma_f32_32x32x16_bf16 v[160:175], v[196:199], v[216:219], v[160:175]
    global_load_dwordx4 v[60:63], v9, s[6:7]
    s_add_u32 s4, s4, 128
    v_mfma_f32_32x32x16_bf16 v[176:191], v[196:199], v[220:223], v[176:191]
    s_addc_u32 s5, s5, 0
    s_add_u32 s6, s6, 131072
    s_waitcnt lgkmcnt(4)
    v_mfma_f32_32x32x16_bf16 v[160:175], v[200:203], v[224:227], v[160:175]
    s_addc_u32 s7, s7, 0
    s_waitcnt vmcnt(18)
    v_mfma_f32_32x32x16_bf16 v[176:191], v[200:203], v[228:231], v[176:191]
    ds_write_b128 v14, v[64:67] offset:30720
    ds_write_b128 v14, v[68:71] offset:35328
    s_waitcnt lgkmcnt(2)
    v_mfma_f32_32x32x16_bf16 v[160:175], v[204:207], v[232:235], v[160:175]
    ds_write_b128 v14, v[72:75] offset:39936
    ds_write_b128 v14, v[76:79] offset:44544
    v_mfma_f32_32x32x16_bf16 v[176:191], v[204:207], v[236:239], v[176:191]
    ds_write_b128 v15, v[80:83] offset:30720
    ds_write_b128 v15, v[84:87] offset:36864
    s_waitcnt lgkmcnt(0)
    s_barrier
    ds_read_b128 v[208:211], v24 offset:0
    ds_read_b128 v[212:215], v24 offset:4608
    ds_read_b64_tr_b16 v[192:193], v25 offset:0
    ds_read_b64_tr_b16 v[194:195], v25 offset:768
    ds_read_b128 v[216:219], v24 offset:32
    ds_read_b128 v[220:223], v24 offset:4640
    ds_read_b64_tr_b16 v[196:197], v25 offset:3072
    ds_read_b64_tr_b16 v[198:199], v25 offset:3840
    ds_read_b128 v[224:227], v24 offset:64
    ds_read_b128 v[228:231], v24 offset:4672
    ds_read_b64_tr_b16 v[200:201], v25 offset:6144
    ds_read_b64_tr_b16 v[202:203], v25 offset:6912
    ds_read_b128 v[232:235], v24 offset:96
    ds_read_b128 v[236:239], v24 offset:4704
    ds_read_b64_tr_b16 v[204:205], v25 offset:9216
    ds_read_b64_tr_b16 v[206:207], v25 offset:9984
    s_waitcnt lgkmcnt(12)
    v_mfma_f32_32x32x16_bf16 v[160:175], v[192:195], v[208:211], v[160:175]
    global_load_dwordx4 v[64:67], v4, s[4:5]
    global_load_dwordx4 v[68:71], v5, s[4:5]
    global_load_dwordx4 v[72:75], v6, s[4:5]
    v_mfma_f32_32x32x16_bf16 v[176:191], v[192:195], v[212:215], v[176:191]
    global_load_dwordx4 v[76:79], v7, s[4:5]
    global_load_dwordx4 v[80:83], v8, s[6:7]
    s_waitcnt lgkmcnt(8)
    v_mfma_f32_32x32x16_bf16 v[160:175], v[196:199], v[216:219], v[160:175]
    global_load_dwordx4 v[84:87], v9, s[6:7]
    s_add_u32 s4, s4, 128
    v_mfma_f32_32x32x16_bf16 v[176:191], v[196:199], v[220:223], v[176:191]
    s_addc_u32 s5, s5, 0
    s_add_u32 s6, s6, 131072
    s_waitcnt lgkmcnt(4)
    v_mfma_f32_32x32x16_bf16 v[160:175], v[200:203], v[224:227], v[160:175]
    s_addc_u32 s7, s7, 0
    s_waitcnt vmcnt(18)
    v_mfma_f32_32x32x16_bf16 v[176:191], v[200:203], v[228:231], v[176:191]
    ds_write_b128 v14, v[88:91] offset:0
    ds_write_b128 v14, v[92:95] offset:4608
    s_waitcnt lgkmcnt(2)
    v_mfma_f32_32x32x16_bf16 v[160:175], v[204:207], v[232:235], v[160:175]
    ds_write_b128 v14, v[96:99] offset:9216
    ds_write_b128 v14, v[100:103] offset:13824
    v_mfma_f32_32x32x16_bf16 v[176:191], v[204:207], v[236:239], v[176:191]
    ds_write_b128 v15, v[104:107] offset:0
    ds_write_b128 v15, v[108:111] offset:6144
    s_waitcnt lgkmcnt(0)
    s_barrier
    ds_read_b128 v[208:211], v22 offset:0
    ds_read_b128 v[212:215], v22 offset:4608
    ds_read_b64_tr_b16 v[192:193], v23 offset:0
    ds_read_b64_tr_b16 v[194:195], v23 offset:768
    ds_read_b128 v[216:219], v22 offset:32
    ds_read_b128 v[220:223], v22 offset:4640
    ds_read_b64_tr_b16 v[196:197], v23 offset:3072
    ds_read_b64_tr_b16 v[198:199], v23 offset:3840
    ds_read_b128 v[224:227], v22 offset:64
    ds_read_b128 v[228:231], v22 offset:4672
    ds_read_b64_tr_b16 v[200:201], v23 offset:6144
    ds_read_b64_tr_b16 v[202:203], v23 offset:6912
    ds_read_b128 v[232:235], v22 offset:96
    ds_read_b128 v[236:239], v22 offset:4704
    ds_read_b64_tr_b16 v[204:205], v23 offset:9216
    ds_read_b64_tr_b16 v[206:207], v23 offset:9984
    s_waitcnt lgkmcnt(12)
    v_mfma_f32_32x32x16_bf16 v[160:175], v[192:195], v[208:211], v[160:175]
    global_load_dwordx4 v[88:91], v4, s[4:5]
    global_load_dwordx4 v[92:95], v5, s[4:5]
    global_load_dwordx4 v[96:99], v6, s[4:5]
    v_mfma_f32_32x32x16_bf16 v[176:191], v[192:195], v[212:215], v[176:191]
    global_load_dwordx4 v[100:103], v7, s[4:5]
    global_load_dwordx4 v[104:107], v8, s[6:7]
    s_waitcnt lgkmcnt(8)
    v_mfma_f32_32x32x16_bf16 v[160:175], v[196:199], v[216:219], v[160:175]
    global_load_dwordx4 v[108:111], v9, s[6:7]
    s_add_u32 s4, s4, 128
    v_mfma_f32_32x32x16_bf16 v[176:191], v[196:199], v[220:223], v[176:191]
    s_addc_u32 s5, s5, 0
    s_add_u32 s6, s6, 131072
    s_waitcnt lgkmcnt(4)
    v_mfma_f32_32x32x16_bf16 v[160:175], v[200:203], v[224:227], v[160:175]
    s_addc_u32 s7, s7, 0
    s_waitcnt vmcnt(18)
    v_mfma_f32_32x32x16_bf16 v[176:191], v[200:203], v[228:231], v[176:191]
    ds_write_b128 v14, v[112:115] offset:30720
    ds_write_b128 v14, v[116:119] offset:35328
    s_waitcnt lgkmcnt(2)
    v_mfma_f32_32x32x16_bf16 v[160:175], v[204:207], v[232:235], v[160:175]
    ds_write_b128 v14, v[120:123] offset:39936
    ds_write_b128 v14, v[124:127] offset:44544
    v_mfma_f32_32x32x16_bf16 v[176:191], v[204:207], v[236:239], v[176:191]
    ds_write_b128 v15, v[128:131] offset:30720
    ds_write_b128 v15, v[132:135] offset:36864
    s_waitcnt lgkmcnt(0)
    s_barrier
    ds_read_b128 v[208:211], v24 offset:0
    ds_read_b128 v[212:215], v24 offset:4608
    ds_read_b64_tr_b16 v[192:193], v25 offset:0
    ds_read_b64_tr_b16 v[194:195], v25 offset:768
    ds_read_b128 v[216:219], v24 offset:32
    ds_read_b128 v[220:223], v24 offset:4640
    ds_read_b64_tr_b16 v[196:197], v25 offset:3072
    ds_read_b64_tr_b16 v[198:199], v25 offset:3840
    ds_read_b128 v[224:227], v24 offset:64
    ds_read_b128 v[228:231], v24 offset:4672
    ds_read_b64_tr_b16 v[200:201], v25 offset:6144
    ds_read_b64_tr_b16 v[202:203], v25 offset:6912
    ds_read_b128 v[232:235], v24 offset:96
    ds_read_b128 v[236:239], v24 offset:4704
    ds_read_b64_tr_b16 v[204:205], v25 offset:9216
    ds_read_b64_tr_b16 v[206:207], v25 offset:9984
    s_waitcnt lgkmcnt(12)
    v_mfma_f32_32x32x16_bf16 v[160:175], v[192:195], v[208:211], v[160:175]
    global_load_dwordx4 v[112:115], v4, s[4:5]
    global_load_dwordx4 v[116:119], v5, s[4:5]
    global_load_dwordx4 v[120:123], v6, s[4:5]
    v_mfma_f32_32x32x16_bf16 v[176:191], v[192:195], v[212:215], v[176:191]
    global_load_dwordx4 v[124:127], v7, s[4:5]
    global_load_dwordx4 v[128:131], v8, s[6:7]
    s_waitcnt lgkmcnt(8)
    v_mfma_f32_32x32x16_bf16 v[160:175], v[196:199], v[216:219], v[160:175]
    global_load_dwordx4 v[132:135], v9, s[6:7]
    s_add_u32 s4, s4, 128
    v_mfma_f32_32x32x16_bf16 v[176:191], v[196:199], v[220:223], v[176:191]
    s_addc_u32 s5, s5, 0
    s_add_u32 s6, s6, 131072
    s_waitcnt lgkmcnt(4)
    v_mfma_f32_32x32x16_bf16 v[160:175], v[200:203], v[224:227], v[160:175]
    s_addc_u32 s7, s7, 0
    s_waitcnt vmcnt(18)
    v_mfma_f32_32x32x16_bf16 v[176:191], v[200:203], v[228:231], v[176:191]
    ds_write_b128 v14, v[40:43] offset:0
    ds_write_b128 v14, v[44:47] offset:4608
    s_waitcnt lgkmcnt(2)
    v_mfma_f32_32x32x16_bf16 v[160:175], v[204:207], v[232:235], v[160:175]
    ds_write_b128 v14, v[48:51] offset:9216
    ds_write_b128 v14, v[52:55] offset:13824
    v_mfma_f32_32x32x16_bf16 v[176:191], v[204:207], v[236:239], v[176:191]
    ds_write_b128 v15, v[56:59] offset:0
    ds_write_b128 v15, v[60:63] offset:6144
    s_waitcnt lgkmcnt(0)
    s_barrier
    ds_read_b128 v[208:211], v22 offset:0
    ds_read_b128 v[212:215], v22 offset:4608
    ds_read_b64_tr_b16 v[192:193], v23 offset:0
    ds_read_b64_tr_b16 v[194:195], v23 offset:768
    ds_read_b128 v[216:219], v22 offset:32
    ds_read_b128 v[220:223], v22 offset:4640
    ds_read_b64_tr_b16 v[196:197], v23 offset:3072
    ds_read_b64_tr_b16 v[198:199], v23 offset:3840
    ds_read_b128 v[224:227], v22 offset:64
    ds_read_b128 v[228:231], v22 offset:4672
    ds_read_b64_tr_b16 v[200:201], v23 offset:6144
    ds_read_b64_tr_b16 v[202:203], v23 offset:6912
    ds_read_b128 v[232:235], v22 offset:96
    ds_read_b128 v[236:239], v22 offset:4704
    ds_read_b64_tr_b16 v[204:205], v23 offset:9216
    ds_read_b64_tr_b16 v[206:207], v23 offset:9984
    s_add_u32 s20, s20, 4
    s_cmp_lt_u32 s20, 12
    s_cbranch_scc1 L_wo3_loop
    s_waitcnt lgkmcnt(12)
    v_mfma_f32_32x32x16_bf16 v[160:175], v[192:195], v[208:211], v[160:175]
    s_waitcnt vmcnt(12)
    v_mfma_f32_32x32x16_bf16 v[176:191], v[192:195], v[212:215], v[176:191]
    ds_write_b128 v14, v[64:67] offset:30720
    s_waitcnt lgkmcnt(9)
    v_mfma_f32_32x32x16_bf16 v[160:175], v[196:199], v[216:219], v[160:175]
    ds_write_b128 v14, v[68:71] offset:35328
    v_mfma_f32_32x32x16_bf16 v[176:191], v[196:199], v[220:223], v[176:191]
    ds_write_b128 v14, v[72:75] offset:39936
    s_waitcnt lgkmcnt(7)
    v_mfma_f32_32x32x16_bf16 v[160:175], v[200:203], v[224:227], v[160:175]
    ds_write_b128 v14, v[76:79] offset:44544
    v_mfma_f32_32x32x16_bf16 v[176:191], v[200:203], v[228:231], v[176:191]
    ds_write_b128 v15, v[80:83] offset:30720
    s_waitcnt lgkmcnt(5)
    v_mfma_f32_32x32x16_bf16 v[160:175], v[204:207], v[232:235], v[160:175]
    ds_write_b128 v15, v[84:87] offset:36864
    v_mfma_f32_32x32x16_bf16 v[176:191], v[204:207], v[236:239], v[176:191]
    s_waitcnt lgkmcnt(0)
    s_barrier
    ds_read_b128 v[208:211], v24 offset:0
    ds_read_b128 v[212:215], v24 offset:4608
    ds_read_b64_tr_b16 v[192:193], v25 offset:0
    ds_read_b64_tr_b16 v[194:195], v25 offset:768
    ds_read_b128 v[216:219], v24 offset:32
    ds_read_b128 v[220:223], v24 offset:4640
    ds_read_b64_tr_b16 v[196:197], v25 offset:3072
    ds_read_b64_tr_b16 v[198:199], v25 offset:3840
    ds_read_b128 v[224:227], v24 offset:64
    ds_read_b128 v[228:231], v24 offset:4672
    ds_read_b64_tr_b16 v[200:201], v25 offset:6144
    ds_read_b64_tr_b16 v[202:203], v25 offset:6912
    ds_read_b128 v[232:235], v24 offset:96
    ds_read_b128 v[236:239], v24 offset:4704
    ds_read_b64_tr_b16 v[204:205], v25 offset:9216
    ds_read_b64_tr_b16 v[206:207], v25 offset:9984
    s_waitcnt lgkmcnt(12)
    v_mfma_f32_32x32x16_bf16 v[160:175], v[192:195], v[208:211], v[160:175]
    s_waitcnt vmcnt(6)
    v_mfma_f32_32x32x16_bf16 v[176:191], v[192:195], v[212:215], v[176:191]
    ds_write_b128 v14, v[88:91] offset:0
    s_waitcnt lgkmcnt(9)
    v_mfma_f32_32x32x16_bf16 v[160:175], v[196:199], v[216:219], v[160:175]
    ds_write_b128 v14, v[92:95] offset:4608
    v_mfma_f32_32x32x16_bf16 v[176:191], v[196:199], v[220:223], v[176:191]
    ds_write_b128 v14, v[96:99] offset:9216
    s_waitcnt lgkmcnt(7)
    v_mfma_f32_32x32x16_bf16 v[160:175], v[200:203], v[224:227], v[160:175]
    ds_write_b128 v14, v[100:103] offset:13824
    v_mfma_f32_32x32x16_bf16 v[176:191], v[200:203], v[228:231], v[176:191]
    ds_write_b128 v15, v[104:107] offset:0
    s_waitcnt lgkmcnt(5)
    v_mfma_f32_32x32x16_bf16 v[160:175], v[204:207], v[232:235], v[160:175]
    ds_write_b128 v15, v[108:111] offset:6144
    v_mfma_f32_32x32x16_bf16 v[176:191], v[204:207], v[236:239], v[176:191]
    s_waitcnt lgkmcnt(0)
    s_barrier
    ds_read_b128 v[208:211], v22 offset:0
    ds_read_b128 v[212:215], v22 offset:4608
    ds_read_b64_tr_b16 v[192:193], v23 offset:0
    ds_read_b64_tr_b16 v[194:195], v23 offset:768
    ds_read_b128 v[216:219], v22 offset:32
    ds_read_b128 v[220:223], v22 offset:4640
    ds_read_b64_tr_b16 v[196:197], v23 offset:3072
    ds_read_b64_tr_b16 v[198:199], v23 offset:3840
    ds_read_b128 v[224:227], v22 offset:64
    ds_read_b128 v[228:231], v22 offset:4672
    ds_read_b64_tr_b16 v[200:201], v23 offset:6144
    ds_read_b64_tr_b16 v[202:203], v23 offset:6912
    ds_read_b128 v[232:235], v22 offset:96
    ds_read_b128 v[236:239], v22 offset:4704
    ds_read_b64_tr_b16 v[204:205], v23 offset:9216
    ds_read_b64_tr_b16 v[206:207], v23 offset:9984
    s_waitcnt lgkmcnt(12)
    v_mfma_f32_32x32x16_bf16 v[160:175], v[192:195], v[208:211], v[160:175]
    s_waitcnt vmcnt(0)
    v_mfma_f32_32x32x16_bf16 v[176:191], v[192:195], v[212:215], v[176:191]
    ds_write_b128 v14, v[112:115] offset:30720
    s_waitcnt lgkmcnt(9)
    v_mfma_f32_32x32x16_bf16 v[160:175], v[196:199], v[216:219], v[160:175]
    ds_write_b128 v14, v[116:119] offset:35328
    v_mfma_f32_32x32x16_bf16 v[176:191], v[196:199], v[220:223], v[176:191]
    ds_write_b128 v14, v[120:123] offset:39936
    s_waitcnt lgkmcnt(7)
    v_mfma_f32_32x32x16_bf16 v[160:175], v[200:203], v[224:227], v[160:175]
    ds_write_b128 v14, v[124:127] offset:44544
    v_mfma_f32_32x32x16_bf16 v[176:191], v[200:203], v[228:231], v[176:191]
    ds_write_b128 v15, v[128:131] offset:30720
    s_waitcnt lgkmcnt(5)
    v_mfma_f32_32x32x16_bf16 v[160:175], v[204:207], v[232:235], v[160:175]
    ds_write_b128 v15, v[132:135] offset:36864
    v_mfma_f32_32x32x16_bf16 v[176:191], v[204:207], v[236:239], v[176:191]
    s_waitcnt lgkmcnt(0)
    s_barrier
    ds_read_b128 v[208:211], v24 offset:0
    ds_read_b128 v[212:215], v24 offset:4608
    ds_read_b64_tr_b16 v[192:193], v25 offset:0
    ds_read_b64_tr_b16 v[194:195], v25 offset:768
    ds_read_b128 v[216:219], v24 offset:32
    ds_read_b128 v[220:223], v24 offset:4640
    ds_read_b64_tr_b16 v[196:197], v25 offset:3072
    ds_read_b64_tr_b16 v[198:199], v25 offset:3840
    ds_read_b128 v[224:227], v24 offset:64
    ds_read_b128 v[228:231], v24 offset:4672
    ds_read_b64_tr_b16 v[200:201], v25 offset:6144
    ds_read_b64_tr_b16 v[202:203], v25 offset:6912
    ds_read_b128 v[232:235], v24 offset:96
    ds_read_b128 v[236:239], v24 offset:4704
    ds_read_b64_tr_b16 v[204:205], v25 offset:9216
    ds_read_b64_tr_b16 v[206:207], v25 offset:9984
    s_waitcnt lgkmcnt(12)
    v_mfma_f32_32x32x16_bf16 v[160:175], v[192:195], v[208:211], v[160:175]
    v_mfma_f32_32x32x16_bf16 v[176:191], v[192:195], v[212:215], v[176:191]
    s_waitcnt lgkmcnt(8)
    v_mfma_f32_32x32x16_bf16 v[160:175], v[196:199], v[216:219], v[160:175]
    v_mfma_f32_32x32x16_bf16 v[176:191], v[196:199], v[220:223], v[176:191]
    s_waitcnt lgkmcnt(4)
    v_mfma_f32_32x32x16_bf16 v[160:175], v[200:203], v[224:227], v[160:175]
    v_mfma_f32_32x32x16_bf16 v[176:191], v[200:203], v[228:231], v[176:191]
    s_waitcnt lgkmcnt(0)
    v_mfma_f32_32x32x16_bf16 v[160:175], v[204:207], v[232:235], v[160:175]
    v_mfma_f32_32x32x16_bf16 v[176:191], v[204:207], v[236:239], v[176:191]
    s_nop 15
    s_nop 7
    s_load_dwordx2 s[14:15], s[0:1], 64
    s_load_dwordx2 s[16:17], s[0:1], 48
    s_load_dwordx2 s[18:19], s[0:1], 64
    s_waitcnt lgkmcnt(0)
    s_add_u32 s18, s18, 4194304
    s_addc_u32 s19, s19, 0
    s_barrier
    v_lshlrev_b32 v24, 13, v17
    v_lshl_add_u32 v22, v20, 7, v24
    v_lshl_add_u32 v22, v21, 4, v22
    ds_write_b128 v22, v[160:163] offset:0
    ds_write_b128 v22, v[164:167] offset:32
    ds_write_b128 v22, v[168:171] offset:64
    ds_write_b128 v22, v[172:175] offset:96
    ds_write_b128 v22, v[176:179] offset:4096
    ds_write_b128 v22, v[180:183] offset:4128
    ds_write_b128 v22, v[184:187] offset:4160
    ds_write_b128 v22, v[188:191] offset:4192
    v_lshl_add_u32 v23, v16, 5, v24
    v_lshrrev_b32 v25, 2, v16
    v_and_b32 v26, 3, v16
    v_lshl_add_u32 v27, v18, 6, s10
    v_add_u32 v27, v27, v25
    s_lshl_b32 s12, s9, 6
    v_lshl_add_u32 v28, v19, 5, s12
    v_lshl_add_u32 v28, v26, 3, v28
    v_lshlrev_b32 v29, 10, v27
    v_add_u32 v29, v29, v28
    v_lshlrev_b32 v29, 1, v29
    s_lshl_b32 s13, s9, 1
    v_lshl_add_u32 v30, v27, 5, s13
    v_add_u32 v30, v30, v19
    v_lshlrev_b32 v30, 3, v30
    global_load_dwordx4 v[40:43], v29, s[14:15] offset:0
    v_add_u32 v31, 32768, v29
    global_load_dwordx4 v[44:47], v31, s[14:15]
    v_add_u32 v31, 65536, v29
    global_load_dwordx4 v[48:51], v31, s[14:15]
    v_add_u32 v31, 98304, v29
    global_load_dwordx4 v[52:55], v31, s[14:15]
    s_waitcnt lgkmcnt(0)
    ds_read_b128 v[64:67], v23 offset:0
    ds_read_b128 v[68:71], v23 offset:16
    ds_read_b128 v[72:75], v23 offset:2048
    ds_read_b128 v[76:79], v23 offset:2064
    ds_read_b128 v[80:83], v23 offset:4096
    ds_read_b128 v[84:87], v23 offset:4112
    ds_read_b128 v[88:91], v23 offset:6144
    ds_read_b128 v[92:95], v23 offset:6160
    s_waitcnt vmcnt(0) lgkmcnt(0)
    v_mov_b32 v56, 0
    v_mov_b32 v57, 0
    v_lshlrev_b32 v58, 16, v40
    v_and_b32 v59, 0xffff0000, v40
    v_add_f32 v58, v58, v64
    v_add_f32 v59, v59, v65
    v_cvt_pk_bf16_f32 v40, v58, v59
    v_lshlrev_b32 v58, 16, v40
    v_and_b32 v59, 0xffff0000, v40
    v_add_f32 v56, v56, v58
    v_fmac_f32 v57, v58, v58
    v_add_f32 v56, v56, v59
    v_fmac_f32 v57, v59, v59
    v_lshlrev_b32 v58, 16, v41
    v_and_b32 v59, 0xffff0000, v41
    v_add_f32 v58, v58, v66
    v_add_f32 v59, v59, v67
    v_cvt_pk_bf16_f32 v41, v58, v59
    v_lshlrev_b32 v58, 16, v41
    v_and_b32 v59, 0xffff0000, v41
    v_add_f32 v56, v56, v58
    v_fmac_f32 v57, v58, v58
    v_add_f32 v56, v56, v59
    v_fmac_f32 v57, v59, v59
    v_lshlrev_b32 v58, 16, v42
    v_and_b32 v59, 0xffff0000, v42
    v_add_f32 v58, v58, v68
    v_add_f32 v59, v59, v69
    v_cvt_pk_bf16_f32 v42, v58, v59
    v_lshlrev_b32 v58, 16, v42
    v_and_b32 v59, 0xffff0000, v42
    v_add_f32 v56, v56, v58
    v_fmac_f32 v57, v58, v58
    v_add_f32 v56, v56, v59
    v_fmac_f32 v57, v59, v59
    v_lshlrev_b32 v58, 16, v43
    v_and_b32 v59, 0xffff0000, v43
    v_add_f32 v58, v58, v70
    v_add_f32 v59, v59, v71
    v_cvt_pk_bf16_f32 v43, v58, v59
    v_lshlrev_b32 v58, 16, v43
    v_and_b32 v59, 0xffff0000, v43
    v_add_f32 v56, v56, v58
    v_fmac_f32 v57, v58, v58
    v_add_f32 v56, v56, v59
    v_fmac_f32 v57, v59, v59
    v_add_u32 v31, 0, v29
    global_store_dwordx4 v31, v[40:43], s[16:17]
    s_nop 1
    v_mov_b32_dpp v58, v56 quad_perm:[1,0,3,2] row_mask:0xf bank_mask:0xf
    v_mov_b32_dpp v59, v57 quad_perm:[1,0,3,2] row_mask:0xf bank_mask:0xf
    v_add_f32 v56, v56, v58
    v_add_f32 v57, v57, v59
    s_nop 1
    v_mov_b32_dpp v58, v56 quad_perm:[2,3,0,1] row_mask:0xf bank_mask:0xf
    v_mov_b32_dpp v59, v57 quad_perm:[2,3,0,1] row_mask:0xf bank_mask:0xf
    v_add_f32 v56, v56, v58
    v_add_f32 v57, v57, v59
    v_cmp_eq_u32 vcc, 0, v26
    s_and_saveexec_b64 s[22:23], vcc
    v_add_u32 v31, 0, v30
    global_store_dwordx2 v31, v[56:57], s[18:19]
    s_mov_b64 exec, s[22:23]
    v_mov_b32 v56, 0
    v_mov_b32 v57, 0
    v_lshlrev_b32 v58, 16, v44
    v_and_b32 v59, 0xffff0000, v44
    v_add_f32 v58, v58, v72
    v_add_f32 v59, v59, v73
    v_cvt_pk_bf16_f32 v44, v58, v59
    v_lshlrev_b32 v58, 16, v44
    v_and_b32 v59, 0xffff0000, v44
    v_add_f32 v56, v56, v58
    v_fmac_f32 v57, v58, v58
    v_add_f32 v56, v56, v59
    v_fmac_f32 v57, v59, v59
    v_lshlrev_b32 v58, 16, v45
    v_and_b32 v59, 0xffff0000, v45
    v_add_f32 v58, v58, v74
    v_add_f32 v59, v59, v75
    v_cvt_pk_bf16_f32 v45, v58, v59
    v_lshlrev_b32 v58, 16, v45
    v_and_b32 v59, 0xffff0000, v45
    v_add_f32 v56, v56, v58
    v_fmac_f32 v57, v58, v58
    v_add_f32 v56, v56, v59
    v_fmac_f32 v57, v59, v59
    v_lshlrev_b32 v58, 16, v46
    v_and_b32 v59, 0xffff0000, v46
    v_add_f32 v58, v58, v76
    v_add_f32 v59, v59, v77
    v_cvt_pk_bf16_f32 v46, v58, v59
    v_lshlrev_b32 v58, 16, v46
    v_and_b32 v59, 0xffff0000, v46
    v_add_f32 v56, v56, v58
    v_fmac_f32 v57, v58, v58
    v_add_f32 v56, v56, v59
    v_fmac_f32 v57, v59, v59
    v_lshlrev_b32 v58, 16, v47
    v_and_b32 v59, 0xffff0000, v47
    v_add_f32 v58, v58, v78
    v_add_f32 v59, v59, v79
    v_cvt_pk_bf16_f32 v47, v58, v59
    v_lshlrev_b32 v58, 16, v47
    v_and_b32 v59, 0xffff0000, v47
    v_add_f32 v56, v56, v58
    v_fmac_f32 v57, v58, v58
    v_add_f32 v56, v56, v59
    v_fmac_f32 v57, v59, v59
    v_add_u32 v31, 32768, v29
    global_store_dwordx4 v31, v[44:47], s[16:17]
    s_nop 1
    v_mov_b32_dpp v58, v56 quad_perm:[1,0,3,2] row_mask:0xf bank_mask:0xf
    v_mov_b32_dpp v59, v57 quad_perm:[1,0,3,2] row_mask:0xf bank_mask:0xf
    v_add_f32 v56, v56, v58
    v_add_f32 v57, v57, v59
    s_nop 1
    v_mov_b32_dpp v58, v56 quad_perm:[2,3,0,1] row_mask:0xf bank_mask:0xf
    v_mov_b32_dpp v59, v57 quad_perm:[2,3,0,1] row_mask:0xf bank_mask:0xf
    v_add_f32 v56, v56, v58
    v_add_f32 v57, v57, v59
    v_cmp_eq_u32 vcc, 0, v26
    s_and_saveexec_b64 s[22:23], vcc
    v_add_u32 v31, 4096, v30
    global_store_dwordx2 v31, v[56:57], s[18:19]
    s_mov_b64 exec, s[22:23]
    v_mov_b32 v56, 0
    v_mov_b32 v57, 0
    v_lshlrev_b32 v58, 16, v48
    v_and_b32 v59, 0xffff0000, v48
    v_add_f32 v58, v58, v80
    v_add_f32 v59, v59, v81
    v_cvt_pk_bf16_f32 v48, v58, v59
    v_lshlrev_b32 v58, 16, v48
    v_and_b32 v59, 0xffff0000, v48
    v_add_f32 v56, v56, v58
    v_fmac_f32 v57, v58, v58
    v_add_f32 v56, v56, v59
    v_fmac_f32 v57, v59, v59
    v_lshlrev_b32 v58, 16, v49
    v_and_b32 v59, 0xffff0000, v49
    v_add_f32 v58, v58, v82
    v_add_f32 v59, v59, v83
    v_cvt_pk_bf16_f32 v49, v58, v59
    v_lshlrev_b32 v58, 16, v49
    v_and_b32 v59, 0xffff0000, v49
    v_add_f32 v56, v56, v58
    v_fmac_f32 v57, v58, v58
    v_add_f32 v56, v56, v59
    v_fmac_f32 v57, v59, v59
    v_lshlrev_b32 v58, 16, v50
    v_and_b32 v59, 0xffff0000, v50
    v_add_f32 v58, v58, v84
    v_add_f32 v59, v59, v85
    v_cvt_pk_bf16_f32 v50, v58, v59
    v_lshlrev_b32 v58, 16, v50
    v_and_b32 v59, 0xffff0000, v50
    v_add_f32 v56, v56, v58
    v_fmac_f32 v57, v58, v58
    v_add_f32 v56, v56, v59
    v_fmac_f32 v57, v59, v59
    v_lshlrev_b32 v58, 16, v51
    v_and_b32 v59, 0xffff0000, v51
    v_add_f32 v58, v58, v86
    v_add_f32 v59, v59, v87
    v_cvt_pk_bf16_f32 v51, v58, v59
    v_lshlrev_b32 v58, 16, v51
    v_and_b32 v59, 0xffff0000, v51
    v_add_f32 v56, v56, v58
    v_fmac_f32 v57, v58, v58
    v_add_f32 v56, v56, v59
    v_fmac_f32 v57, v59, v59
    v_add_u32 v31, 65536, v29
    global_store_dwordx4 v31, v[48:51], s[16:17]
    s_nop 1
    v_mov_b32_dpp v58, v56 quad_perm:[1,0,3,2] row_mask:0xf bank_mask:0xf
    v_mov_b32_dpp v59, v57 quad_perm:[1,0,3,2] row_mask:0xf bank_mask:0xf
    v_add_f32 v56, v56, v58
    v_add_f32 v57, v57, v59
    s_nop 1
    v_mov_b32_dpp v58, v56 quad_perm:[2,3,0,1] row_mask:0xf bank_mask:0xf
    v_mov_b32_dpp v59, v57 quad_perm:[2,3,0,1] row_mask:0xf bank_mask:0xf
    v_add_f32 v56, v56, v58
    v_add_f32 v57, v57, v59
    v_cmp_eq_u32 vcc, 0, v26
    s_and_saveexec_b64 s[22:23], vcc
    v_add_u32 v31, 8192, v30
    global_store_dwordx2 v31, v[56:57], s[18:19]
    s_mov_b64 exec, s[22:23]
    v_mov_b32 v56, 0
    v_mov_b32 v57, 0
    v_lshlrev_b32 v58, 16, v52
    v_and_b32 v59, 0xffff0000, v52
    v_add_f32 v58, v58, v88
    v_add_f32 v59, v59, v89
    v_cvt_pk_bf16_f32 v52, v58, v59
    v_lshlrev_b32 v58, 16, v52
    v_and_b32 v59, 0xffff0000, v52
    v_add_f32 v56, v56, v58
    v_fmac_f32 v57, v58, v58
    v_add_f32 v56, v56, v59
    v_fmac_f32 v57, v59, v59
    v_lshlrev_b32 v58, 16, v53
    v_and_b32 v59, 0xffff0000, v53
    v_add_f32 v58, v58, v90
    v_add_f32 v59, v59, v91
    v_cvt_pk_bf16_f32 v53, v58, v59
    v_lshlrev_b32 v58, 16, v53
    v_and_b32 v59, 0xffff0000, v53
    v_add_f32 v56, v56, v58
    v_fmac_f32 v57, v58, v58
    v_add_f32 v56, v56, v59
    v_fmac_f32 v57, v59, v59
    v_lshlrev_b32 v58, 16, v54
    v_and_b32 v59, 0xffff0000, v54
    v_add_f32 v58, v58, v92
    v_add_f32 v59, v59, v93
    v_cvt_pk_bf16_f32 v54, v58, v59
    v_lshlrev_b32 v58, 16, v54
    v_and_b32 v59, 0xffff0000, v54
    v_add_f32 v56, v56, v58
    v_fmac_f32 v57, v58, v58
    v_add_f32 v56, v56, v59
    v_fmac_f32 v57, v59, v59
    v_lshlrev_b32 v58, 16, v55
    v_and_b32 v59, 0xffff0000, v55
    v_add_f32 v58, v58, v94
    v_add_f32 v59, v59, v95
    v_cvt_pk_bf16_f32 v55, v58, v59
    v_lshlrev_b32 v58, 16, v55
    v_and_b32 v59, 0xffff0000, v55
    v_add_f32 v56, v56, v58
    v_fmac_f32 v57, v58, v58
    v_add_f32 v56, v56, v59
    v_fmac_f32 v57, v59, v59
    v_add_u32 v31, 98304, v29
    global_store_dwordx4 v31, v[52:55], s[16:17]
    s_nop 1
    v_mov_b32_dpp v58, v56 quad_perm:[1,0,3,2] row_mask:0xf bank_mask:0xf
    v_mov_b32_dpp v59, v57 quad_perm:[1,0,3,2] row_mask:0xf bank_mask:0xf
    v_add_f32 v56, v56, v58
    v_add_f32 v57, v57, v59
    s_nop 1
    v_mov_b32_dpp v58, v56 quad_perm:[2,3,0,1] row_mask:0xf bank_mask:0xf
    v_mov_b32_dpp v59, v57 quad_perm:[2,3,0,1] row_mask:0xf bank_mask:0xf
    v_add_f32 v56, v56, v58
    v_add_f32 v57, v57, v59
    v_cmp_eq_u32 vcc, 0, v26
    s_and_saveexec_b64 s[22:23], vcc
    v_add_u32 v31, 12288, v30
    global_store_dwordx2 v31, v[56:57], s[18:19]
    s_mov_b64 exec, s[22:23]
L_wo3_end:
    s_endpgm
.section .rodata,"a"
.p2align 6
.amdhsa_kernel prep_kernel
  .amdhsa_next_free_vgpr 256
  .amdhsa_next_free_sgpr 102
  .amdhsa_accum_offset 256
  .amdhsa_group_segment_fixed_size 0
  .amdhsa_kernarg_size 72
  .amdhsa_user_sgpr_count 2
  .amdhsa_user_sgpr_kernarg_segment_ptr 1
  .amdhsa_system_sgpr_workgroup_id_x 1
.end_amdhsa_kernel
.section .rodata,"a"
.p2align 6
.amdhsa_kernel qkv0_kernel
  .amdhsa_next_free_vgpr 256
  .amdhsa_next_free_sgpr 102
  .amdhsa_accum_offset 256
  .amdhsa_group_segment_fixed_size 0
  .amdhsa_kernarg_size 72
  .amdhsa_user_sgpr_count 2
  .amdhsa_user_sgpr_kernarg_segment_ptr 1
  .amdhsa_system_sgpr_workgroup_id_x 1
.end_amdhsa_kernel
.section .rodata,"a"
.p2align 6
.amdhsa_kernel atta0_kernel
  .amdhsa_next_free_vgpr 256
  .amdhsa_next_free_sgpr 102
  .amdhsa_accum_offset 256
  .amdhsa_group_segment_fixed_size 0
  .amdhsa_kernarg_size 72
  .amdhsa_user_sgpr_count 2
  .amdhsa_user_sgpr_kernarg_segment_ptr 1
  .amdhsa_system_sgpr_workgroup_id_x 1
.end_amdhsa_kernel
.section .rodata,"a"
.p2align 6
.amdhsa_kernel wo0_kernel
  .amdhsa_next_free_vgpr 256
  .amdhsa_next_free_sgpr 102
  .amdhsa_accum_offset 256
  .amdhsa_group_segment_fixed_size 0
  .amdhsa_kernarg_size 72
  .amdhsa_user_sgpr_count 2
  .amdhsa_user_sgpr_kernarg_segment_ptr 1
  .amdhsa_system_sgpr_workgroup_id_x 1
.end_amdhsa_kernel
.section .rodata,"a"
.p2align 6
.amdhsa_kernel qkv1_kernel
  .amdhsa_next_free_vgpr 256
  .amdhsa_next_free_sgpr 102
  .amdhsa_accum_offset 256
  .amdhsa_group_segment_fixed_size 0
  .amdhsa_kernarg_size 72
  .amdhsa_user_sgpr_count 2
  .amdhsa_user_sgpr_kernarg_segment_ptr 1
  .amdhsa_system_sgpr_workgroup_id_x 1
.end_amdhsa_kernel
.section .rodata,"a"
.p2align 6
.amdhsa_kernel attb1_kernel
  .amdhsa_next_free_vgpr 256
  .amdhsa_next_free_sgpr 102
  .amdhsa_accum_offset 256
  .amdhsa_group_segment_fixed_size 0
  .amdhsa_kernarg_size 72
  .amdhsa_user_sgpr_count 2
  .amdhsa_user_sgpr_kernarg_segment_ptr 1
  .amdhsa_system_sgpr_workgroup_id_x 1
.end_amdhsa_kernel
.section .rodata,"a"
.p2align 6
.amdhsa_kernel wo1_kernel
  .amdhsa_next_free_vgpr 256
  .amdhsa_next_free_sgpr 102
  .amdhsa_accum_offset 256
  .amdhsa_group_segment_fixed_size 0
  .amdhsa_kernarg_size 72
  .amdhsa_user_sgpr_count 2
  .amdhsa_user_sgpr_kernarg_segment_ptr 1
  .amdhsa_system_sgpr_workgroup_id_x 1
.end_amdhsa_kernel
.section .rodata,"a"
.p2align 6
.amdhsa_kernel qkv2_kernel
  .amdhsa_next_free_vgpr 256
  .amdhsa_next_free_sgpr 102
  .amdhsa_accum_offset 256
  .amdhsa_group_segment_fixed_size 0
  .amdhsa_kernarg_size 72
  .amdhsa_user_sgpr_count 2
  .amdhsa_user_sgpr_kernarg_segment_ptr 1
  .amdhsa_system_sgpr_workgroup_id_x 1
.end_amdhsa_kernel
.section .rodata,"a"
.p2align 6
.amdhsa_kernel wo2_kernel
  .amdhsa_next_free_vgpr 256
  .amdhsa_next_free_sgpr 102
  .amdhsa_accum_offset 256
  .amdhsa_group_segment_fixed_size 0
  .amdhsa_kernarg_size 72
  .amdhsa_user_sgpr_count 2
  .amdhsa_user_sgpr_kernarg_segment_ptr 1
  .amdhsa_system_sgpr_workgroup_id_x 1
.end_amdhsa_kernel
.section .rodata,"a"
.p2align 6
.amdhsa_kernel qkv3_kernel
  .amdhsa_next_free_vgpr 256
  .amdhsa_next_free_sgpr 102
  .amdhsa_accum_offset 256
  .amdhsa_group_segment_fixed_size 0
  .amdhsa_kernarg_size 72
  .amdhsa_user_sgpr_count 2
  .amdhsa_user_sgpr_kernarg_segment_ptr 1
  .amdhsa_system_sgpr_workgroup_id_x 1
.end_amdhsa_kernel
.section .rodata,"a"
.p2align 6
.amdhsa_kernel wo3_kernel
  .amdhsa_next_free_vgpr 256
  .amdhsa_next_free_sgpr 102
  .amdhsa_accum_offset 256
  .amdhsa_group_segment_fixed_size 0
  .amdhsa_kernarg_size 72
  .amdhsa_user_sgpr_count 2
  .amdhsa_user_sgpr_kernarg_segment_ptr 1
  .amdhsa_system_sgpr_workgroup_id_x 1
.end_amdhsa_kernel
```
